```python
import torch

def _softmax(x, axis=-1):
    return torch.softmax(x, dim=axis)

def _gelu(x):
    return torch.nn.functional.gelu(x, approximate='tanh')

def _silu(x):
    return torch.nn.functional.silu(x)

def _sigmoid(x):
    return torch.sigmoid(x)

def _layernorm(x, axis=-1, eps=1e-05):
    m = x.mean(dim=axis, keepdim=True)
    v = x.var(dim=axis, keepdim=True, unbiased=False)
    return (x - m) / torch.sqrt(v + eps)

def _scatter_add(tgt, idx, src, axis=0):
    return tgt.clone().index_add_(axis, idx, src)

def _segment_sum(src, seg, n):
    out = torch.zeros((n,) + src.shape[1:], dtype=src.dtype)
    return out.index_add_(0, seg, src)

def _pad(x, pw):
    flat = tuple((v for pair in reversed(pw) for v in pair))
    return torch.nn.functional.pad(x, flat)
kernel_name = 'adaLN_cond__sliding_local_dilated__mixer_channel_mlp__prompt'

def setup_inputs():

    _w = lambda a: (lambda t: t.to(torch.bfloat16) if t.is_floating_point() else t)(torch.as_tensor(a))

    def _A_setup():
        B, S, D = (1, 2048, 640)
        return {'x': _w((lambda *s: torch.randn(*s, dtype=torch.bfloat16) * 0.05)(B, S, D)), 'wqkv': _w((lambda *s: torch.randn(*s, dtype=torch.bfloat16) * 0.05)(D, 3 * D)), 'wo': _w((lambda *s: torch.randn(*s, dtype=torch.bfloat16) * 0.05)(D, D))}
    _A_in = _A_setup()

    def _B_setup():
        B, S, D, F = (1, 2048, 640, 1728)
        return {'x': _w((lambda *s: torch.randn(*s, dtype=torch.bfloat16) * 0.05)(B, S, D)), 'w1': _w((lambda *s: torch.randn(*s, dtype=torch.bfloat16) * 3.2)(D, F) * D ** (-0.5)), 'b1': _w((lambda *s: torch.randn(*s, dtype=torch.bfloat16) * 1.6)(F)), 'w2': _w((lambda *s: torch.randn(*s, dtype=torch.bfloat16) * 0.4)(F, D) * F ** (-0.5)), 'b2': _w((lambda *s: torch.randn(*s, dtype=torch.bfloat16) * 0.8)(D))}
    _B_in = _B_setup()
    return {'A_x': _A_in['x'], 'A_wqkv': _A_in['wqkv'], 'A_wo': _A_in['wo'], 'B_x': _B_in['x'], 'B_w1': _B_in['w1'], 'B_b1': _B_in['b1'], 'B_w2': _B_in['w2'], 'B_b2': _B_in['b2'], 'c': _w((lambda *s: torch.randn(*s, dtype=torch.bfloat16) * 0.1)(1, 640) * 8.0), 'w_mod': _w((lambda *s: torch.randn(*s, dtype=torch.bfloat16) * 0.1)(640, 6 * 640) * 640 ** (-0.5) * 8.0)}

def reference(A_x, A_wqkv, A_wo, B_x, B_w1, B_b1, B_w2, B_b2, c, w_mod):

    def _A_ref(x, wqkv, wo):
        B, S, D = x.shape
        H = 32
        Dh = D // H
        W, dil = (8, 2)
        qkv = (lambda x, *d: x.permute(*d))((x @ wqkv).reshape(B, S, 3, H, Dh), 2, 0, 3, 1, 4)
        q, k, v = (qkv[0], qkv[1], qkv[2])
        scale = Dh ** (-0.5)
        pos = torch.arange(S)
        off = torch.arange(W) * dil
        idx = pos[:, None] - off[None, :]
        mask = idx >= 0
        idx_c = torch.where(mask, idx, 0).reshape(-1)
        kg = k[:, :, idx_c, :].reshape(B, H, S, W, Dh)
        vg = v[:, :, idx_c, :].reshape(B, H, S, W, Dh)
        logits = torch.einsum('bhsd,bhswd->bhsw', q, kg) * scale
        logits = torch.where(mask[None, None, :, :], logits, -1000000000.0)
        attn = _softmax(logits, axis=-1)
        o = torch.einsum('bhsw,bhswd->bhsd', attn, vg)
        return (lambda x, *d: x.permute(*d))(o, 0, 2, 1, 3).reshape(B, S, D) @ wo

    def _B_ref(x, w1, b1, w2, b2):
        y = _layernorm(x, axis=-1)
        h = _gelu(torch.einsum('bsd,df->bsf', y, w1) + b1)
        return torch.einsum('bsf,fd->bsd', h, w2) + b2
    x = A_x
    mod = (_silu(c) @ w_mod).reshape(c.shape[0], 6, 1, -1)
    sa, ca, ga, sb, cb, gb = (mod[:, 0].clone(), mod[:, 1].clone(), mod[:, 2].clone(), mod[:, 3].clone(), mod[:, 4].clone(), mod[:, 5].clone())
    h = _layernorm(x, axis=-1) * (1 + ca) + sa
    x = x + ga * _A_ref(h, A_wqkv, A_wo)
    h = _layernorm(x, axis=-1) * (1 + cb) + sb
    x = x + gb * _B_ref(h, B_w1, B_b1, B_w2, B_b2)
    return x
```

```asm
; @launch grid=(256,1,1) block=(256,1,1) lds=163840
.amdgcn_target "amdgcn-amd-amdhsa--gfx950"
.text
.globl adaLN_cond__sliding_local_dilated__mixer_channel_mlp__prompt_kernel
.p2align 8
.type adaLN_cond__sliding_local_dilated__mixer_channel_mlp__prompt_kernel,@function
adaLN_cond__sliding_local_dilated__mixer_channel_mlp__prompt_kernel:
  s_cmp_ge_u32 s2, 256
  s_cbranch_scc1 KP_END
  s_load_dwordx16 s[28:43], s[0:1], 0
  s_load_dwordx8 s[44:51], s[0:1], 64
  s_load_dwordx2 s[52:53], s[0:1], 96
  s_getpc_b64 s[20:21]
PC0:
  s_lshr_b32 s7, s2, 3
  s_lshl_b32 s6, s7, 8
  v_add_u32 v1, s6, v0
  v_lshrrev_b32 v1, 4, v1
  v_lshlrev_b32 v1, 7, v1
  v_min_u32 v1, KP_END-PC0, v1
  global_load_dword v243, v1, s[20:21]
  v_lshrrev_b32 v1, 6, v0
  v_and_b32 v2, 63, v0
  v_readfirstlane_b32 s3, v1
  v_lshlrev_b32 v1, 4, v2
  s_and_b32 s6, s3, 1
  s_lshl_b32 s60, s6, 4
  s_lshr_b32 s6, s3, 1
  s_lshl_b32 s6, s6, 2
  s_add_u32 s60, s60, s6
  s_sub_u32 s6, s2, 80
  s_mul_i32 s56, s6, 10923
  s_lshr_b32 s56, s56, 16
  s_mul_i32 s57, s56, 6
  s_sub_u32 s57, s6, s57
  s_and_b32 s22, s2, 7
  s_lshr_b32 s23, s2, 3
  s_mul_i32 s54, s22, 10
  s_add_u32 s54, s54, s23
  s_mul_i32 s55, s54, 3277
  s_lshr_b32 s55, s55, 16
  s_mul_i32 s24, s55, 20
  s_sub_u32 s54, s54, s24
  s_mul_i32 s22, s22, 7
  s_add_u32 s22, s22, s23
  s_sub_u32 s22, s22, 5
  s_sub_u32 s23, s22, 40
  s_cmp_ge_u32 s22, 60
  s_cselect_b32 s22, s23, s22
  s_cselect_b32 s23, 1, 0
  s_cmp_ge_u32 s2, 200
  s_cselect_b32 s54, s22, s54
  s_cselect_b32 s55, s23, s55
  s_lshl_b32 s22, s56, 5
  s_add_u32 s22, s22, s60
  s_mul_i32 s22, s22, 3840
  s_mul_i32 s23, s57, 640
  s_add_u32 s22, s22, s23
  s_mul_i32 s24, s55, 160
  s_mul_i32 s23, s3, 40
  s_add_u32 s24, s24, s23
  s_mul_i32 s24, s24, 7680
  s_lshl_b32 s23, s54, 7
  s_add_u32 s24, s24, s23
  v_lshrrev_b32 v12, 3, v2
  v_and_b32 v15, 6, v12
  v_mul_u32_u24 v12, 7680, v12
  v_and_b32 v13, 7, v2
  v_xor_b32 v15, v15, v13
  v_lshl_add_u32 v254, v15, 4, v12
  s_mov_b32 s25, 61440
  s_mov_b32 s26, 61440
  s_movk_i32 s27, 1024
  s_movk_i32 s58, 5120
  s_mov_b32 s59, -1
  s_mov_b32 s18, 4915200
  s_mov_b32 s19, 0x20000
  s_cmp_lt_u32 s6, 120
  s_cselect_b32 s95, 1, 0
  s_cselect_b32 s24, s22, s24
  s_cmov_b32 s25, 3840
  s_cmov_b32 s26, 19200
  s_cmov_b32 s27, 672
  s_cmov_b32 s58, 5376
  s_cmov_b32 s59, 0xff
  s_cmov_b32 s18, 2457600
  s_cselect_b64 vcc, -1, 0
  v_cndmask_b32 v12, v254, v1, vcc
  s_mul_i32 m0, s3, s58
  v_lshlrev_b32 v242, 3, v0
  s_cmp_eq_u32 s95, 1
  s_waitcnt lgkmcnt(0)
  s_cselect_b32 s16, s30, s46
  s_cselect_b32 s17, s31, s47
  s_load_dword s94, s[52:53], 49152
  s_mov_b32 s96, s44
  s_mov_b32 s97, s45
  s_mov_b32 s98, 1280
  s_mov_b32 s99, 0x20000
  buffer_load_dwordx2 v[240:241], v242, s[96:99], 0 offen
  s_mov_b32 exec_hi, s59
  buffer_load_dwordx4 v12, s[16:19], s24 offen nt lds
  s_add_u32 s24, s24, s25
  s_add_u32 m0, m0, s27
  s_nop 0
  buffer_load_dwordx4 v12, s[16:19], s24 offen nt lds
  s_add_u32 s24, s24, s25
  s_add_u32 m0, m0, s27
  s_nop 0
  buffer_load_dwordx4 v12, s[16:19], s24 offen nt lds
  s_add_u32 s24, s24, s25
  s_add_u32 m0, m0, s27
  s_nop 0
  buffer_load_dwordx4 v12, s[16:19], s24 offen nt lds
  s_add_u32 s24, s24, s26
  s_add_u32 m0, m0, s27
  s_nop 0
  buffer_load_dwordx4 v12, s[16:19], s24 offen nt lds
  s_add_u32 s24, s24, s25
  s_add_u32 m0, m0, s27
  s_cmp_eq_u32 s95, 0
  s_cbranch_scc1 SK1
  buffer_load_dwordx4 v12, s[16:19], s24 offen nt lds
  s_add_u32 s24, s24, s25
  s_add_u32 m0, m0, s27
  s_nop 0
  buffer_load_dwordx4 v12, s[16:19], s24 offen nt lds
  s_add_u32 s24, s24, s25
  s_add_u32 m0, m0, s27
  s_nop 0
  buffer_load_dwordx4 v12, s[16:19], s24 offen nt lds
SK1:
  s_mov_b64 exec, -1
  s_lshr_b32 s7, s2, 3
  s_and_b32 s6, s2, 7
  s_lshr_b32 s4, s6, 1
  s_lshl_b32 s4, s4, 3
  s_lshr_b32 s5, s7, 2
  s_add_u32 s4, s4, s5
  s_and_b32 s5, s6, 1
  s_lshl_b32 s5, s5, 2
  s_and_b32 s7, s7, 3
  s_add_u32 s5, s5, s7
  v_lshrrev_b32 v3, 4, v2
  v_and_b32 v5, 15, v2
  s_lshl_b32 s6, s3, 2
  v_add_u32 v15, s6, v3
  v_mul_u32_u24 v14, 2560, v15
  v_lshl_add_u32 v14, v5, 4, v14
  v_xor_b32 v15, v15, v13
  v_lshlrev_b32 v15, 4, v15
  v_lshl_add_u32 v15, v5, 8, v15
  v_lshlrev_b32 v13, 3, v0
  s_lshl_b32 s8, s4, 6
  s_cmp_lt_u32 s3, 2
  s_cselect_b32 s9, 17, 0
  s_and_b32 s6, s5, 3
  s_cmp_eq_u32 s6, 3
  s_cselect_b32 s6, 0, s6
  s_and_b32 s10, s5, 1
  s_add_u32 s7, s6, 0
  s_sub_u32 s22, s7, 3
  s_cmp_ge_u32 s7, 3
  s_cselect_b32 s7, s22, s7
  s_lshl_b32 s22, s7, 5
  s_cmp_eq_u32 s7, 0
  s_cselect_b32 s22, s9, s22
  s_sub_u32 s22, s22, 32
  s_add_u32 s22, s22, s8
  s_mul_i32 s22, s22, 1280
  v_add_u32 v4, s22, v14
  s_mul_i32 s7, s7, 20480
  v_add_u32 v244, s7, v15
  s_add_u32 s7, s6, 1
  s_sub_u32 s22, s7, 3
  s_cmp_ge_u32 s7, 3
  s_cselect_b32 s7, s22, s7
  s_lshl_b32 s22, s7, 5
  s_cmp_eq_u32 s7, 0
  s_cselect_b32 s22, s9, s22
  s_sub_u32 s22, s22, 32
  s_add_u32 s22, s22, s8
  s_mul_i32 s22, s22, 1280
  v_add_u32 v6, s22, v14
  s_mul_i32 s7, s7, 20480
  v_add_u32 v245, s7, v15
  s_add_u32 s7, s6, 2
  s_sub_u32 s22, s7, 3
  s_cmp_ge_u32 s7, 3
  s_cselect_b32 s7, s22, s7
  s_lshl_b32 s22, s7, 5
  s_cmp_eq_u32 s7, 0
  s_cselect_b32 s22, s9, s22
  s_sub_u32 s22, s22, 32
  s_add_u32 s22, s22, s8
  s_mul_i32 s22, s22, 1280
  v_add_u32 v7, s22, v14
  s_mul_i32 s7, s7, 20480
  v_add_u32 v246, s7, v15
  s_xor_b32 s7, s10, 0
  s_lshl_b32 s22, s7, 5
  s_add_u32 s22, s22, 1
  s_add_u32 s7, s7, 3
  s_add_u32 s22, s22, s8
  s_mul_i32 s22, s22, 1280
  v_add_u32 v8, s22, v14
  s_mul_i32 s7, s7, 20480
  v_add_u32 v247, s7, v15
  s_xor_b32 s7, s10, 1
  s_lshl_b32 s22, s7, 5
  s_add_u32 s22, s22, 1
  s_add_u32 s7, s7, 3
  s_add_u32 s22, s22, s8
  s_mul_i32 s22, s22, 1280
  v_add_u32 v9, s22, v14
  s_mul_i32 s7, s7, 20480
  v_add_u32 v248, s7, v15
  s_mov_b32 s10, 2621440
  s_mov_b32 s11, 0x20000
  s_mov_b32 s8, s28
  s_mov_b32 s9, s29
  s_mov_b32 s12, s52
  s_mov_b32 s13, s53
  s_mov_b32 s14, 24694784
  s_mov_b32 s15, 0x20000
  v_mov_b32 v11, 1879048192
  v_cmp_eq_u32 vcc, 0, v0
  s_nop 1
  v_cndmask_b32_e64 v10, v11, 0, vcc
  v_add_u32 v242, 158720, v13
  s_mul_i32 s6, s5, 448
  s_mul_i32 s7, s5, 384
  s_add_u32 s7, s7, 384
  s_cmp_ge_u32 s5, 6
  s_cselect_b32 s6, s7, s6
  s_mul_i32 s7, s5, 160
  s_mov_b32 s98, 3456
  s_mov_b32 m0, 157760
  s_bitcmp1_b32 s3, 0
  s_cselect_b32 s96, s42, s38
  s_cselect_b32 s97, s43, s39
  s_cselect_b32 s6, s7, s6
  s_cmov_b32 s98, 1280
  s_cmov_b32 m0, 158272
  s_mov_b64 exec, 0xfffffff
  buffer_load_dwordx4 v1, s[96:99], s6 offen lds
  s_mov_b64 exec, -1
  s_nop 4
  s_and_b32 s20, s3, 1
  s_lshr_b32 s21, s3, 1
  s_mul_i32 s31, s3, 5888
  s_add_u32 s31, s31, 112704
  s_movk_i32 s35, 0xff
  v_mov_b32 v249, v1
  s_mov_b32 s61, 0
  s_and_b32 s34, s2, 1
  s_cmp_lt_u32 s2, 100
  s_cbranch_scc1 SB_W1
  s_cmp_ge_u32 s2, 140
  s_cbranch_scc1 SB_W2
  s_sub_u32 s59, s2, 100
  s_lshr_b32 s59, s59, 1
  s_mov_b32 s96, s32
  s_mov_b32 s97, s33
  s_mov_b32 s98, 819200
  s_mov_b32 s99, 0x20000
  s_mul_i32 s7, s59, 40
  s_mul_i32 s22, s20, 20
  s_add_u32 s7, s7, s22
  s_lshl_b32 s22, s21, 2
  s_add_u32 s7, s7, s22
  s_sub_u32 s6, s59, 16
  s_mul_i32 s6, s6, 160
  s_mul_i32 s22, s20, 80
  s_add_u32 s6, s6, s22
  s_mul_i32 s22, s21, 20
  s_add_u32 s6, s6, s22
  s_add_u32 s6, s6, 16
  s_cmp_ge_u32 s59, 16
  s_cselect_b32 s7, s6, s7
  s_mov_b32 s30, 6400
  s_cmov_b32 s30, 47360
  s_mov_b32 s58, 1
  s_cmp_ge_u32 s59, 10
  s_cselect_b32 s61, 64, 0
  s_mov_b32 s62, 2686976
  s_mov_b32 s63, 102400
  s_branch SB_WW
SB_W2:
  s_sub_u32 s59, s2, 140
  s_lshr_b32 s59, s59, 1
  s_mov_b32 s96, s40
  s_mov_b32 s97, s41
  s_mov_b32 s98, 2211840
  s_mov_b32 s99, 0x20000
  s_lshl_b32 s7, s59, 5
  s_lshl_b32 s22, s3, 3
  s_add_u32 s7, s7, s22
  s_mov_b32 s30, 1280
  s_mov_b32 s62, 5718016
  s_mov_b32 s63, 276480
  s_cmp_ge_u32 s2, 248
  s_cselect_b32 s58, 3, 1
  s_cselect_b32 s7, 0, s7
  s_cselect_b64 vcc, -1, 0
  v_cndmask_b32 v249, v1, v11, vcc
SB_WW:
  s_mov_b32 s29, 1280
  s_mul_i32 s28, s7, 1280
  s_mul_i32 s22, s34, 640
  s_add_u32 s28, s28, s22
  s_lshl_b32 s22, s34, 2
  s_add_u32 s22, s22, s3
  s_mul_i32 s22, s22, s63
  s_add_u32 s62, s62, s22
  s_mul_i32 s22, s59, 5120
  s_add_u32 s62, s62, s22
  s_branch SB_END
SB_W1:
  s_mul_i32 s59, s2, 52429
  s_lshr_b32 s59, s59, 18
  s_mul_i32 s61, s59, 5
  s_sub_u32 s61, s2, s61
  s_mov_b32 s96, s36
  s_mov_b32 s97, s37
  s_mov_b32 s98, 2211840
  s_mov_b32 s99, 0x20000
  s_lshr_b32 s7, s59, 1
  s_mul_i32 s7, s7, 80
  s_and_b32 s22, s59, 1
  s_lshl_b32 s22, s22, 5
  s_add_u32 s7, s7, s22
  s_add_u32 s7, s7, s60
  s_sub_u32 s6, s59, 16
  s_mul_i32 s6, s6, 160
  s_mul_i32 s22, s21, 80
  s_add_u32 s6, s6, s22
  s_lshl_b32 s22, s20, 3
  s_add_u32 s6, s6, s22
  s_add_u32 s6, s6, 64
  s_cmp_ge_u32 s59, 16
  s_cselect_b32 s7, s6, s7
  s_mov_b32 s30, 17280
  s_cmov_b32 s30, 3456
  s_mov_b32 s29, 3456
  s_mul_i32 s28, s7, 3456
  s_mul_i32 s22, s61, 704
  s_add_u32 s28, s28, s22
  s_movk_i32 s35, 0xfff
  s_mov_b32 s58, 2
  s_mul_i32 s62, s61, 11
  s_add_u32 s62, s62, s21
  s_mul_i32 s62, s62, 40960
  s_lshl_b32 s22, s59, 11
  s_add_u32 s62, s62, s22
  s_lshl_b32 s22, s20, 10
  s_add_u32 s62, s62, s22
  s_add_u32 s62, s62, 3506176
SB_END:
  s_nop 4
  s_mov_b32 s100, 0x3f803f80
  s_mov_b32 s16, s46
  s_mov_b32 s17, s47
  s_mov_b32 s18, 4915200
  s_mov_b32 s19, 0x20000
  s_add_u32 s50, s2, 0
  s_and_b32 s50, s50, 255
  s_and_b32 s6, s2, 7
  s_mul_i32 s6, s6, 13
  s_lshr_b32 s7, s50, 3
  s_add_u32 s6, s6, s7
  s_add_u32 s6, s6, 56
  s_mul_i32 s53, s6, 1639
  s_lshr_b32 s53, s53, 16
  s_mul_i32 s51, s53, 40
  s_sub_u32 s51, s6, s51
  s_add_u32 s51, s51, 20
  s_mul_i32 s6, s53, 160
  s_mul_i32 s7, s3, 40
  s_add_u32 s6, s6, s7
  s_mul_i32 s6, s6, 7680
  s_lshl_b32 s7, s51, 7
  s_add_u32 s6, s6, s7
  s_xor_b32 s7, s2, 0
  s_and_b32 s7, s7, 0
  s_lshl_b32 s7, s7, 6
  s_or_b32 s43, s50, s7
  s_cmp_lt_u32 s43, 104
  s_cselect_b32 s50, s6, 0
  s_cselect_b32 s6, 0, 1879048192
  v_add_u32 v0, s6, v254
  v_and_b32 v12, 1, v2
  v_cmp_eq_u32 s[32:33], 1, v12
  v_and_b32 v12, 2, v2
  v_cmp_eq_u32 s[36:37], 2, v12
  s_lshl_b32 s23, s3, 10
  s_add_u32 s23, s23, 21823488
  s_lshr_b32 s25, s5, 2
  s_lshl_b32 s25, s25, 8
  s_add_u32 s25, s25, 32768
  v_mov_b32 v12, 0
  v_mov_b32 v13, 0
  v_mov_b32 v14, 110080
  ds_write_b64 v14, v[12:13]
  buffer_load_dwordx4 v[116:119], v4, s[8:11], 0 offen offset:0
  buffer_load_dwordx4 v[120:123], v4, s[8:11], 0 offen offset:256
  buffer_load_dwordx4 v[124:127], v4, s[8:11], 0 offen offset:512
  buffer_load_dwordx4 v[128:131], v4, s[8:11], 0 offen offset:768
  buffer_load_dwordx4 v[132:135], v4, s[8:11], 0 offen offset:1024
  buffer_load_dwordx4 v[136:139], v6, s[8:11], 0 offen offset:0
  buffer_load_dwordx4 v[140:143], v6, s[8:11], 0 offen offset:256
  buffer_load_dwordx4 v[144:147], v6, s[8:11], 0 offen offset:512
  s_mov_b32 s6, 0xbfb8aa3b
  s_waitcnt vmcnt(14)
  v_lshlrev_b32 v236, 16, v240
  v_and_b32 v237, 0xffff0000, v240
  v_lshlrev_b32 v238, 16, v241
  v_and_b32 v239, 0xffff0000, v241
  v_mul_f32 v232, s6, v236
  v_mul_f32 v233, s6, v237
  v_mul_f32 v234, s6, v238
  v_mul_f32 v235, s6, v239
  v_exp_f32 v232, v232
  v_exp_f32 v233, v233
  v_exp_f32 v234, v234
  v_exp_f32 v235, v235
  v_add_f32 v232, 1.0, v232
  v_add_f32 v233, 1.0, v233
  v_add_f32 v234, 1.0, v234
  v_add_f32 v235, 1.0, v235
  v_rcp_f32 v232, v232
  v_rcp_f32 v233, v233
  v_rcp_f32 v234, v234
  v_rcp_f32 v235, v235
  v_mul_f32 v236, v236, v232
  v_mul_f32 v237, v237, v233
  v_mul_f32 v238, v238, v234
  v_mul_f32 v239, v239, v235
  v_cvt_pk_bf16_f32 v240, v236, v237
  v_cvt_pk_bf16_f32 v241, v238, v239
  ds_write_b64 v242, v[240:241]
  buffer_load_dwordx4 v[148:151], v6, s[8:11], 0 offen offset:768
  buffer_load_dwordx4 v[152:155], v6, s[8:11], 0 offen offset:1024
  buffer_load_dwordx4 v[156:159], v7, s[8:11], 0 offen offset:0
  buffer_load_dwordx4 v[160:163], v7, s[8:11], 0 offen offset:256
  buffer_load_dwordx4 v[164:167], v7, s[8:11], 0 offen offset:512
  s_waitcnt lgkmcnt(0)
  s_mul_i32 s94, s94, 0x2c9277b5
  s_add_u32 s94, s94, 0xac564b05
  s_and_b32 s44, s94, 0xff
  s_bfe_u32 s45, s94, 0x80008
  s_bfe_u32 s46, s94, 0x80010
  s_lshr_b32 s47, s94, 24
  s_not_b32 s6, s94
  v_mov_b32 v252, s6
  v_mov_b32 v253, s6
  v_mov_b32 v254, s6
  v_mov_b32 v255, s6
  v_lshlrev_b32 v12, 6, v3
  v_cmp_eq_u32 vcc, 0, v5
  s_nop 1
  v_cndmask_b32 v13, v11, v12, vcc
  s_lshl_b32 s6, s54, 10
  s_lshl_b32 s7, s55, 4
  s_add_u32 s6, s6, s7
  s_lshl_b32 s7, s3, 8
  s_add_u32 s6, s6, s7
  s_add_u32 s6, s6, 21823488
  s_cmp_eq_u32 s95, 0
  s_cselect_b32 s6, s6, s14
  buffer_store_dwordx4 v[252:255], v13, s[12:15], s6 offen sc1
  s_waitcnt vmcnt(15)
  s_waitcnt lgkmcnt(0)
  s_barrier
  s_nop 4
  s_cmp_eq_u32 s95, 0
  s_cbranch_scc1 PA_M
  v_lshrrev_b32 v12, 2, v2
  v_mul_u32_u24 v12, 672, v12
  v_and_b32 v13, 3, v2
  s_mul_i32 s6, s3, 160
  v_add_u32 v12, s6, v12
  v_mul_u32_u24 v14, 40, v13
  v_add_u32 v14, v14, v12
  v_lshl_add_u32 v12, v13, 3, v12
  ds_read_b64_tr_b16 v[216:217], v12 offset:0
  ds_read_b64_tr_b16 v[218:219], v12 offset:10752
  ds_read_b64_tr_b16 v[220:221], v12 offset:40
  ds_read_b64_tr_b16 v[222:223], v12 offset:10792
  ds_read_b64_tr_b16 v[224:225], v12 offset:80
  ds_read_b64_tr_b16 v[226:227], v12 offset:10832
  ds_read_b64_tr_b16 v[228:229], v12 offset:120
  ds_read_b64_tr_b16 v[230:231], v12 offset:10872
  ds_read_b64_tr_b16 v[232:233], v14 offset:32
  ds_read_b64_tr_b16 v[234:235], v14 offset:10784
  s_and_b32 s6, s57, 1
  s_lshl_b32 s6, s6, 2
  s_add_u32 s6, s6, s3
  s_mul_i32 s6, s6, 327680
  s_lshl_b32 s7, s56, 12
  s_add_u32 s6, s6, s7
  s_add_u32 s6, s6, 65536
  s_lshr_b32 s7, s57, 1
  s_mul_i32 s24, s7, 81920
  s_add_u32 s24, s24, s6
  s_lshl_b32 s7, s7, 10
  s_add_u32 s6, s6, s7
  s_waitcnt lgkmcnt(8)
  buffer_store_dwordx4 v[216:219], v1, s[12:15], s6 offen sc1
  s_add_u32 s6, s6, 81920
  s_waitcnt lgkmcnt(6)
  buffer_store_dwordx4 v[220:223], v1, s[12:15], s6 offen sc1
  s_add_u32 s6, s6, 81920
  s_waitcnt lgkmcnt(4)
  buffer_store_dwordx4 v[224:227], v1, s[12:15], s6 offen sc1
  s_add_u32 s6, s6, 81920
  s_waitcnt lgkmcnt(2)
  buffer_store_dwordx4 v[228:231], v1, s[12:15], s6 offen sc1
  s_waitcnt lgkmcnt(0)
  buffer_store_dwordx4 v[232:235], v1, s[12:15], s24 offen offset:3072 sc1
  s_branch PA_END
PA_M:
  v_bfe_u32 v13, v2, 3, 2
  v_xor_b32 v13, s3, v13
  v_lshrrev_b32 v12, 2, v2
  v_lshlrev_b32 v12, 7, v12
  v_lshl_add_u32 v12, v13, 5, v12
  v_and_b32 v13, 3, v2
  v_lshl_add_u32 v12, v13, 3, v12
  s_mul_i32 s6, s55, 320
  s_add_u32 s6, s6, 158720
  v_lshl_add_u32 v13, v3, 3, s6
  ds_read_b64_tr_b16 a[0:1], v12 offset:0
  ds_read_b64_tr_b16 a[2:3], v12 offset:2048
  ds_read_b64 a[20:21], v13 offset:0
  ds_read_b64 a[22:23], v13 offset:32
  ds_read_b64_tr_b16 a[4:5], v12 offset:4096
  ds_read_b64_tr_b16 a[6:7], v12 offset:6144
  ds_read_b64 a[24:25], v13 offset:64
  ds_read_b64 a[26:27], v13 offset:96
  ds_read_b64_tr_b16 a[8:9], v12 offset:8192
  ds_read_b64_tr_b16 a[10:11], v12 offset:10240
  ds_read_b64 a[28:29], v13 offset:128
  ds_read_b64 a[30:31], v13 offset:160
  ds_read_b64_tr_b16 a[12:13], v12 offset:12288
  ds_read_b64_tr_b16 a[14:15], v12 offset:14336
  ds_read_b64 a[32:33], v13 offset:192
  ds_read_b64 a[34:35], v13 offset:224
  ds_read_b64_tr_b16 a[16:17], v12 offset:16384
  ds_read_b64_tr_b16 a[18:19], v12 offset:18432
  ds_read_b64 a[36:37], v13 offset:256
  ds_read_b64 a[38:39], v13 offset:288
  v_lshlrev_b32 v12, 6, v3
  v_cmp_eq_u32 vcc, 0, v5
  s_nop 1
  v_cndmask_b32 v13, v11, v12, vcc
  s_lshl_b32 s6, s54, 10
  s_lshl_b32 s7, s55, 4
  s_add_u32 s6, s6, s7
  s_lshl_b32 s7, s3, 8
  s_add_u32 s6, s6, s7
  s_add_u32 s6, s6, 21823488
  v_mov_b32 v12, s94
  s_cmp_lt_u32 s2, 80
  s_waitcnt lgkmcnt(15)
  v_mfma_f32_16x16x32_bf16 v[252:255], a[0:3], a[20:23], 0
  s_waitcnt lgkmcnt(12)
  v_mfma_f32_16x16x32_bf16 v[252:255], a[4:7], a[24:27], v[252:255]
  s_waitcnt lgkmcnt(8)
  v_mfma_f32_16x16x32_bf16 v[252:255], a[8:11], a[28:31], v[252:255]
  s_waitcnt lgkmcnt(4)
  v_mfma_f32_16x16x32_bf16 v[252:255], a[12:15], a[32:35], v[252:255]
  s_waitcnt lgkmcnt(0)
  v_mfma_f32_16x16x32_bf16 v[252:255], a[16:19], a[36:39], v[252:255]
  s_mov_b32 s7, 0x07060504
  s_cmov_b32 s7, 0x07060500
  s_nop 5
  v_perm_b32 v252, v252, v12, s7
  s_mov_b32 s7, 0x07060504
  s_cmov_b32 s7, 0x07060501
  v_perm_b32 v253, v253, v12, s7
  s_mov_b32 s7, 0x07060504
  s_cmov_b32 s7, 0x07060502
  v_perm_b32 v254, v254, v12, s7
  s_mov_b32 s7, 0x07060504
  s_cmov_b32 s7, 0x07060503
  v_perm_b32 v255, v255, v12, s7
  buffer_store_dwordx4 v[252:255], v13, s[12:15], s6 offen sc1
  buffer_store_dword v11, v11, s[12:15], 0 offen
  buffer_store_dword v11, v11, s[12:15], 0 offen
  buffer_store_dword v11, v11, s[12:15], 0 offen
  buffer_store_dword v11, v11, s[12:15], 0 offen
PA_END:
  s_nop 4
  buffer_load_dwordx4 v[168:171], v7, s[8:11], 0 offen offset:768
  buffer_load_dwordx4 v[172:175], v7, s[8:11], 0 offen offset:1024
  buffer_load_dwordx4 v[176:179], v8, s[8:11], 0 offen offset:0
  buffer_load_dwordx4 v[180:183], v8, s[8:11], 0 offen offset:256
  buffer_load_dwordx4 v[184:187], v8, s[8:11], 0 offen offset:512
  buffer_load_dwordx4 v[188:191], v8, s[8:11], 0 offen offset:768
  buffer_load_dwordx4 v[192:195], v8, s[8:11], 0 offen offset:1024
  buffer_load_dwordx4 v[196:199], v9, s[8:11], 0 offen offset:0
  buffer_load_dwordx4 v[200:203], v9, s[8:11], 0 offen offset:256
  buffer_load_dwordx4 v[204:207], v9, s[8:11], 0 offen offset:512
  buffer_load_dwordx4 v[208:211], v9, s[8:11], 0 offen offset:768
  buffer_load_dwordx4 v[212:215], v9, s[8:11], 0 offen offset:1024
  v_mov_b32 v4, v244
  v_mov_b32 v6, v245
  v_mov_b32 v7, v246
  v_mov_b32 v8, v247
  v_mov_b32 v9, v248
  v_mov_b32 v14, 0
  v_mov_b32 v15, 0
  s_waitcnt vmcnt(30)
  v_dot2_f32_bf16 v14, v116, s100, v14
  v_dot2c_f32_bf16 v15, v116, v116
  v_dot2_f32_bf16 v14, v117, s100, v14
  v_dot2c_f32_bf16 v15, v117, v117
  v_dot2_f32_bf16 v14, v118, s100, v14
  v_dot2c_f32_bf16 v15, v118, v118
  v_dot2_f32_bf16 v14, v119, s100, v14
  v_dot2c_f32_bf16 v15, v119, v119
  s_waitcnt vmcnt(29)
  v_dot2_f32_bf16 v14, v120, s100, v14
  v_dot2c_f32_bf16 v15, v120, v120
  v_dot2_f32_bf16 v14, v121, s100, v14
  v_dot2c_f32_bf16 v15, v121, v121
  v_dot2_f32_bf16 v14, v122, s100, v14
  v_dot2c_f32_bf16 v15, v122, v122
  v_dot2_f32_bf16 v14, v123, s100, v14
  v_dot2c_f32_bf16 v15, v123, v123
  s_waitcnt vmcnt(28)
  v_dot2_f32_bf16 v14, v124, s100, v14
  v_dot2c_f32_bf16 v15, v124, v124
  v_dot2_f32_bf16 v14, v125, s100, v14
  v_dot2c_f32_bf16 v15, v125, v125
  v_dot2_f32_bf16 v14, v126, s100, v14
  v_dot2c_f32_bf16 v15, v126, v126
  v_dot2_f32_bf16 v14, v127, s100, v14
  v_dot2c_f32_bf16 v15, v127, v127
  s_waitcnt vmcnt(27)
  v_dot2_f32_bf16 v14, v128, s100, v14
  v_dot2c_f32_bf16 v15, v128, v128
  v_dot2_f32_bf16 v14, v129, s100, v14
  v_dot2c_f32_bf16 v15, v129, v129
  v_dot2_f32_bf16 v14, v130, s100, v14
  v_dot2c_f32_bf16 v15, v130, v130
  v_dot2_f32_bf16 v14, v131, s100, v14
  v_dot2c_f32_bf16 v15, v131, v131
  s_waitcnt vmcnt(26)
  v_dot2_f32_bf16 v14, v132, s100, v14
  v_dot2c_f32_bf16 v15, v132, v132
  v_dot2_f32_bf16 v14, v133, s100, v14
  v_dot2c_f32_bf16 v15, v133, v133
  v_dot2_f32_bf16 v14, v134, s100, v14
  v_dot2c_f32_bf16 v15, v134, v134
  v_dot2_f32_bf16 v14, v135, s100, v14
  v_dot2c_f32_bf16 v15, v135, v135
  s_nop 1
  v_add_f32_dpp v14, v14, v14 row_ror:8 row_mask:0xf bank_mask:0xf
  v_add_f32_dpp v15, v15, v15 row_ror:8 row_mask:0xf bank_mask:0xf
  v_lshlrev_b32 v16, 16, v116
  v_and_b32 v17, 0xffff0000, v116
  v_lshlrev_b32 v18, 16, v117
  v_and_b32 v19, 0xffff0000, v117
  v_lshlrev_b32 v20, 16, v118
  v_and_b32 v21, 0xffff0000, v118
  v_lshlrev_b32 v22, 16, v119
  v_and_b32 v23, 0xffff0000, v119
  v_lshlrev_b32 v24, 16, v120
  v_and_b32 v25, 0xffff0000, v120
  v_add_f32_dpp v14, v14, v14 row_ror:4 row_mask:0xf bank_mask:0xf
  v_add_f32_dpp v15, v15, v15 row_ror:4 row_mask:0xf bank_mask:0xf
  v_lshlrev_b32 v26, 16, v121
  v_and_b32 v27, 0xffff0000, v121
  v_lshlrev_b32 v28, 16, v122
  v_and_b32 v29, 0xffff0000, v122
  v_lshlrev_b32 v30, 16, v123
  v_and_b32 v31, 0xffff0000, v123
  v_lshlrev_b32 v32, 16, v124
  v_and_b32 v33, 0xffff0000, v124
  v_lshlrev_b32 v34, 16, v125
  v_and_b32 v35, 0xffff0000, v125
  v_add_f32_dpp v14, v14, v14 row_ror:2 row_mask:0xf bank_mask:0xf
  v_add_f32_dpp v15, v15, v15 row_ror:2 row_mask:0xf bank_mask:0xf
  v_lshlrev_b32 v36, 16, v126
  v_and_b32 v37, 0xffff0000, v126
  v_lshlrev_b32 v38, 16, v127
  v_and_b32 v39, 0xffff0000, v127
  v_lshlrev_b32 v40, 16, v128
  v_and_b32 v41, 0xffff0000, v128
  v_lshlrev_b32 v42, 16, v129
  v_and_b32 v43, 0xffff0000, v129
  v_lshlrev_b32 v44, 16, v130
  v_and_b32 v45, 0xffff0000, v130
  v_add_f32_dpp v14, v14, v14 row_ror:1 row_mask:0xf bank_mask:0xf
  v_add_f32_dpp v15, v15, v15 row_ror:1 row_mask:0xf bank_mask:0xf
  v_lshlrev_b32 v46, 16, v131
  v_and_b32 v47, 0xffff0000, v131
  v_lshlrev_b32 v48, 16, v132
  v_and_b32 v49, 0xffff0000, v132
  v_lshlrev_b32 v50, 16, v133
  v_and_b32 v51, 0xffff0000, v133
  v_lshlrev_b32 v52, 16, v134
  v_and_b32 v53, 0xffff0000, v134
  v_lshlrev_b32 v54, 16, v135
  v_and_b32 v55, 0xffff0000, v135
  v_mul_f32 v14, 0x3acccccd, v14
  v_mul_f32 v15, 0x3acccccd, v15
  v_fma_f32 v15, -v14, v14, v15
  v_max_f32 v15, 0, v15
  v_add_f32 v15, 0x3727c5ac, v15
  v_rsq_f32 v13, v15
  s_nop 0
  v_mul_f32_e64 v15, -v14, v13
  v_mov_b32 v14, v13
  v_pk_fma_f32 v[16:17], v[16:17], v[14:15], v[14:15] op_sel:[0,0,1] op_sel_hi:[1,0,1]
  v_pk_fma_f32 v[18:19], v[18:19], v[14:15], v[14:15] op_sel:[0,0,1] op_sel_hi:[1,0,1]
  v_pk_fma_f32 v[20:21], v[20:21], v[14:15], v[14:15] op_sel:[0,0,1] op_sel_hi:[1,0,1]
  v_pk_fma_f32 v[22:23], v[22:23], v[14:15], v[14:15] op_sel:[0,0,1] op_sel_hi:[1,0,1]
  v_pk_fma_f32 v[24:25], v[24:25], v[14:15], v[14:15] op_sel:[0,0,1] op_sel_hi:[1,0,1]
  v_pk_fma_f32 v[26:27], v[26:27], v[14:15], v[14:15] op_sel:[0,0,1] op_sel_hi:[1,0,1]
  v_pk_fma_f32 v[28:29], v[28:29], v[14:15], v[14:15] op_sel:[0,0,1] op_sel_hi:[1,0,1]
  v_pk_fma_f32 v[30:31], v[30:31], v[14:15], v[14:15] op_sel:[0,0,1] op_sel_hi:[1,0,1]
  v_pk_fma_f32 v[32:33], v[32:33], v[14:15], v[14:15] op_sel:[0,0,1] op_sel_hi:[1,0,1]
  v_pk_fma_f32 v[34:35], v[34:35], v[14:15], v[14:15] op_sel:[0,0,1] op_sel_hi:[1,0,1]
  v_pk_fma_f32 v[36:37], v[36:37], v[14:15], v[14:15] op_sel:[0,0,1] op_sel_hi:[1,0,1]
  v_pk_fma_f32 v[38:39], v[38:39], v[14:15], v[14:15] op_sel:[0,0,1] op_sel_hi:[1,0,1]
  v_pk_fma_f32 v[40:41], v[40:41], v[14:15], v[14:15] op_sel:[0,0,1] op_sel_hi:[1,0,1]
  v_pk_fma_f32 v[42:43], v[42:43], v[14:15], v[14:15] op_sel:[0,0,1] op_sel_hi:[1,0,1]
  v_pk_fma_f32 v[44:45], v[44:45], v[14:15], v[14:15] op_sel:[0,0,1] op_sel_hi:[1,0,1]
  v_pk_fma_f32 v[46:47], v[46:47], v[14:15], v[14:15] op_sel:[0,0,1] op_sel_hi:[1,0,1]
  v_pk_fma_f32 v[48:49], v[48:49], v[14:15], v[14:15] op_sel:[0,0,1] op_sel_hi:[1,0,1]
  v_pk_fma_f32 v[50:51], v[50:51], v[14:15], v[14:15] op_sel:[0,0,1] op_sel_hi:[1,0,1]
  v_pk_fma_f32 v[52:53], v[52:53], v[14:15], v[14:15] op_sel:[0,0,1] op_sel_hi:[1,0,1]
  v_pk_fma_f32 v[54:55], v[54:55], v[14:15], v[14:15] op_sel:[0,0,1] op_sel_hi:[1,0,1]
  s_sub_u32 s6, s2, 80
  s_and_b32 s7, s6, 1
  s_lshl_b32 s7, s7, 8
  s_lshr_b32 s6, s6, 1
  s_lshl_b32 s6, s6, 2
  s_add_u32 s6, s6, s7
  s_add_u32 s6, s6, 32768
  s_cmp_eq_u32 s95, 1
  s_cselect_b32 s6, s6, s14
  v_mov_b32 v12, s94
  s_waitcnt vmcnt(12)
  s_barrier
  buffer_store_dword v12, v10, s[12:15], s6 offen sc1
  s_mov_b32 m0, s31
  s_mov_b32 exec_hi, s35
  buffer_load_dwordx4 v249, s[96:99], s28 offen nt lds
  s_mov_b64 exec, -1
  s_add_u32 s28, s28, s29
  s_add_u32 s31, s31, 736
  s_mov_b32 m0, s31
  s_mov_b32 exec_hi, s35
  buffer_load_dwordx4 v249, s[96:99], s28 offen nt lds
  s_mov_b64 exec, -1
  s_add_u32 s28, s28, s29
  s_add_u32 s31, s31, 736
  s_mov_b32 m0, s31
  s_mov_b32 exec_hi, s35
  buffer_load_dwordx4 v249, s[96:99], s28 offen nt lds
  s_mov_b64 exec, -1
  s_add_u32 s28, s28, s29
  s_add_u32 s31, s31, 736
  s_mov_b32 m0, s31
  s_mov_b32 exec_hi, s35
  buffer_load_dwordx4 v249, s[96:99], s28 offen nt lds
  s_mov_b64 exec, -1
  s_add_u32 s28, s28, s30
  s_add_u32 s31, s31, 736
  s_mov_b32 m0, s31
  s_mov_b32 exec_hi, s35
  buffer_load_dwordx4 v249, s[96:99], s28 offen nt lds
  s_mov_b64 exec, -1
  s_add_u32 s28, s28, s29
  s_add_u32 s31, s31, 736
  s_mov_b32 m0, s31
  s_mov_b32 exec_hi, s35
  buffer_load_dwordx4 v249, s[96:99], s28 offen nt lds
  s_mov_b64 exec, -1
  s_add_u32 s28, s28, s29
  s_add_u32 s31, s31, 736
  s_mov_b32 m0, s31
  s_mov_b32 exec_hi, s35
  buffer_load_dwordx4 v249, s[96:99], s28 offen nt lds
  s_mov_b64 exec, -1
  s_add_u32 s28, s28, s29
  s_add_u32 s31, s31, 736
  s_mov_b32 m0, s31
  s_mov_b32 exec_hi, s35
  buffer_load_dwordx4 v249, s[96:99], s28 offen nt lds
  s_mov_b64 exec, -1
  v_mov_b32 v14, 0
  v_mov_b32 v15, 0
  v_dot2_f32_bf16 v14, v136, s100, v14
  v_dot2c_f32_bf16 v15, v136, v136
  v_dot2_f32_bf16 v14, v137, s100, v14
  v_dot2c_f32_bf16 v15, v137, v137
  v_dot2_f32_bf16 v14, v138, s100, v14
  v_dot2c_f32_bf16 v15, v138, v138
  v_dot2_f32_bf16 v14, v139, s100, v14
  v_dot2c_f32_bf16 v15, v139, v139
  v_dot2_f32_bf16 v14, v140, s100, v14
  v_dot2c_f32_bf16 v15, v140, v140
  v_dot2_f32_bf16 v14, v141, s100, v14
  v_dot2c_f32_bf16 v15, v141, v141
  v_dot2_f32_bf16 v14, v142, s100, v14
  v_dot2c_f32_bf16 v15, v142, v142
  v_dot2_f32_bf16 v14, v143, s100, v14
  v_dot2c_f32_bf16 v15, v143, v143
  v_dot2_f32_bf16 v14, v144, s100, v14
  v_dot2c_f32_bf16 v15, v144, v144
  v_dot2_f32_bf16 v14, v145, s100, v14
  v_dot2c_f32_bf16 v15, v145, v145
  v_dot2_f32_bf16 v14, v146, s100, v14
  v_dot2c_f32_bf16 v15, v146, v146
  v_dot2_f32_bf16 v14, v147, s100, v14
  v_dot2c_f32_bf16 v15, v147, v147
  v_dot2_f32_bf16 v14, v148, s100, v14
  v_dot2c_f32_bf16 v15, v148, v148
  v_dot2_f32_bf16 v14, v149, s100, v14
  v_dot2c_f32_bf16 v15, v149, v149
  v_dot2_f32_bf16 v14, v150, s100, v14
  v_dot2c_f32_bf16 v15, v150, v150
  v_dot2_f32_bf16 v14, v151, s100, v14
  v_dot2c_f32_bf16 v15, v151, v151
  v_dot2_f32_bf16 v14, v152, s100, v14
  v_dot2c_f32_bf16 v15, v152, v152
  v_dot2_f32_bf16 v14, v153, s100, v14
  v_dot2c_f32_bf16 v15, v153, v153
  v_dot2_f32_bf16 v14, v154, s100, v14
  v_dot2c_f32_bf16 v15, v154, v154
  v_dot2_f32_bf16 v14, v155, s100, v14
  v_dot2c_f32_bf16 v15, v155, v155
  s_nop 1
  v_add_f32_dpp v14, v14, v14 row_ror:8 row_mask:0xf bank_mask:0xf
  v_add_f32_dpp v15, v15, v15 row_ror:8 row_mask:0xf bank_mask:0xf
  v_lshlrev_b32 v56, 16, v136
  v_and_b32 v57, 0xffff0000, v136
  v_lshlrev_b32 v58, 16, v137
  v_and_b32 v59, 0xffff0000, v137
  v_lshlrev_b32 v60, 16, v138
  v_and_b32 v61, 0xffff0000, v138
  v_lshlrev_b32 v62, 16, v139
  v_and_b32 v63, 0xffff0000, v139
  v_lshlrev_b32 v64, 16, v140
  v_and_b32 v65, 0xffff0000, v140
  v_add_f32_dpp v14, v14, v14 row_ror:4 row_mask:0xf bank_mask:0xf
  v_add_f32_dpp v15, v15, v15 row_ror:4 row_mask:0xf bank_mask:0xf
  v_lshlrev_b32 v66, 16, v141
  v_and_b32 v67, 0xffff0000, v141
  v_mov_b32 v236, 0
  v_mov_b32 v237, 0
  v_mov_b32 v238, 0
  v_mov_b32 v239, 0
  s_and_b32 s6, s5, 3
  s_lshl_b32 s7, s4, 2
  s_add_u32 s6, s6, s7
  s_mul_i32 s6, s6, 20480
  s_lshl_b32 s7, s3, 10
  s_add_u32 s6, s6, s7
  s_lshr_b32 s7, s5, 2
  s_mul_i32 s7, s7, 2621440
  s_add_u32 s6, s6, s7
  s_add_u32 s6, s6, 7946240
  buffer_store_dwordx4 v[236:239], v1, s[12:15], s6 offen sc1
  v_lshlrev_b32 v68, 16, v142
  v_and_b32 v69, 0xffff0000, v142
  v_lshlrev_b32 v70, 16, v143
  v_and_b32 v71, 0xffff0000, v143
  v_lshlrev_b32 v72, 16, v144
  v_and_b32 v73, 0xffff0000, v144
  v_lshlrev_b32 v74, 16, v145
  v_and_b32 v75, 0xffff0000, v145
  v_add_f32_dpp v14, v14, v14 row_ror:2 row_mask:0xf bank_mask:0xf
  v_add_f32_dpp v15, v15, v15 row_ror:2 row_mask:0xf bank_mask:0xf
  v_lshlrev_b32 v76, 16, v146
  v_and_b32 v77, 0xffff0000, v146
  v_lshlrev_b32 v78, 16, v147
  v_and_b32 v79, 0xffff0000, v147
  v_lshlrev_b32 v80, 16, v148
  v_and_b32 v81, 0xffff0000, v148
  v_lshlrev_b32 v82, 16, v149
  v_and_b32 v83, 0xffff0000, v149
  v_lshlrev_b32 v84, 16, v150
  v_and_b32 v85, 0xffff0000, v150
  v_add_f32_dpp v14, v14, v14 row_ror:1 row_mask:0xf bank_mask:0xf
  v_add_f32_dpp v15, v15, v15 row_ror:1 row_mask:0xf bank_mask:0xf
  v_lshlrev_b32 v86, 16, v151
  v_and_b32 v87, 0xffff0000, v151
  v_lshlrev_b32 v88, 16, v152
  v_and_b32 v89, 0xffff0000, v152
  v_lshlrev_b32 v90, 16, v153
  v_and_b32 v91, 0xffff0000, v153
  v_lshlrev_b32 v92, 16, v154
  v_and_b32 v93, 0xffff0000, v154
  v_lshlrev_b32 v94, 16, v155
  v_and_b32 v95, 0xffff0000, v155
  v_mul_f32 v14, 0x3acccccd, v14
  v_mul_f32 v15, 0x3acccccd, v15
  v_fma_f32 v15, -v14, v14, v15
  v_max_f32 v15, 0, v15
  v_add_f32 v15, 0x3727c5ac, v15
  v_rsq_f32 v13, v15
  s_nop 0
  v_mul_f32_e64 v15, -v14, v13
  v_mov_b32 v14, v13
  v_pk_fma_f32 v[56:57], v[56:57], v[14:15], v[14:15] op_sel:[0,0,1] op_sel_hi:[1,0,1]
  v_pk_fma_f32 v[58:59], v[58:59], v[14:15], v[14:15] op_sel:[0,0,1] op_sel_hi:[1,0,1]
  v_pk_fma_f32 v[60:61], v[60:61], v[14:15], v[14:15] op_sel:[0,0,1] op_sel_hi:[1,0,1]
  v_pk_fma_f32 v[62:63], v[62:63], v[14:15], v[14:15] op_sel:[0,0,1] op_sel_hi:[1,0,1]
  v_pk_fma_f32 v[64:65], v[64:65], v[14:15], v[14:15] op_sel:[0,0,1] op_sel_hi:[1,0,1]
  v_pk_fma_f32 v[66:67], v[66:67], v[14:15], v[14:15] op_sel:[0,0,1] op_sel_hi:[1,0,1]
  v_pk_fma_f32 v[68:69], v[68:69], v[14:15], v[14:15] op_sel:[0,0,1] op_sel_hi:[1,0,1]
  v_pk_fma_f32 v[70:71], v[70:71], v[14:15], v[14:15] op_sel:[0,0,1] op_sel_hi:[1,0,1]
  v_pk_fma_f32 v[72:73], v[72:73], v[14:15], v[14:15] op_sel:[0,0,1] op_sel_hi:[1,0,1]
  v_pk_fma_f32 v[74:75], v[74:75], v[14:15], v[14:15] op_sel:[0,0,1] op_sel_hi:[1,0,1]
  v_pk_fma_f32 v[76:77], v[76:77], v[14:15], v[14:15] op_sel:[0,0,1] op_sel_hi:[1,0,1]
  v_pk_fma_f32 v[78:79], v[78:79], v[14:15], v[14:15] op_sel:[0,0,1] op_sel_hi:[1,0,1]
  v_pk_fma_f32 v[80:81], v[80:81], v[14:15], v[14:15] op_sel:[0,0,1] op_sel_hi:[1,0,1]
  v_pk_fma_f32 v[82:83], v[82:83], v[14:15], v[14:15] op_sel:[0,0,1] op_sel_hi:[1,0,1]
  v_pk_fma_f32 v[84:85], v[84:85], v[14:15], v[14:15] op_sel:[0,0,1] op_sel_hi:[1,0,1]
  v_pk_fma_f32 v[86:87], v[86:87], v[14:15], v[14:15] op_sel:[0,0,1] op_sel_hi:[1,0,1]
  v_pk_fma_f32 v[88:89], v[88:89], v[14:15], v[14:15] op_sel:[0,0,1] op_sel_hi:[1,0,1]
  v_pk_fma_f32 v[90:91], v[90:91], v[14:15], v[14:15] op_sel:[0,0,1] op_sel_hi:[1,0,1]
  v_lshrrev_b32 v240, 3, v2
  v_lshlrev_b32 v240, 12, v240
  v_and_b32 v241, 7, v2
  v_lshl_add_u32 v240, v241, 4, v240
  s_lshl_b32 s6, s4, 7
  s_add_u32 s6, s6, 24629248
  s_or_b32 s7, s5, s3
  s_cmp_eq_u32 s7, 0
  s_cselect_b32 s6, s6, s14
  buffer_store_dwordx4 v[236:239], v240, s[12:15], s6 offen sc1
  v_pk_fma_f32 v[92:93], v[92:93], v[14:15], v[14:15] op_sel:[0,0,1] op_sel_hi:[1,0,1]
  v_pk_fma_f32 v[94:95], v[94:95], v[14:15], v[14:15] op_sel:[0,0,1] op_sel_hi:[1,0,1]
  v_mov_b32 v14, 0
  v_mov_b32 v15, 0
  v_dot2_f32_bf16 v14, v156, s100, v14
  v_dot2c_f32_bf16 v15, v156, v156
  v_dot2_f32_bf16 v14, v157, s100, v14
  v_dot2c_f32_bf16 v15, v157, v157
  v_dot2_f32_bf16 v14, v158, s100, v14
  v_dot2c_f32_bf16 v15, v158, v158
  v_dot2_f32_bf16 v14, v159, s100, v14
  v_dot2c_f32_bf16 v15, v159, v159
  v_dot2_f32_bf16 v14, v160, s100, v14
  v_dot2c_f32_bf16 v15, v160, v160
  v_dot2_f32_bf16 v14, v161, s100, v14
  v_dot2c_f32_bf16 v15, v161, v161
  v_dot2_f32_bf16 v14, v162, s100, v14
  v_dot2c_f32_bf16 v15, v162, v162
  v_dot2_f32_bf16 v14, v163, s100, v14
  v_dot2c_f32_bf16 v15, v163, v163
  v_dot2_f32_bf16 v14, v164, s100, v14
  v_dot2c_f32_bf16 v15, v164, v164
  v_dot2_f32_bf16 v14, v165, s100, v14
  v_dot2c_f32_bf16 v15, v165, v165
  v_dot2_f32_bf16 v14, v166, s100, v14
  v_dot2c_f32_bf16 v15, v166, v166
  v_dot2_f32_bf16 v14, v167, s100, v14
  v_dot2c_f32_bf16 v15, v167, v167
  s_waitcnt vmcnt(22)
  v_dot2_f32_bf16 v14, v168, s100, v14
  v_dot2c_f32_bf16 v15, v168, v168
  v_dot2_f32_bf16 v14, v169, s100, v14
  v_dot2c_f32_bf16 v15, v169, v169
  v_dot2_f32_bf16 v14, v170, s100, v14
  v_dot2c_f32_bf16 v15, v170, v170
  v_dot2_f32_bf16 v14, v171, s100, v14
  v_dot2c_f32_bf16 v15, v171, v171
  s_waitcnt vmcnt(21)
  v_dot2_f32_bf16 v14, v172, s100, v14
  v_dot2c_f32_bf16 v15, v172, v172
  v_dot2_f32_bf16 v14, v173, s100, v14
  v_dot2c_f32_bf16 v15, v173, v173
  v_dot2_f32_bf16 v14, v174, s100, v14
  v_dot2c_f32_bf16 v15, v174, v174
  v_dot2_f32_bf16 v14, v175, s100, v14
  v_dot2c_f32_bf16 v15, v175, v175
  s_nop 1
  v_add_f32_dpp v14, v14, v14 row_ror:8 row_mask:0xf bank_mask:0xf
  v_add_f32_dpp v15, v15, v15 row_ror:8 row_mask:0xf bank_mask:0xf
  v_lshlrev_b32 v96, 16, v156
  v_and_b32 v97, 0xffff0000, v156
  v_lshlrev_b32 v98, 16, v157
  v_and_b32 v99, 0xffff0000, v157
  v_lshlrev_b32 v100, 16, v158
  v_and_b32 v101, 0xffff0000, v158
  v_lshlrev_b32 v102, 16, v159
  v_and_b32 v103, 0xffff0000, v159
  v_lshlrev_b32 v104, 16, v160
  v_and_b32 v105, 0xffff0000, v160
  v_add_f32_dpp v14, v14, v14 row_ror:4 row_mask:0xf bank_mask:0xf
  v_add_f32_dpp v15, v15, v15 row_ror:4 row_mask:0xf bank_mask:0xf
  v_lshlrev_b32 v106, 16, v161
  v_and_b32 v107, 0xffff0000, v161
  v_lshlrev_b32 v108, 16, v162
  v_and_b32 v109, 0xffff0000, v162
  v_lshlrev_b32 v110, 16, v163
  v_and_b32 v111, 0xffff0000, v163
  v_lshlrev_b32 v112, 16, v164
  v_and_b32 v113, 0xffff0000, v164
  v_lshlrev_b32 v114, 16, v165
  v_and_b32 v115, 0xffff0000, v165
  v_add_f32_dpp v14, v14, v14 row_ror:2 row_mask:0xf bank_mask:0xf
  v_add_f32_dpp v15, v15, v15 row_ror:2 row_mask:0xf bank_mask:0xf
  v_lshlrev_b32 v116, 16, v166
  v_and_b32 v117, 0xffff0000, v166
  v_lshlrev_b32 v118, 16, v167
  v_and_b32 v119, 0xffff0000, v167
  v_lshlrev_b32 v120, 16, v168
  v_and_b32 v121, 0xffff0000, v168
  v_lshlrev_b32 v122, 16, v169
  v_and_b32 v123, 0xffff0000, v169
  v_lshlrev_b32 v124, 16, v170
  v_and_b32 v125, 0xffff0000, v170
  v_add_f32_dpp v14, v14, v14 row_ror:1 row_mask:0xf bank_mask:0xf
  v_add_f32_dpp v15, v15, v15 row_ror:1 row_mask:0xf bank_mask:0xf
  v_lshlrev_b32 v126, 16, v171
  v_and_b32 v127, 0xffff0000, v171
  v_lshlrev_b32 v128, 16, v172
  v_and_b32 v129, 0xffff0000, v172
  v_lshlrev_b32 v130, 16, v173
  v_and_b32 v131, 0xffff0000, v173
  v_lshlrev_b32 v132, 16, v174
  v_and_b32 v133, 0xffff0000, v174
  v_lshlrev_b32 v134, 16, v175
  v_and_b32 v135, 0xffff0000, v175
  v_mul_f32 v14, 0x3acccccd, v14
  v_mul_f32 v15, 0x3acccccd, v15
  v_fma_f32 v15, -v14, v14, v15
  v_max_f32 v15, 0, v15
  v_add_f32 v15, 0x3727c5ac, v15
  v_rsq_f32 v13, v15
  s_nop 0
  v_mul_f32_e64 v15, -v14, v13
  v_mov_b32 v14, v13
  v_pk_fma_f32 v[96:97], v[96:97], v[14:15], v[14:15] op_sel:[0,0,1] op_sel_hi:[1,0,1]
  v_pk_fma_f32 v[98:99], v[98:99], v[14:15], v[14:15] op_sel:[0,0,1] op_sel_hi:[1,0,1]
  v_pk_fma_f32 v[100:101], v[100:101], v[14:15], v[14:15] op_sel:[0,0,1] op_sel_hi:[1,0,1]
  v_pk_fma_f32 v[102:103], v[102:103], v[14:15], v[14:15] op_sel:[0,0,1] op_sel_hi:[1,0,1]
  v_pk_fma_f32 v[104:105], v[104:105], v[14:15], v[14:15] op_sel:[0,0,1] op_sel_hi:[1,0,1]
  v_pk_fma_f32 v[106:107], v[106:107], v[14:15], v[14:15] op_sel:[0,0,1] op_sel_hi:[1,0,1]
  v_pk_fma_f32 v[108:109], v[108:109], v[14:15], v[14:15] op_sel:[0,0,1] op_sel_hi:[1,0,1]
  v_pk_fma_f32 v[110:111], v[110:111], v[14:15], v[14:15] op_sel:[0,0,1] op_sel_hi:[1,0,1]
  v_pk_fma_f32 v[112:113], v[112:113], v[14:15], v[14:15] op_sel:[0,0,1] op_sel_hi:[1,0,1]
  v_pk_fma_f32 v[114:115], v[114:115], v[14:15], v[14:15] op_sel:[0,0,1] op_sel_hi:[1,0,1]
  v_pk_fma_f32 v[116:117], v[116:117], v[14:15], v[14:15] op_sel:[0,0,1] op_sel_hi:[1,0,1]
  v_pk_fma_f32 v[118:119], v[118:119], v[14:15], v[14:15] op_sel:[0,0,1] op_sel_hi:[1,0,1]
  v_pk_fma_f32 v[120:121], v[120:121], v[14:15], v[14:15] op_sel:[0,0,1] op_sel_hi:[1,0,1]
  v_pk_fma_f32 v[122:123], v[122:123], v[14:15], v[14:15] op_sel:[0,0,1] op_sel_hi:[1,0,1]
  v_pk_fma_f32 v[124:125], v[124:125], v[14:15], v[14:15] op_sel:[0,0,1] op_sel_hi:[1,0,1]
  v_pk_fma_f32 v[126:127], v[126:127], v[14:15], v[14:15] op_sel:[0,0,1] op_sel_hi:[1,0,1]
  v_pk_fma_f32 v[128:129], v[128:129], v[14:15], v[14:15] op_sel:[0,0,1] op_sel_hi:[1,0,1]
  v_pk_fma_f32 v[130:131], v[130:131], v[14:15], v[14:15] op_sel:[0,0,1] op_sel_hi:[1,0,1]
  v_pk_fma_f32 v[132:133], v[132:133], v[14:15], v[14:15] op_sel:[0,0,1] op_sel_hi:[1,0,1]
  v_pk_fma_f32 v[134:135], v[134:135], v[14:15], v[14:15] op_sel:[0,0,1] op_sel_hi:[1,0,1]
  s_mul_i32 s6, s3, 5120
  s_add_u32 m0, s6, 136256
  s_nop 0
  buffer_load_dwordx4 v0, s[16:19], s50 offen nt lds
  s_add_u32 s50, s50, 61440
  s_mul_i32 s6, s3, 5120
  s_add_u32 m0, s6, 137280
  s_nop 0
  buffer_load_dwordx4 v0, s[16:19], s50 offen nt lds
  s_add_u32 s50, s50, 61440
  s_mul_i32 s6, s3, 5120
  s_add_u32 m0, s6, 138304
  s_nop 0
  buffer_load_dwordx4 v0, s[16:19], s50 offen nt lds
  s_add_u32 s50, s50, 61440
  s_mul_i32 s6, s3, 5120
  s_add_u32 m0, s6, 139328
  s_nop 0
  buffer_load_dwordx4 v0, s[16:19], s50 offen nt lds
  s_add_u32 s50, s50, 61440
  s_mul_i32 s6, s3, 5120
  s_add_u32 m0, s6, 140352
  s_nop 0
  buffer_load_dwordx4 v0, s[16:19], s50 offen nt lds
  s_add_u32 s50, s50, 61440
  s_add_u32 s6, s23, 0
  buffer_load_dwordx4 v[216:219], v1, s[12:15], s6 offen sc1
  s_add_u32 s6, s23, 4096
  buffer_load_dwordx4 v[220:223], v1, s[12:15], s6 offen sc1
  s_add_u32 s6, s23, 8192
  buffer_load_dwordx4 v[224:227], v1, s[12:15], s6 offen sc1
  s_add_u32 s6, s23, 12288
  buffer_load_dwordx4 v[228:231], v1, s[12:15], s6 offen sc1
  s_add_u32 s6, s23, 16384
  buffer_load_dwordx4 v[232:235], v1, s[12:15], s6 offen sc1
  v_min_u32 v251, 59, v2
  v_lshlrev_b32 v251, 2, v251
  buffer_load_dword v250, v251, s[12:15], s25 offen sc1
  v_mov_b32 v14, 0
  v_mov_b32 v15, 0
  s_waitcnt vmcnt(31)
  v_dot2_f32_bf16 v14, v176, s100, v14
  v_dot2c_f32_bf16 v15, v176, v176
  v_dot2_f32_bf16 v14, v177, s100, v14
  v_dot2c_f32_bf16 v15, v177, v177
  v_dot2_f32_bf16 v14, v178, s100, v14
  v_dot2c_f32_bf16 v15, v178, v178
  v_dot2_f32_bf16 v14, v179, s100, v14
  v_dot2c_f32_bf16 v15, v179, v179
  s_waitcnt vmcnt(30)
  v_dot2_f32_bf16 v14, v180, s100, v14
  v_dot2c_f32_bf16 v15, v180, v180
  v_dot2_f32_bf16 v14, v181, s100, v14
  v_dot2c_f32_bf16 v15, v181, v181
  v_dot2_f32_bf16 v14, v182, s100, v14
  v_dot2c_f32_bf16 v15, v182, v182
  v_dot2_f32_bf16 v14, v183, s100, v14
  v_dot2c_f32_bf16 v15, v183, v183
  s_waitcnt vmcnt(29)
  v_dot2_f32_bf16 v14, v184, s100, v14
  v_dot2c_f32_bf16 v15, v184, v184
  v_dot2_f32_bf16 v14, v185, s100, v14
  v_dot2c_f32_bf16 v15, v185, v185
  v_dot2_f32_bf16 v14, v186, s100, v14
  v_dot2c_f32_bf16 v15, v186, v186
  v_dot2_f32_bf16 v14, v187, s100, v14
  v_dot2c_f32_bf16 v15, v187, v187
  s_waitcnt vmcnt(28)
  v_dot2_f32_bf16 v14, v188, s100, v14
  v_dot2c_f32_bf16 v15, v188, v188
  v_dot2_f32_bf16 v14, v189, s100, v14
  s_lshl_b32 s6, s4, 1
  s_and_b32 s7, s3, 1
  s_add_u32 s6, s6, s7
  s_mul_i32 s6, s6, 40960
  s_mul_i32 s7, s5, 160
  s_add_u32 s6, s6, s7
  s_lshr_b32 s7, s3, 1
  s_lshl_b32 s57, s7, 6
  s_add_u32 s57, s57, s6
  v_mul_u32_u24 v252, 2560, v5
  v_lshl_add_u32 v253, v3, 3, v252
  v_lshl_add_u32 v252, v3, 4, v252
  s_mul_i32 s7, s7, 1879048192
  v_add_u32 v253, s7, v253
  buffer_load_dwordx4 a[240:243], v252, s[8:11], s57 offen
  v_dot2c_f32_bf16 v15, v189, v189
  v_dot2_f32_bf16 v14, v190, s100, v14
  v_dot2c_f32_bf16 v15, v190, v190
  v_dot2_f32_bf16 v14, v191, s100, v14
  v_dot2c_f32_bf16 v15, v191, v191
  s_waitcnt vmcnt(28)
  v_dot2_f32_bf16 v14, v192, s100, v14
  v_dot2c_f32_bf16 v15, v192, v192
  v_dot2_f32_bf16 v14, v193, s100, v14
  v_dot2c_f32_bf16 v15, v193, v193
  v_dot2_f32_bf16 v14, v194, s100, v14
  v_dot2c_f32_bf16 v15, v194, v194
  v_dot2_f32_bf16 v14, v195, s100, v14
  v_dot2c_f32_bf16 v15, v195, v195
  s_nop 1
  v_add_f32_dpp v14, v14, v14 row_ror:8 row_mask:0xf bank_mask:0xf
  v_add_f32_dpp v15, v15, v15 row_ror:8 row_mask:0xf bank_mask:0xf
  v_lshlrev_b32 v136, 16, v176
  v_and_b32 v137, 0xffff0000, v176
  v_lshlrev_b32 v138, 16, v177
  v_and_b32 v139, 0xffff0000, v177
  v_lshlrev_b32 v140, 16, v178
  v_and_b32 v141, 0xffff0000, v178
  v_lshlrev_b32 v142, 16, v179
  v_and_b32 v143, 0xffff0000, v179
  v_lshlrev_b32 v144, 16, v180
  v_and_b32 v145, 0xffff0000, v180
  v_add_f32_dpp v14, v14, v14 row_ror:4 row_mask:0xf bank_mask:0xf
  v_add_f32_dpp v15, v15, v15 row_ror:4 row_mask:0xf bank_mask:0xf
  v_lshlrev_b32 v146, 16, v181
  v_and_b32 v147, 0xffff0000, v181
  buffer_load_dwordx4 a[246:249], v252, s[8:11], s57 offen offset:1280
  v_lshlrev_b32 v148, 16, v182
  v_and_b32 v149, 0xffff0000, v182
  v_lshlrev_b32 v150, 16, v183
  v_and_b32 v151, 0xffff0000, v183
  v_lshlrev_b32 v152, 16, v184
  v_and_b32 v153, 0xffff0000, v184
  v_lshlrev_b32 v154, 16, v185
  v_and_b32 v155, 0xffff0000, v185
  v_add_f32_dpp v14, v14, v14 row_ror:2 row_mask:0xf bank_mask:0xf
  v_add_f32_dpp v15, v15, v15 row_ror:2 row_mask:0xf bank_mask:0xf
  v_lshlrev_b32 v156, 16, v186
  v_and_b32 v157, 0xffff0000, v186
  v_lshlrev_b32 v158, 16, v187
  v_and_b32 v159, 0xffff0000, v187
  v_lshlrev_b32 v160, 16, v188
  v_and_b32 v161, 0xffff0000, v188
  v_lshlrev_b32 v162, 16, v189
  v_and_b32 v163, 0xffff0000, v189
  v_lshlrev_b32 v164, 16, v190
  v_and_b32 v165, 0xffff0000, v190
  v_add_f32_dpp v14, v14, v14 row_ror:1 row_mask:0xf bank_mask:0xf
  v_add_f32_dpp v15, v15, v15 row_ror:1 row_mask:0xf bank_mask:0xf
  v_lshlrev_b32 v166, 16, v191
  v_and_b32 v167, 0xffff0000, v191
  v_lshlrev_b32 v168, 16, v192
  v_and_b32 v169, 0xffff0000, v192
  v_lshlrev_b32 v170, 16, v193
  v_and_b32 v171, 0xffff0000, v193
  v_lshlrev_b32 v172, 16, v194
  buffer_load_dwordx2 a[244:245], v253, s[8:11], s57 offen offset:128
  v_and_b32 v173, 0xffff0000, v194
  v_lshlrev_b32 v174, 16, v195
  v_and_b32 v175, 0xffff0000, v195
  v_mul_f32 v14, 0x3acccccd, v14
  v_mul_f32 v15, 0x3acccccd, v15
  v_fma_f32 v15, -v14, v14, v15
  v_max_f32 v15, 0, v15
  v_add_f32 v15, 0x3727c5ac, v15
  v_rsq_f32 v13, v15
  s_nop 0
  v_mul_f32_e64 v15, -v14, v13
  v_mov_b32 v14, v13
  v_pk_fma_f32 v[136:137], v[136:137], v[14:15], v[14:15] op_sel:[0,0,1] op_sel_hi:[1,0,1]
  v_pk_fma_f32 v[138:139], v[138:139], v[14:15], v[14:15] op_sel:[0,0,1] op_sel_hi:[1,0,1]
  v_pk_fma_f32 v[140:141], v[140:141], v[14:15], v[14:15] op_sel:[0,0,1] op_sel_hi:[1,0,1]
  v_pk_fma_f32 v[142:143], v[142:143], v[14:15], v[14:15] op_sel:[0,0,1] op_sel_hi:[1,0,1]
  v_pk_fma_f32 v[144:145], v[144:145], v[14:15], v[14:15] op_sel:[0,0,1] op_sel_hi:[1,0,1]
  v_pk_fma_f32 v[146:147], v[146:147], v[14:15], v[14:15] op_sel:[0,0,1] op_sel_hi:[1,0,1]
  v_pk_fma_f32 v[148:149], v[148:149], v[14:15], v[14:15] op_sel:[0,0,1] op_sel_hi:[1,0,1]
  v_pk_fma_f32 v[150:151], v[150:151], v[14:15], v[14:15] op_sel:[0,0,1] op_sel_hi:[1,0,1]
  v_pk_fma_f32 v[152:153], v[152:153], v[14:15], v[14:15] op_sel:[0,0,1] op_sel_hi:[1,0,1]
  v_pk_fma_f32 v[154:155], v[154:155], v[14:15], v[14:15] op_sel:[0,0,1] op_sel_hi:[1,0,1]
  v_pk_fma_f32 v[156:157], v[156:157], v[14:15], v[14:15] op_sel:[0,0,1] op_sel_hi:[1,0,1]
  v_pk_fma_f32 v[158:159], v[158:159], v[14:15], v[14:15] op_sel:[0,0,1] op_sel_hi:[1,0,1]
  v_pk_fma_f32 v[160:161], v[160:161], v[14:15], v[14:15] op_sel:[0,0,1] op_sel_hi:[1,0,1]
  v_pk_fma_f32 v[162:163], v[162:163], v[14:15], v[14:15] op_sel:[0,0,1] op_sel_hi:[1,0,1]
  v_pk_fma_f32 v[164:165], v[164:165], v[14:15], v[14:15] op_sel:[0,0,1] op_sel_hi:[1,0,1]
  v_pk_fma_f32 v[166:167], v[166:167], v[14:15], v[14:15] op_sel:[0,0,1] op_sel_hi:[1,0,1]
  v_pk_fma_f32 v[168:169], v[168:169], v[14:15], v[14:15] op_sel:[0,0,1] op_sel_hi:[1,0,1]
  v_pk_fma_f32 v[170:171], v[170:171], v[14:15], v[14:15] op_sel:[0,0,1] op_sel_hi:[1,0,1]
  buffer_load_dwordx2 a[250:251], v253, s[8:11], s57 offen offset:1408
  v_pk_fma_f32 v[172:173], v[172:173], v[14:15], v[14:15] op_sel:[0,0,1] op_sel_hi:[1,0,1]
  v_pk_fma_f32 v[174:175], v[174:175], v[14:15], v[14:15] op_sel:[0,0,1] op_sel_hi:[1,0,1]
  v_mov_b32 v14, 0
  v_mov_b32 v15, 0
  s_waitcnt vmcnt(30)
  v_dot2_f32_bf16 v14, v196, s100, v14
  v_dot2c_f32_bf16 v15, v196, v196
  v_dot2_f32_bf16 v14, v197, s100, v14
  v_dot2c_f32_bf16 v15, v197, v197
  v_dot2_f32_bf16 v14, v198, s100, v14
  v_dot2c_f32_bf16 v15, v198, v198
  v_dot2_f32_bf16 v14, v199, s100, v14
  v_dot2c_f32_bf16 v15, v199, v199
  s_waitcnt vmcnt(29)
  v_dot2_f32_bf16 v14, v200, s100, v14
  v_dot2c_f32_bf16 v15, v200, v200
  v_dot2_f32_bf16 v14, v201, s100, v14
  v_dot2c_f32_bf16 v15, v201, v201
  v_dot2_f32_bf16 v14, v202, s100, v14
  v_dot2c_f32_bf16 v15, v202, v202
  v_dot2_f32_bf16 v14, v203, s100, v14
  v_dot2c_f32_bf16 v15, v203, v203
  s_waitcnt vmcnt(28)
  v_dot2_f32_bf16 v14, v204, s100, v14
  v_dot2c_f32_bf16 v15, v204, v204
  v_dot2_f32_bf16 v14, v205, s100, v14
  v_dot2c_f32_bf16 v15, v205, v205
  v_dot2_f32_bf16 v14, v206, s100, v14
  v_dot2c_f32_bf16 v15, v206, v206
  v_dot2_f32_bf16 v14, v207, s100, v14
  v_dot2c_f32_bf16 v15, v207, v207
  s_waitcnt vmcnt(27)
  v_dot2_f32_bf16 v14, v208, s100, v14
  v_dot2c_f32_bf16 v15, v208, v208
  v_dot2_f32_bf16 v14, v209, s100, v14
  v_dot2c_f32_bf16 v15, v209, v209
  v_dot2_f32_bf16 v14, v210, s100, v14
  v_dot2c_f32_bf16 v15, v210, v210
  v_dot2_f32_bf16 v14, v211, s100, v14
  v_dot2c_f32_bf16 v15, v211, v211
  s_waitcnt vmcnt(26)
  v_dot2_f32_bf16 v14, v212, s100, v14
  v_dot2c_f32_bf16 v15, v212, v212
  v_dot2_f32_bf16 v14, v213, s100, v14
  v_dot2c_f32_bf16 v15, v213, v213
  v_dot2_f32_bf16 v14, v214, s100, v14
  v_dot2c_f32_bf16 v15, v214, v214
  v_dot2_f32_bf16 v14, v215, s100, v14
  v_dot2c_f32_bf16 v15, v215, v215
  s_nop 1
  v_add_f32_dpp v14, v14, v14 row_ror:8 row_mask:0xf bank_mask:0xf
  v_add_f32_dpp v15, v15, v15 row_ror:8 row_mask:0xf bank_mask:0xf
  v_lshlrev_b32 v176, 16, v196
  v_and_b32 v177, 0xffff0000, v196
  v_lshlrev_b32 v178, 16, v197
  v_and_b32 v179, 0xffff0000, v197
  v_lshlrev_b32 v180, 16, v198
  v_and_b32 v181, 0xffff0000, v198
  v_lshlrev_b32 v182, 16, v199
  v_and_b32 v183, 0xffff0000, v199
  v_lshlrev_b32 v184, 16, v200
  v_and_b32 v185, 0xffff0000, v200
  v_add_f32_dpp v14, v14, v14 row_ror:4 row_mask:0xf bank_mask:0xf
  v_add_f32_dpp v15, v15, v15 row_ror:4 row_mask:0xf bank_mask:0xf
  v_lshlrev_b32 v186, 16, v201
  v_and_b32 v187, 0xffff0000, v201
  v_lshlrev_b32 v188, 16, v202
  v_and_b32 v189, 0xffff0000, v202
  v_lshlrev_b32 v190, 16, v203
  v_and_b32 v191, 0xffff0000, v203
  v_lshlrev_b32 v192, 16, v204
  v_and_b32 v193, 0xffff0000, v204
  v_lshlrev_b32 v194, 16, v205
  v_and_b32 v195, 0xffff0000, v205
  v_add_f32_dpp v14, v14, v14 row_ror:2 row_mask:0xf bank_mask:0xf
  v_add_f32_dpp v15, v15, v15 row_ror:2 row_mask:0xf bank_mask:0xf
  v_lshlrev_b32 v196, 16, v206
  v_and_b32 v197, 0xffff0000, v206
  v_lshlrev_b32 v198, 16, v207
  v_and_b32 v199, 0xffff0000, v207
  v_lshlrev_b32 v200, 16, v208
  v_and_b32 v201, 0xffff0000, v208
  v_lshlrev_b32 v202, 16, v209
  v_and_b32 v203, 0xffff0000, v209
  v_lshlrev_b32 v204, 16, v210
  v_and_b32 v205, 0xffff0000, v210
  v_add_f32_dpp v14, v14, v14 row_ror:1 row_mask:0xf bank_mask:0xf
  v_add_f32_dpp v15, v15, v15 row_ror:1 row_mask:0xf bank_mask:0xf
  v_lshlrev_b32 v206, 16, v211
  v_and_b32 v207, 0xffff0000, v211
  v_lshlrev_b32 v208, 16, v212
  v_and_b32 v209, 0xffff0000, v212
  v_lshlrev_b32 v210, 16, v213
  v_and_b32 v211, 0xffff0000, v213
  v_lshlrev_b32 v212, 16, v214
  v_and_b32 v213, 0xffff0000, v214
  v_lshlrev_b32 v214, 16, v215
  v_and_b32 v215, 0xffff0000, v215
  v_mul_f32 v14, 0x3acccccd, v14
  v_mul_f32 v15, 0x3acccccd, v15
  v_fma_f32 v15, -v14, v14, v15
  v_max_f32 v15, 0, v15
  v_add_f32 v15, 0x3727c5ac, v15
  v_rsq_f32 v13, v15
  s_nop 0
  v_mul_f32_e64 v15, -v14, v13
  v_mov_b32 v14, v13
  v_pk_fma_f32 v[176:177], v[176:177], v[14:15], v[14:15] op_sel:[0,0,1] op_sel_hi:[1,0,1]
  v_pk_fma_f32 v[178:179], v[178:179], v[14:15], v[14:15] op_sel:[0,0,1] op_sel_hi:[1,0,1]
  v_pk_fma_f32 v[180:181], v[180:181], v[14:15], v[14:15] op_sel:[0,0,1] op_sel_hi:[1,0,1]
  v_pk_fma_f32 v[182:183], v[182:183], v[14:15], v[14:15] op_sel:[0,0,1] op_sel_hi:[1,0,1]
  v_pk_fma_f32 v[184:185], v[184:185], v[14:15], v[14:15] op_sel:[0,0,1] op_sel_hi:[1,0,1]
  v_pk_fma_f32 v[186:187], v[186:187], v[14:15], v[14:15] op_sel:[0,0,1] op_sel_hi:[1,0,1]
  v_pk_fma_f32 v[188:189], v[188:189], v[14:15], v[14:15] op_sel:[0,0,1] op_sel_hi:[1,0,1]
  v_pk_fma_f32 v[190:191], v[190:191], v[14:15], v[14:15] op_sel:[0,0,1] op_sel_hi:[1,0,1]
  v_pk_fma_f32 v[192:193], v[192:193], v[14:15], v[14:15] op_sel:[0,0,1] op_sel_hi:[1,0,1]
  v_pk_fma_f32 v[194:195], v[194:195], v[14:15], v[14:15] op_sel:[0,0,1] op_sel_hi:[1,0,1]
  v_pk_fma_f32 v[196:197], v[196:197], v[14:15], v[14:15] op_sel:[0,0,1] op_sel_hi:[1,0,1]
  v_pk_fma_f32 v[198:199], v[198:199], v[14:15], v[14:15] op_sel:[0,0,1] op_sel_hi:[1,0,1]
  v_pk_fma_f32 v[200:201], v[200:201], v[14:15], v[14:15] op_sel:[0,0,1] op_sel_hi:[1,0,1]
  v_pk_fma_f32 v[202:203], v[202:203], v[14:15], v[14:15] op_sel:[0,0,1] op_sel_hi:[1,0,1]
  v_pk_fma_f32 v[204:205], v[204:205], v[14:15], v[14:15] op_sel:[0,0,1] op_sel_hi:[1,0,1]
  v_pk_fma_f32 v[206:207], v[206:207], v[14:15], v[14:15] op_sel:[0,0,1] op_sel_hi:[1,0,1]
  v_pk_fma_f32 v[208:209], v[208:209], v[14:15], v[14:15] op_sel:[0,0,1] op_sel_hi:[1,0,1]
  v_pk_fma_f32 v[210:211], v[210:211], v[14:15], v[14:15] op_sel:[0,0,1] op_sel_hi:[1,0,1]
  v_pk_fma_f32 v[212:213], v[212:213], v[14:15], v[14:15] op_sel:[0,0,1] op_sel_hi:[1,0,1]
  v_pk_fma_f32 v[214:215], v[214:215], v[14:15], v[14:15] op_sel:[0,0,1] op_sel_hi:[1,0,1]
  s_mov_b32 s16, s48
  s_mov_b32 s17, s49
  s_mov_b32 s18, 2621440
  s_mov_b32 s19, 0x20000
  s_mov_b32 s20, 0x3ea52b5c
  s_mov_b32 s21, 0x3acccccd
  s_mov_b32 s22, 0x3727c5ac
  s_lshl_b32 s52, s4, 7
  s_add_u32 s52, s52, 24629248
  s_add_u32 s54, s12, s52
  s_addc_u32 s55, s13, 0
  s_lshl_b32 s6, s5, 2
  s_add_u32 s52, s52, s6
  s_lshl_b32 s60, s3, 10
  s_waitcnt vmcnt(4)
  v_cmp_ne_u32 vcc, s94, v250
  s_mov_b32 s7, 0
SYA:
  s_nop 3
  s_cbranch_vccz SYA_DONE
  s_sleep 2
  buffer_load_dword v250, v251, s[12:15], s25 offen sc1
  s_waitcnt vmcnt(0)
  v_cmp_ne_u32 vcc, s94, v250
  s_add_u32 s7, s7, 1
  s_cmp_lt_u32 s7, 262144
  s_cbranch_scc1 SYA
SYA_DONE:
  s_lshl_b32 s24, s5, 2
  s_add_u32 s24, s24, s3
  s_mul_i32 s24, s24, 81920
  s_add_u32 s24, s24, 65536
  s_and_b32 s41, s4, 0
  s_mul_i32 s38, s41, 40960
  s_add_u32 s24, s24, s38
  s_lshl_b32 s38, s38, 1
  s_mul_i32 s39, s41, 20480
  s_sub_u32 s39, 10240, s39
  s_sub_u32 s40, 61440, s39
  s_mul_i32 s41, s41, 10240
  buffer_load_dwordx4 a[0:3], v1, s[12:15], s24 offen offset:0 sc1
  buffer_load_dwordx4 a[4:7], v1, s[12:15], s24 offen offset:1024 sc1
  s_mov_b32 s7, 0
SYM:
  v_xor_b32 v216, s44, v216
  v_xor_b32 v217, s45, v217
  v_xor_b32 v218, s46, v218
  v_xor_b32 v219, s47, v219
  v_xor_b32 v220, s44, v220
  v_xor_b32 v221, s45, v221
  v_xor_b32 v222, s46, v222
  v_xor_b32 v223, s47, v223
  v_xor_b32 v224, s44, v224
  v_xor_b32 v225, s45, v225
  v_xor_b32 v226, s46, v226
  v_xor_b32 v227, s47, v227
  v_xor_b32 v228, s44, v228
  v_xor_b32 v229, s45, v229
  v_xor_b32 v230, s46, v230
  v_xor_b32 v231, s47, v231
  v_xor_b32 v232, s44, v232
  v_xor_b32 v233, s45, v233
  v_xor_b32 v234, s46, v234
  v_xor_b32 v235, s47, v235
  v_or_b32 v13, v216, v217
  v_or3_b32 v13, v13, v218, v219
  v_or3_b32 v13, v13, v220, v221
  v_or3_b32 v13, v13, v222, v223
  v_or3_b32 v13, v13, v224, v225
  v_or3_b32 v13, v13, v226, v227
  v_or3_b32 v13, v13, v228, v229
  v_or3_b32 v13, v13, v230, v231
  v_or3_b32 v13, v13, v232, v233
  v_or3_b32 v13, v13, v234, v235
  v_and_b32 v13, 0xff, v13
  v_cmp_ne_u32 vcc, 0, v13
  s_nop 3
  s_cbranch_vccz SYM_DONE
  s_sleep 2
  s_add_u32 s6, s23, 0
  buffer_load_dwordx4 v[216:219], v1, s[12:15], s6 offen sc1
  s_add_u32 s6, s23, 4096
  buffer_load_dwordx4 v[220:223], v1, s[12:15], s6 offen sc1
  s_add_u32 s6, s23, 8192
  buffer_load_dwordx4 v[224:227], v1, s[12:15], s6 offen sc1
  s_add_u32 s6, s23, 12288
  buffer_load_dwordx4 v[228:231], v1, s[12:15], s6 offen sc1
  s_add_u32 s6, s23, 16384
  buffer_load_dwordx4 v[232:235], v1, s[12:15], s6 offen sc1
  s_waitcnt vmcnt(0)
  s_add_u32 s7, s7, 1
  s_cmp_lt_u32 s7, 262144
  s_cbranch_scc1 SYM
SYM_DONE:
  s_cmp_ge_u32 s3, 2
  s_cselect_b64 s[34:35], -1, 0
  s_lshr_b32 s6, s3, 1
  s_lshl_b32 s6, s6, 9
  s_and_b32 s7, s3, 1
  s_lshl_b32 s7, s7, 7
  s_add_u32 s6, s6, s7
  s_add_u32 s6, s6, 102400
  v_and_b32 v12, 3, v2
  v_lshl_add_u32 v12, v12, 2, s6
  v_bfe_u32 v13, v2, 2, 1
  v_lshl_add_u32 v12, v13, 8, v12
  v_lshrrev_b32 v13, 3, v2
  v_lshl_add_u32 v12, v13, 4, v12
  v_add_f32_dpp v216, v216, v216 quad_perm:[1,0,3,2] row_mask:0xf bank_mask:0xf
  buffer_load_dwordx4 a[8:11], v1, s[12:15], s24 offen offset:2048 sc1
  v_add_f32_dpp v217, v217, v217 quad_perm:[1,0,3,2] row_mask:0xf bank_mask:0xf
  v_add_f32_dpp v218, v218, v218 quad_perm:[1,0,3,2] row_mask:0xf bank_mask:0xf
  v_add_f32_dpp v219, v219, v219 quad_perm:[1,0,3,2] row_mask:0xf bank_mask:0xf
  v_add_f32_dpp v220, v220, v220 quad_perm:[1,0,3,2] row_mask:0xf bank_mask:0xf
  v_add_f32_dpp v221, v221, v221 quad_perm:[1,0,3,2] row_mask:0xf bank_mask:0xf
  v_add_f32_dpp v222, v222, v222 quad_perm:[1,0,3,2] row_mask:0xf bank_mask:0xf
  v_add_f32_dpp v223, v223, v223 quad_perm:[1,0,3,2] row_mask:0xf bank_mask:0xf
  v_add_f32_dpp v224, v224, v224 quad_perm:[1,0,3,2] row_mask:0xf bank_mask:0xf
  v_add_f32_dpp v225, v225, v225 quad_perm:[1,0,3,2] row_mask:0xf bank_mask:0xf
  s_cmp_eq_u32 s3, 3
  s_cbranch_scc1 SK2
  buffer_load_dwordx4 a[12:15], v1, s[12:15], s24 offen offset:3072 sc1
SK2:
  s_add_u32 s24, s24, 4096
  v_add_f32_dpp v226, v226, v226 quad_perm:[1,0,3,2] row_mask:0xf bank_mask:0xf
  v_add_f32_dpp v227, v227, v227 quad_perm:[1,0,3,2] row_mask:0xf bank_mask:0xf
  v_add_f32_dpp v228, v228, v228 quad_perm:[1,0,3,2] row_mask:0xf bank_mask:0xf
  v_add_f32_dpp v229, v229, v229 quad_perm:[1,0,3,2] row_mask:0xf bank_mask:0xf
  v_add_f32_dpp v230, v230, v230 quad_perm:[1,0,3,2] row_mask:0xf bank_mask:0xf
  v_add_f32_dpp v231, v231, v231 quad_perm:[1,0,3,2] row_mask:0xf bank_mask:0xf
  v_add_f32_dpp v232, v232, v232 quad_perm:[1,0,3,2] row_mask:0xf bank_mask:0xf
  v_add_f32_dpp v233, v233, v233 quad_perm:[1,0,3,2] row_mask:0xf bank_mask:0xf
  v_add_f32_dpp v234, v234, v234 quad_perm:[1,0,3,2] row_mask:0xf bank_mask:0xf
  v_add_f32_dpp v235, v235, v235 quad_perm:[1,0,3,2] row_mask:0xf bank_mask:0xf
  buffer_load_dwordx4 a[16:19], v1, s[12:15], s24 offen offset:0 sc1
  v_cndmask_b32_e64 v216, v216, v217, s[32:33]
  v_cndmask_b32_e64 v218, v218, v219, s[32:33]
  v_cndmask_b32_e64 v220, v220, v221, s[32:33]
  v_cndmask_b32_e64 v222, v222, v223, s[32:33]
  v_cndmask_b32_e64 v224, v224, v225, s[32:33]
  v_cndmask_b32_e64 v226, v226, v227, s[32:33]
  v_cndmask_b32_e64 v228, v228, v229, s[32:33]
  v_cndmask_b32_e64 v230, v230, v231, s[32:33]
  v_cndmask_b32_e64 v232, v232, v233, s[32:33]
  v_cndmask_b32_e64 v234, v234, v235, s[32:33]
  buffer_load_dwordx4 a[20:23], v1, s[12:15], s24 offen offset:1024 sc1
  v_add_f32_dpp v216, v216, v216 quad_perm:[2,3,0,1] row_mask:0xf bank_mask:0xf
  v_add_f32_dpp v218, v218, v218 quad_perm:[2,3,0,1] row_mask:0xf bank_mask:0xf
  v_add_f32_dpp v220, v220, v220 quad_perm:[2,3,0,1] row_mask:0xf bank_mask:0xf
  v_add_f32_dpp v222, v222, v222 quad_perm:[2,3,0,1] row_mask:0xf bank_mask:0xf
  v_add_f32_dpp v224, v224, v224 quad_perm:[2,3,0,1] row_mask:0xf bank_mask:0xf
  v_add_f32_dpp v226, v226, v226 quad_perm:[2,3,0,1] row_mask:0xf bank_mask:0xf
  v_add_f32_dpp v228, v228, v228 quad_perm:[2,3,0,1] row_mask:0xf bank_mask:0xf
  v_add_f32_dpp v230, v230, v230 quad_perm:[2,3,0,1] row_mask:0xf bank_mask:0xf
  v_add_f32_dpp v232, v232, v232 quad_perm:[2,3,0,1] row_mask:0xf bank_mask:0xf
  v_add_f32_dpp v234, v234, v234 quad_perm:[2,3,0,1] row_mask:0xf bank_mask:0xf
  buffer_load_dwordx4 a[24:27], v1, s[12:15], s24 offen offset:2048 sc1
  v_cndmask_b32_e64 v216, v216, v218, s[36:37]
  v_cndmask_b32_e64 v220, v220, v222, s[36:37]
  v_cndmask_b32_e64 v224, v224, v226, s[36:37]
  v_cndmask_b32_e64 v228, v228, v230, s[36:37]
  v_cndmask_b32_e64 v232, v232, v234, s[36:37]
  v_cvt_pk_bf16_f32 v216, 0, v216
  ds_write_b32 v12, v216 offset:0
  v_cvt_pk_bf16_f32 v220, 0, v220
  ds_write_b32 v12, v220 offset:1024
  s_cmp_eq_u32 s3, 3
  s_cbranch_scc1 SK3
  buffer_load_dwordx4 a[28:31], v1, s[12:15], s24 offen offset:3072 sc1
SK3:
  s_add_u32 s24, s24, 4096
  v_cvt_pk_bf16_f32 v224, 0, v224
  v_add_f32 v225, 1.0, v224
  v_cvt_pk_bf16_f32 v225, 0, v225
  v_cndmask_b32_e64 v224, v224, v225, s[34:35]
  ds_write_b32 v12, v224 offset:2048
  v_cvt_pk_bf16_f32 v228, 0, v228
  buffer_load_dwordx4 a[32:35], v1, s[12:15], s24 offen offset:0 sc1
  v_add_f32 v228, 1.0, v228
  v_cvt_pk_bf16_f32 v228, 0, v228
  ds_write_b32 v12, v228 offset:3072
  v_cvt_pk_bf16_f32 v232, 0, v232
  v_add_f32 v232, 1.0, v232
  v_cvt_pk_bf16_f32 v232, 0, v232
  ds_write_b32 v12, v232 offset:4096
  buffer_load_dwordx4 a[36:39], v1, s[12:15], s24 offen offset:1024 sc1
  s_waitcnt lgkmcnt(0)
  s_barrier
  buffer_load_dwordx4 a[40:43], v1, s[12:15], s24 offen offset:2048 sc1
  s_cmp_eq_u32 s3, 3
  s_cbranch_scc1 SK4
  buffer_load_dwordx4 a[44:47], v1, s[12:15], s24 offen offset:3072 sc1
SK4:
  s_add_u32 s24, s24, 4096
  buffer_load_dwordx4 a[48:51], v1, s[12:15], s24 offen offset:0 sc1
  buffer_load_dwordx4 a[52:55], v1, s[12:15], s24 offen offset:1024 sc1
  s_nop 4
  v_lshrrev_b32 v12, 2, v2
  v_mul_u32_u24 v12, 736, v12
  v_and_b32 v13, 3, v2
  v_add_u32 v12, 112704, v12
  s_mov_b32 s96, s62
  s_mov_b32 s99, 100663296
  s_cmp_eq_u32 s58, 2
  s_cbranch_scc1 PB_W1
  s_mul_i32 s6, s3, 160
  v_add_u32 v12, s6, v12
  v_lshl_add_u32 v14, v13, 3, v12
  v_lshl_add_u32 v12, v13, 4, v12
  v_subrev_u32 v15, s61, v12
  v_add_u32 v12, s61, v12
  ds_read_b64_tr_b16 a[216:217], v12 offset:0
  ds_read_b64_tr_b16 a[218:219], v12 offset:11776
  ds_read_b64_tr_b16 a[220:221], v12 offset:8
  ds_read_b64_tr_b16 a[222:223], v12 offset:11784
  ds_read_b64_tr_b16 a[224:225], v15 offset:64
  ds_read_b64_tr_b16 a[226:227], v15 offset:11840
  ds_read_b64_tr_b16 a[228:229], v15 offset:72
  ds_read_b64_tr_b16 a[230:231], v15 offset:11848
  ds_read_b64_tr_b16 a[232:233], v14 offset:128
  ds_read_b64_tr_b16 a[234:235], v14 offset:11904
  s_movk_i32 s97, 1024
  s_branch PB_END
PB_W1:
  s_lshl_b32 s6, s3, 5
  v_add_u32 v12, s6, v12
  v_lshl_add_u32 v12, v13, 3, v12
  ds_read_b64_tr_b16 a[216:217], v12 offset:0
  ds_read_b64_tr_b16 a[218:219], v12 offset:11776
  ds_read_b64_tr_b16 a[220:221], v12 offset:128
  ds_read_b64_tr_b16 a[222:223], v12 offset:11904
  ds_read_b64_tr_b16 a[224:225], v12 offset:256
  ds_read_b64_tr_b16 a[226:227], v12 offset:12032
  ds_read_b64_tr_b16 a[228:229], v12 offset:384
  ds_read_b64_tr_b16 a[230:231], v12 offset:12160
  ds_read_b64_tr_b16 a[232:233], v12 offset:512
  ds_read_b64_tr_b16 a[234:235], v12 offset:12288
  ds_read_b64_tr_b16 a[236:237], v12 offset:640
  ds_read_b64_tr_b16 a[238:239], v12 offset:12416
  s_mov_b32 s97, 81920
  s_lshr_b32 s6, s61, 1
  s_or_b32 s6, s6, s3
  s_cmp_lt_u32 s6, 2
  s_cmov_b32 s99, 81920
PB_END:
  s_nop 4
  v_lshlrev_b32 v15, 4, v5
  v_add_u32 v15, 102400, v15
  ds_read_b128 v[216:219], v15 offset:0
  ds_read_b128 v[220:223], v15 offset:256
  ds_read_b128 v[224:227], v15 offset:2560
  ds_read_b128 v[228:231], v15 offset:2816
  v_xor_b32 v12, v5, v3
  v_lshlrev_b32 v12, 4, v12
  v_lshl_add_u32 v12, v3, 8, v12
  v_add_u32 v12, s41, v12
  v_xor_b32 v13, 64, v12
  v_mov_b32 v14, s94
  ds_read_b128 v[232:235], v15 offset:512
  ds_read_b128 v[236:239], v15 offset:768
  ds_read_b128 v[240:243], v15 offset:3072
  ds_read_b128 v[244:247], v15 offset:3328
  s_waitcnt lgkmcnt(5)
  v_pk_fma_f32 v[16:17], v[16:17], v[224:225], v[216:217]
  v_pk_fma_f32 v[18:19], v[18:19], v[226:227], v[218:219]
  s_waitcnt lgkmcnt(4)
  v_pk_fma_f32 v[20:21], v[20:21], v[228:229], v[220:221]
  v_pk_fma_f32 v[22:23], v[22:23], v[230:231], v[222:223]
  v_cvt_pk_bf16_f32 v16, v16, v17
  v_cvt_pk_bf16_f32 v17, v18, v19
  v_cvt_pk_bf16_f32 v18, v20, v21
  v_cvt_pk_bf16_f32 v19, v22, v23
  ds_write_b128 v4, v[16:19] offset:0
  buffer_store_dwordx4 a[216:219], v249, s[12:15], s96 offen sc1
  s_add_u32 s96, s96, s97
  v_pk_fma_f32 v[56:57], v[56:57], v[224:225], v[216:217]
  v_pk_fma_f32 v[58:59], v[58:59], v[226:227], v[218:219]
  v_pk_fma_f32 v[60:61], v[60:61], v[228:229], v[220:221]
  v_pk_fma_f32 v[62:63], v[62:63], v[230:231], v[222:223]
  v_cvt_pk_bf16_f32 v56, v56, v57
  v_cvt_pk_bf16_f32 v57, v58, v59
  v_cvt_pk_bf16_f32 v58, v60, v61
  v_cvt_pk_bf16_f32 v59, v62, v63
  ds_write_b128 v6, v[56:59] offset:0
  buffer_store_dwordx4 a[220:223], v249, s[12:15], s96 offen sc1
  s_add_u32 s96, s96, s97
  v_pk_fma_f32 v[96:97], v[96:97], v[224:225], v[216:217]
  v_pk_fma_f32 v[98:99], v[98:99], v[226:227], v[218:219]
  v_pk_fma_f32 v[100:101], v[100:101], v[228:229], v[220:221]
  v_pk_fma_f32 v[102:103], v[102:103], v[230:231], v[222:223]
  v_cvt_pk_bf16_f32 v96, v96, v97
  v_cvt_pk_bf16_f32 v97, v98, v99
  v_cvt_pk_bf16_f32 v98, v100, v101
  v_cvt_pk_bf16_f32 v99, v102, v103
  ds_write_b128 v7, v[96:99] offset:0
  buffer_store_dwordx4 a[224:227], v249, s[12:15], s96 offen sc1
  s_add_u32 s96, s96, s97
  ds_read_b128 v[216:219], v15 offset:1024
  ds_read_b128 v[220:223], v15 offset:1280
  ds_read_b128 v[224:227], v15 offset:3584
  ds_read_b128 v[228:231], v15 offset:3840
  s_waitcnt lgkmcnt(8)
  v_pk_fma_f32 v[24:25], v[24:25], v[240:241], v[232:233]
  v_pk_fma_f32 v[26:27], v[26:27], v[242:243], v[234:235]
  s_waitcnt lgkmcnt(7)
  v_pk_fma_f32 v[28:29], v[28:29], v[244:245], v[236:237]
  v_pk_fma_f32 v[30:31], v[30:31], v[246:247], v[238:239]
  v_cvt_pk_bf16_f32 v24, v24, v25
  v_cvt_pk_bf16_f32 v25, v26, v27
  v_cvt_pk_bf16_f32 v26, v28, v29
  v_cvt_pk_bf16_f32 v27, v30, v31
  ds_write_b128 v4, v[24:27] offset:4096
  buffer_store_dwordx4 a[228:231], v249, s[12:15], s96 offen sc1
  s_add_u32 s96, s96, s97
  v_pk_fma_f32 v[64:65], v[64:65], v[240:241], v[232:233]
  v_pk_fma_f32 v[66:67], v[66:67], v[242:243], v[234:235]
  v_pk_fma_f32 v[68:69], v[68:69], v[244:245], v[236:237]
  v_pk_fma_f32 v[70:71], v[70:71], v[246:247], v[238:239]
  v_cvt_pk_bf16_f32 v64, v64, v65
  v_cvt_pk_bf16_f32 v65, v66, v67
  v_cvt_pk_bf16_f32 v66, v68, v69
  v_cvt_pk_bf16_f32 v67, v70, v71
  ds_write_b128 v6, v[64:67] offset:4096
  buffer_store_dwordx4 a[232:235], v249, s[12:15], s96 offen sc1
  s_add_u32 s96, s96, s99
  v_pk_fma_f32 v[104:105], v[104:105], v[240:241], v[232:233]
  v_pk_fma_f32 v[106:107], v[106:107], v[242:243], v[234:235]
  v_pk_fma_f32 v[108:109], v[108:109], v[244:245], v[236:237]
  v_pk_fma_f32 v[110:111], v[110:111], v[246:247], v[238:239]
  v_cvt_pk_bf16_f32 v104, v104, v105
  v_cvt_pk_bf16_f32 v105, v106, v107
  v_cvt_pk_bf16_f32 v106, v108, v109
  v_cvt_pk_bf16_f32 v107, v110, v111
  ds_write_b128 v7, v[104:107] offset:4096
  buffer_store_dwordx4 a[236:239], v249, s[12:15], s96 offen sc1
  ds_read_b128 v[232:235], v15 offset:1536
  ds_read_b128 v[236:239], v15 offset:1792
  ds_read_b128 v[240:243], v15 offset:4096
  ds_read_b128 v[244:247], v15 offset:4352
  s_waitcnt lgkmcnt(8)
  v_pk_fma_f32 v[32:33], v[32:33], v[224:225], v[216:217]
  v_pk_fma_f32 v[34:35], v[34:35], v[226:227], v[218:219]
  s_waitcnt lgkmcnt(7)
  v_pk_fma_f32 v[36:37], v[36:37], v[228:229], v[220:221]
  v_pk_fma_f32 v[38:39], v[38:39], v[230:231], v[222:223]
  v_cvt_pk_bf16_f32 v32, v32, v33
  v_cvt_pk_bf16_f32 v33, v34, v35
  v_cvt_pk_bf16_f32 v34, v36, v37
  v_cvt_pk_bf16_f32 v35, v38, v39
  ds_write_b128 v4, v[32:35] offset:8192
  buffer_load_dwordx4 a[56:59], v1, s[12:15], s24 offen offset:2048 sc1
  s_cmp_eq_u32 s3, 3
  s_cbranch_scc1 SK5
  buffer_load_dwordx4 a[60:63], v1, s[12:15], s24 offen offset:3072 sc1
SK5:
  s_add_u32 s24, s24, 4096
  v_pk_fma_f32 v[72:73], v[72:73], v[224:225], v[216:217]
  v_pk_fma_f32 v[74:75], v[74:75], v[226:227], v[218:219]
  v_pk_fma_f32 v[76:77], v[76:77], v[228:229], v[220:221]
  v_pk_fma_f32 v[78:79], v[78:79], v[230:231], v[222:223]
  v_cvt_pk_bf16_f32 v72, v72, v73
  v_cvt_pk_bf16_f32 v73, v74, v75
  v_cvt_pk_bf16_f32 v74, v76, v77
  v_cvt_pk_bf16_f32 v75, v78, v79
  ds_write_b128 v6, v[72:75] offset:8192
  buffer_load_dwordx4 a[64:67], v1, s[12:15], s24 offen offset:0 sc1
  v_pk_fma_f32 v[112:113], v[112:113], v[224:225], v[216:217]
  v_pk_fma_f32 v[114:115], v[114:115], v[226:227], v[218:219]
  v_pk_fma_f32 v[116:117], v[116:117], v[228:229], v[220:221]
  v_pk_fma_f32 v[118:119], v[118:119], v[230:231], v[222:223]
  v_cvt_pk_bf16_f32 v112, v112, v113
  v_cvt_pk_bf16_f32 v113, v114, v115
  v_cvt_pk_bf16_f32 v114, v116, v117
  v_cvt_pk_bf16_f32 v115, v118, v119
  ds_write_b128 v7, v[112:115] offset:8192
  buffer_load_dwordx4 a[68:71], v1, s[12:15], s24 offen offset:1024 sc1
  buffer_load_dwordx4 a[72:75], v1, s[12:15], s24 offen offset:2048 sc1
  ds_read_b128 v[216:219], v15 offset:2048
  ds_read_b128 v[220:223], v15 offset:2304
  ds_read_b128 v[224:227], v15 offset:4608
  ds_read_b128 v[228:231], v15 offset:4864
  s_waitcnt lgkmcnt(8)
  v_pk_fma_f32 v[40:41], v[40:41], v[240:241], v[232:233]
  v_pk_fma_f32 v[42:43], v[42:43], v[242:243], v[234:235]
  s_waitcnt lgkmcnt(7)
  v_pk_fma_f32 v[44:45], v[44:45], v[244:245], v[236:237]
  v_pk_fma_f32 v[46:47], v[46:47], v[246:247], v[238:239]
  v_cvt_pk_bf16_f32 v40, v40, v41
  v_cvt_pk_bf16_f32 v41, v42, v43
  v_cvt_pk_bf16_f32 v42, v44, v45
  v_cvt_pk_bf16_f32 v43, v46, v47
  ds_write_b128 v4, v[40:43] offset:12288
  s_cmp_eq_u32 s3, 3
  s_cbranch_scc1 SK6
  buffer_load_dwordx4 a[76:79], v1, s[12:15], s24 offen offset:3072 sc1
SK6:
  s_add_u32 s24, s24, 4096
  v_pk_fma_f32 v[80:81], v[80:81], v[240:241], v[232:233]
  v_pk_fma_f32 v[82:83], v[82:83], v[242:243], v[234:235]
  v_pk_fma_f32 v[84:85], v[84:85], v[244:245], v[236:237]
  v_pk_fma_f32 v[86:87], v[86:87], v[246:247], v[238:239]
  v_cvt_pk_bf16_f32 v80, v80, v81
  v_cvt_pk_bf16_f32 v81, v82, v83
  v_cvt_pk_bf16_f32 v82, v84, v85
  v_cvt_pk_bf16_f32 v83, v86, v87
  ds_write_b128 v6, v[80:83] offset:12288
  buffer_load_dwordx4 a[80:83], v1, s[12:15], s24 offen offset:0 sc1
  buffer_load_dwordx4 a[84:87], v1, s[12:15], s24 offen offset:1024 sc1
  v_pk_fma_f32 v[120:121], v[120:121], v[240:241], v[232:233]
  v_pk_fma_f32 v[122:123], v[122:123], v[242:243], v[234:235]
  v_pk_fma_f32 v[124:125], v[124:125], v[244:245], v[236:237]
  v_pk_fma_f32 v[126:127], v[126:127], v[246:247], v[238:239]
  v_cvt_pk_bf16_f32 v120, v120, v121
  v_cvt_pk_bf16_f32 v121, v122, v123
  v_cvt_pk_bf16_f32 v122, v124, v125
  v_cvt_pk_bf16_f32 v123, v126, v127
  ds_write_b128 v7, v[120:123] offset:12288
  buffer_load_dwordx4 a[88:91], v1, s[12:15], s24 offen offset:2048 sc1
  s_waitcnt lgkmcnt(4)
  v_pk_fma_f32 v[48:49], v[48:49], v[224:225], v[216:217]
  v_pk_fma_f32 v[50:51], v[50:51], v[226:227], v[218:219]
  s_waitcnt lgkmcnt(3)
  v_pk_fma_f32 v[52:53], v[52:53], v[228:229], v[220:221]
  v_pk_fma_f32 v[54:55], v[54:55], v[230:231], v[222:223]
  v_cvt_pk_bf16_f32 v48, v48, v49
  v_cvt_pk_bf16_f32 v49, v50, v51
  v_cvt_pk_bf16_f32 v50, v52, v53
  v_cvt_pk_bf16_f32 v51, v54, v55
  ds_write_b128 v4, v[48:51] offset:16384
  s_cmp_eq_u32 s3, 3
  s_cbranch_scc1 SK7
  buffer_load_dwordx4 a[92:95], v1, s[12:15], s24 offen offset:3072 sc1
SK7:
  s_add_u32 s24, s24, 4096
  buffer_load_dwordx4 a[96:99], v1, s[12:15], s24 offen offset:0 sc1
  v_pk_fma_f32 v[88:89], v[88:89], v[224:225], v[216:217]
  v_pk_fma_f32 v[90:91], v[90:91], v[226:227], v[218:219]
  v_pk_fma_f32 v[92:93], v[92:93], v[228:229], v[220:221]
  v_pk_fma_f32 v[94:95], v[94:95], v[230:231], v[222:223]
  v_cvt_pk_bf16_f32 v88, v88, v89
  v_cvt_pk_bf16_f32 v89, v90, v91
  v_cvt_pk_bf16_f32 v90, v92, v93
  v_cvt_pk_bf16_f32 v91, v94, v95
  ds_write_b128 v6, v[88:91] offset:16384
  buffer_load_dwordx4 a[100:103], v1, s[12:15], s24 offen offset:1024 sc1
  v_pk_fma_f32 v[128:129], v[128:129], v[224:225], v[216:217]
  v_pk_fma_f32 v[130:131], v[130:131], v[226:227], v[218:219]
  v_pk_fma_f32 v[132:133], v[132:133], v[228:229], v[220:221]
  v_pk_fma_f32 v[134:135], v[134:135], v[230:231], v[222:223]
  v_cvt_pk_bf16_f32 v128, v128, v129
  v_cvt_pk_bf16_f32 v129, v130, v131
  v_cvt_pk_bf16_f32 v130, v132, v133
  v_cvt_pk_bf16_f32 v131, v134, v135
  ds_write_b128 v7, v[128:131] offset:16384
  buffer_load_dwordx4 a[104:107], v1, s[12:15], s24 offen offset:2048 sc1
  s_cmp_eq_u32 s3, 3
  s_cbranch_scc1 SK8
  buffer_load_dwordx4 a[108:111], v1, s[12:15], s24 offen offset:3072 sc1
SK8:
  s_add_u32 s24, s24, 4096
  s_waitcnt vmcnt(10)
  s_waitcnt lgkmcnt(0)
  s_barrier
  s_cmp_lg_u32 s3, 0
  s_cbranch_scc1 SK9
  s_lshl_b32 s26, s2, 2
  s_add_u32 s26, s26, 33792
  buffer_store_dword v14, v10, s[12:15], s26 offen sc1
SK9:
  ds_read_b128 v[92:95], v12 offset:0
  ds_read_b128 v[96:99], v12 offset:20480
  ds_read_b128 v[100:103], v12 offset:40960
  s_waitcnt lgkmcnt(2)
  v_mfma_f32_16x16x32_bf16 v[24:27], a[4:7], v[92:95], 0
  s_mul_i32 s63, s53, 320
  ds_read_b128 v[104:107], v13 offset:1024
  ds_read_b128 v[60:63], v15 offset:2048
  v_bfe_u32 v123, v2, 3, 2
  v_mfma_f32_16x16x32_bf16 v[36:39], v[92:95], a[8:11], 0
  s_add_u32 s63, s63, 158720
  ds_read_b128 v[108:111], v13 offset:21504
  ds_read_b128 v[64:67], v15 offset:2304
  v_xor_b32 v123, s3, v123
  v_mfma_f32_16x16x32_bf16 v[48:51], a[12:15], v[92:95], 0
  ds_read_b128 v[112:115], v13 offset:41984
  ds_read_b128 v[68:71], v15 offset:4608
  v_lshrrev_b32 v122, 2, v2
  s_waitcnt lgkmcnt(7)
  v_mfma_f32_16x16x32_bf16 v[16:19], a[0:3], v[96:99], 0
  buffer_load_dwordx4 a[112:115], v1, s[12:15], s24 offen offset:0 sc1
  ds_read_b128 v[72:75], v15 offset:4864
  v_mfma_f32_16x16x32_bf16 v[28:31], a[4:7], v[96:99], 0
  ds_read_b128 v[76:79], v15 offset:1536
  ds_read_b128 v[80:83], v15 offset:1792
  v_lshlrev_b32 v122, 7, v122
  v_mfma_f32_16x16x32_bf16 v[40:43], v[96:99], a[8:11], 0
  buffer_load_dwordx4 a[116:119], v1, s[12:15], s24 offen offset:1024 sc1
  ds_read_b128 v[84:87], v15 offset:4096
  v_mfma_f32_16x16x32_bf16 v[52:55], a[12:15], v[96:99], 0
  ds_read_b128 v[88:91], v15 offset:4352
  v_lshl_add_u32 v122, v123, 5, v122
  v_and_b32 v123, 3, v2
  v_lshl_add_u32 v122, v123, 3, v122
  s_waitcnt lgkmcnt(11)
  v_mfma_f32_16x16x32_bf16 v[20:23], a[0:3], v[100:103], 0
  buffer_load_dwordx4 a[120:123], v1, s[12:15], s24 offen offset:2048 sc1
  v_add_u32 v122, 136256, v122
  v_lshl_add_u32 v123, v3, 3, s63
  v_mfma_f32_16x16x32_bf16 v[32:35], a[4:7], v[100:103], 0
  ds_read_b64_tr_b16 a[176:177], v122 offset:0
  ds_read_b64_tr_b16 a[178:179], v122 offset:2048
  v_cmp_eq_u32 vcc, 0, v5
  v_mfma_f32_16x16x32_bf16 v[44:47], v[100:103], a[8:11], 0
  s_cmp_eq_u32 s3, 3
  s_cbranch_scc1 SK10
  buffer_load_dwordx4 a[124:127], v1, s[12:15], s24 offen offset:3072 sc1
SK10:
  ds_read_b64 a[196:197], v123 offset:0
  v_mfma_f32_16x16x32_bf16 v[56:59], a[12:15], v[100:103], 0
  s_waitcnt lgkmcnt(9)
  ds_read_b64 a[198:199], v123 offset:32
  ds_read_b64_tr_b16 a[180:181], v122 offset:4096
  s_lshl_b32 s63, s51, 10
  v_mfma_f32_16x16x32_bf16 v[24:27], a[20:23], v[104:107], v[24:27]
  s_add_u32 s24, s24, 4096
  ds_read_b128 v[92:95], v12 offset:2048
  ds_read_b64_tr_b16 a[182:183], v122 offset:6144
  s_lshl_b32 s62, s53, 4
  v_mfma_f32_16x16x32_bf16 v[36:39], v[104:107], a[24:27], v[36:39]
  s_add_u32 s63, s63, s62
  ds_read_b128 v[96:99], v12 offset:22528
  ds_read_b64 a[200:201], v123 offset:64
  s_lshl_b32 s62, s3, 8
  v_mfma_f32_16x16x32_bf16 v[48:51], a[28:31], v[104:107], v[48:51]
  s_add_u32 s63, s63, s62
  ds_read_b128 v[100:103], v12 offset:43008
  ds_read_b64 a[202:203], v123 offset:96
  s_add_u32 s63, s63, 21823488
  v_mfma_f32_16x16x32_bf16 v[16:19], a[16:19], v[108:111], v[16:19]
  buffer_load_dwordx4 a[128:131], v1, s[12:15], s24 offen offset:0 sc1
  ds_read_b64_tr_b16 a[184:185], v122 offset:8192
  v_mfma_f32_16x16x32_bf16 v[28:31], a[20:23], v[108:111], v[28:31]
  ds_read_b64_tr_b16 a[186:187], v122 offset:10240
  ds_read_b64 a[204:205], v123 offset:128
  v_accvgpr_read_b32 v124, a240
  v_mfma_f32_16x16x32_bf16 v[40:43], v[108:111], a[24:27], v[40:43]
  buffer_load_dwordx4 a[132:135], v1, s[12:15], s24 offen offset:1024 sc1
  ds_read_b64 a[206:207], v123 offset:160
  s_waitcnt lgkmcnt(11)
  v_mfma_f32_16x16x32_bf16 v[116:119], a[176:179], a[196:199], 0
  ds_read_b64_tr_b16 a[188:189], v122 offset:12288
  ds_read_b64_tr_b16 a[190:191], v122 offset:14336
  v_accvgpr_read_b32 v125, a241
  v_mfma_f32_16x16x32_bf16 v[52:55], a[28:31], v[108:111], v[52:55]
  ds_read_b64 a[208:209], v123 offset:192
  ds_read_b64 a[210:211], v123 offset:224
  v_accvgpr_read_b32 v126, a242
  v_mfma_f32_16x16x32_bf16 v[20:23], a[16:19], v[112:115], v[20:23]
  buffer_load_dwordx4 a[136:139], v1, s[12:15], s24 offen offset:2048 sc1
  ds_read_b64_tr_b16 a[192:193], v122 offset:16384
  s_waitcnt lgkmcnt(9)
  v_mfma_f32_16x16x32_bf16 v[116:119], a[180:183], a[200:203], v[116:119]
  ds_read_b64_tr_b16 a[194:195], v122 offset:18432
  ds_read_b64 a[212:213], v123 offset:256
  v_lshlrev_b32 v122, 6, v3
  v_mfma_f32_16x16x32_bf16 v[32:35], a[20:23], v[112:115], v[32:35]
  ds_read_b64 a[214:215], v123 offset:288
  v_cndmask_b32 v123, v11, v122, vcc
  s_cmp_lt_u32 s43, 104
  s_cselect_b32 s63, s63, s14
  v_mfma_f32_16x16x32_bf16 v[44:47], v[112:115], a[24:27], v[44:47]
  s_cmp_eq_u32 s3, 3
  s_cbranch_scc1 SK11
  buffer_load_dwordx4 a[140:143], v1, s[12:15], s24 offen offset:3072 sc1
SK11:
  v_accvgpr_read_b32 v127, a243
  v_accvgpr_read_b32 v128, a244
  s_waitcnt lgkmcnt(8)
  v_mfma_f32_16x16x32_bf16 v[116:119], a[184:187], a[204:207], v[116:119]
  s_add_u32 s24, s24, 4096
  v_accvgpr_read_b32 v129, a245
  v_accvgpr_read_b32 v130, a246
  v_accvgpr_read_b32 v131, a247
  v_accvgpr_read_b32 v132, a248
  v_mfma_f32_16x16x32_bf16 v[56:59], a[28:31], v[112:115], v[56:59]
  v_accvgpr_read_b32 v133, a249
  v_accvgpr_read_b32 v134, a250
  v_accvgpr_read_b32 v135, a251
  v_fma_f32 v208, v208, v68, v60
  s_waitcnt lgkmcnt(4)
  v_mfma_f32_16x16x32_bf16 v[116:119], a[188:191], a[208:211], v[116:119]
  v_fma_f32 v209, v209, v69, v61
  v_fma_f32 v210, v210, v70, v62
  v_fma_f32 v211, v211, v71, v63
  v_fma_f32 v212, v212, v72, v64
  v_mfma_f32_16x16x32_bf16 v[24:27], a[36:39], v[92:95], v[24:27]
  ds_read_b128 v[104:107], v13 offset:3072
  v_fma_f32 v213, v213, v73, v65
  v_fma_f32 v214, v214, v74, v66
  v_fma_f32 v215, v215, v75, v67
  v_mfma_f32_16x16x32_bf16 v[36:39], v[92:95], a[40:43], v[36:39]
  ds_read_b128 v[108:111], v13 offset:23552
  v_cvt_pk_bf16_f32 v208, v208, v209
  v_cvt_pk_bf16_f32 v209, v210, v211
  v_cvt_pk_bf16_f32 v210, v212, v213
  s_waitcnt lgkmcnt(2)
  v_mfma_f32_16x16x32_bf16 v[116:119], a[192:195], a[212:215], v[116:119]
  v_cvt_pk_bf16_f32 v211, v214, v215
  v_fma_f32 v168, v168, v68, v60
  v_fma_f32 v169, v169, v69, v61
  v_fma_f32 v170, v170, v70, v62
  v_mfma_f32_16x16x32_bf16 v[48:51], a[44:47], v[92:95], v[48:51]
  ds_read_b128 v[112:115], v13 offset:44032
  ds_write_b128 v9, v[208:211] offset:16384
  v_mfma_f32_16x16x32_bf16 v[16:19], a[32:35], v[96:99], v[16:19]
  buffer_load_dwordx4 a[144:147], v1, s[12:15], s24 offen offset:0 sc1
  buffer_store_dwordx4 v[116:119], v123, s[12:15], s63 offen sc1
  v_mfma_f32_16x16x32_bf16 v[28:31], a[36:39], v[96:99], v[28:31]
  v_fma_f32 v171, v171, v71, v63
  v_fma_f32 v172, v172, v72, v64
  v_fma_f32 v173, v173, v73, v65
  v_fma_f32 v174, v174, v74, v66
  v_mfma_f32_16x16x32_bf16 v[40:43], v[96:99], a[40:43], v[40:43]
  buffer_load_dwordx4 a[148:151], v1, s[12:15], s24 offen offset:1024 sc1
  v_fma_f32 v175, v175, v75, v67
  v_cvt_pk_bf16_f32 v168, v168, v169
  v_mfma_f32_16x16x32_bf16 v[52:55], a[44:47], v[96:99], v[52:55]
  v_cvt_pk_bf16_f32 v169, v170, v171
  v_cvt_pk_bf16_f32 v170, v172, v173
  v_cvt_pk_bf16_f32 v171, v174, v175
  v_fma_f32 v200, v200, v84, v76
  v_mfma_f32_16x16x32_bf16 v[20:23], a[32:35], v[100:103], v[20:23]
  buffer_load_dwordx4 a[152:155], v1, s[12:15], s24 offen offset:2048 sc1
  ds_write_b128 v8, v[168:171] offset:16384
  v_mfma_f32_16x16x32_bf16 v[32:35], a[36:39], v[100:103], v[32:35]
  ds_read_b128 v[60:63], v15 offset:1024
  ds_read_b128 v[64:67], v15 offset:1280
  v_fma_f32 v201, v201, v85, v77
  v_mfma_f32_16x16x32_bf16 v[44:47], v[100:103], a[40:43], v[44:47]
  s_cmp_eq_u32 s3, 3
  s_cbranch_scc1 SK12
  buffer_load_dwordx4 a[156:159], v1, s[12:15], s24 offen offset:3072 sc1
SK12:
  ds_read_b128 v[68:71], v15 offset:3584
  v_mfma_f32_16x16x32_bf16 v[56:59], a[44:47], v[100:103], v[56:59]
  s_waitcnt vmcnt(19) lgkmcnt(5)
  ds_read_b128 v[72:75], v15 offset:3840
  v_fma_f32 v202, v202, v86, v78
  v_fma_f32 v203, v203, v87, v79
  v_fma_f32 v204, v204, v88, v80
  v_mfma_f32_16x16x32_bf16 v[24:27], a[52:55], v[104:107], v[24:27]
  s_add_u32 s24, s24, 4096
  ds_read_b128 v[92:95], v12 offset:4096
  v_fma_f32 v205, v205, v89, v81
  v_fma_f32 v206, v206, v90, v82
  v_fma_f32 v207, v207, v91, v83
  v_mfma_f32_16x16x32_bf16 v[36:39], v[104:107], a[56:59], v[36:39]
  s_sub_u32 s24, s24, s38
  ds_read_b128 v[96:99], v12 offset:24576
  v_cvt_pk_bf16_f32 v200, v200, v201
  v_cvt_pk_bf16_f32 v201, v202, v203
  v_cvt_pk_bf16_f32 v202, v204, v205
  v_mfma_f32_16x16x32_bf16 v[48:51], a[60:63], v[104:107], v[48:51]
  ds_read_b128 v[100:103], v12 offset:45056
  v_cvt_pk_bf16_f32 v203, v206, v207
  v_fma_f32 v160, v160, v84, v76
  v_fma_f32 v161, v161, v85, v77
  v_mfma_f32_16x16x32_bf16 v[16:19], a[48:51], v[108:111], v[16:19]
  buffer_load_dwordx4 a[160:163], v1, s[12:15], s24 offen offset:0 sc1
  ds_write_b128 v9, v[200:203] offset:12288
  v_mfma_f32_16x16x32_bf16 v[28:31], a[52:55], v[108:111], v[28:31]
  v_fma_f32 v162, v162, v86, v78
  v_fma_f32 v163, v163, v87, v79
  v_fma_f32 v164, v164, v88, v80
  v_fma_f32 v165, v165, v89, v81
  v_mfma_f32_16x16x32_bf16 v[40:43], v[108:111], a[56:59], v[40:43]
  buffer_load_dwordx4 a[164:167], v1, s[12:15], s24 offen offset:1024 sc1
  v_fma_f32 v166, v166, v90, v82
  v_fma_f32 v167, v167, v91, v83
  v_mfma_f32_16x16x32_bf16 v[52:55], a[60:63], v[108:111], v[52:55]
  v_cvt_pk_bf16_f32 v160, v160, v161
  v_cvt_pk_bf16_f32 v161, v162, v163
  v_cvt_pk_bf16_f32 v162, v164, v165
  v_cvt_pk_bf16_f32 v163, v166, v167
  v_mfma_f32_16x16x32_bf16 v[20:23], a[48:51], v[112:115], v[20:23]
  buffer_load_dwordx4 a[168:171], v1, s[12:15], s24 offen offset:2048 sc1
  ds_write_b128 v8, v[160:163] offset:12288
  v_mfma_f32_16x16x32_bf16 v[32:35], a[52:55], v[112:115], v[32:35]
  ds_read_b128 v[76:79], v15 offset:512
  ds_read_b128 v[80:83], v15 offset:768
  s_waitcnt lgkmcnt(8)
  v_fma_f32 v192, v192, v68, v60
  v_mfma_f32_16x16x32_bf16 v[44:47], v[112:115], a[56:59], v[44:47]
  s_cmp_eq_u32 s3, 3
  s_cbranch_scc1 SK13
  buffer_load_dwordx4 a[172:175], v1, s[12:15], s24 offen offset:3072 sc1
SK13:
  ds_read_b128 v[84:87], v15 offset:3072
  v_mfma_f32_16x16x32_bf16 v[56:59], a[60:63], v[112:115], v[56:59]
  s_waitcnt vmcnt(19) lgkmcnt(5)
  ds_read_b128 v[88:91], v15 offset:3328
  v_fma_f32 v193, v193, v69, v61
  v_fma_f32 v194, v194, v70, v62
  v_fma_f32 v195, v195, v71, v63
  v_mfma_f32_16x16x32_bf16 v[24:27], a[68:71], v[92:95], v[24:27]
  s_add_u32 s24, s24, 4096
  ds_read_b128 v[104:107], v13 offset:5120
  v_fma_f32 v196, v196, v72, v64
  v_fma_f32 v197, v197, v73, v65
  v_fma_f32 v198, v198, v74, v66
  v_mfma_f32_16x16x32_bf16 v[36:39], v[92:95], a[72:75], v[36:39]
  ds_read_b128 v[108:111], v13 offset:25600
  v_fma_f32 v199, v199, v75, v67
  v_cvt_pk_bf16_f32 v192, v192, v193
  v_cvt_pk_bf16_f32 v193, v194, v195
  v_mfma_f32_16x16x32_bf16 v[48:51], a[76:79], v[92:95], v[48:51]
  ds_read_b128 v[112:115], v13 offset:46080
  v_cvt_pk_bf16_f32 v194, v196, v197
  v_cvt_pk_bf16_f32 v195, v198, v199
  v_fma_f32 v152, v152, v68, v60
  v_mfma_f32_16x16x32_bf16 v[16:19], a[64:67], v[96:99], v[16:19]
  buffer_load_dwordx4 a[176:179], v1, s[12:15], s24 offen offset:0 sc1
  ds_write_b128 v9, v[192:195] offset:8192
  v_mfma_f32_16x16x32_bf16 v[28:31], a[68:71], v[96:99], v[28:31]
  v_fma_f32 v153, v153, v69, v61
  v_fma_f32 v154, v154, v70, v62
  v_fma_f32 v155, v155, v71, v63
  v_fma_f32 v156, v156, v72, v64
  v_mfma_f32_16x16x32_bf16 v[40:43], v[96:99], a[72:75], v[40:43]
  buffer_load_dwordx4 a[180:183], v1, s[12:15], s24 offen offset:1024 sc1
  v_fma_f32 v157, v157, v73, v65
  v_fma_f32 v158, v158, v74, v66
  v_mfma_f32_16x16x32_bf16 v[52:55], a[76:79], v[96:99], v[52:55]
  v_fma_f32 v159, v159, v75, v67
  v_cvt_pk_bf16_f32 v152, v152, v153
  v_cvt_pk_bf16_f32 v153, v154, v155
  v_cvt_pk_bf16_f32 v154, v156, v157
  v_mfma_f32_16x16x32_bf16 v[20:23], a[64:67], v[100:103], v[20:23]
  buffer_load_dwordx4 a[184:187], v1, s[12:15], s24 offen offset:2048 sc1
  v_cvt_pk_bf16_f32 v155, v158, v159
  s_waitcnt lgkmcnt(5)
  v_fma_f32 v184, v184, v84, v76
  v_mfma_f32_16x16x32_bf16 v[32:35], a[68:71], v[100:103], v[32:35]
  ds_write_b128 v8, v[152:155] offset:8192
  ds_read_b128 v[60:63], v15 offset:0
  v_mfma_f32_16x16x32_bf16 v[44:47], v[100:103], a[72:75], v[44:47]
  s_cmp_eq_u32 s3, 3
  s_cbranch_scc1 SK14
  buffer_load_dwordx4 a[188:191], v1, s[12:15], s24 offen offset:3072 sc1
SK14:
  ds_read_b128 v[64:67], v15 offset:256
  v_mfma_f32_16x16x32_bf16 v[56:59], a[76:79], v[100:103], v[56:59]
  s_waitcnt vmcnt(19) lgkmcnt(4)
  ds_read_b128 v[68:71], v15 offset:2560
  ds_read_b128 v[72:75], v15 offset:2816
  v_fma_f32 v185, v185, v85, v77
  v_mfma_f32_16x16x32_bf16 v[24:27], a[84:87], v[104:107], v[24:27]
  s_add_u32 s24, s24, 4096
  ds_read_b128 v[92:95], v12 offset:6144
  v_fma_f32 v186, v186, v86, v78
  v_mfma_f32_16x16x32_bf16 v[36:39], v[104:107], a[88:91], v[36:39]
  ds_read_b128 v[96:99], v12 offset:26624
  v_fma_f32 v187, v187, v87, v79
  v_mfma_f32_16x16x32_bf16 v[48:51], a[92:95], v[104:107], v[48:51]
  ds_read_b128 v[100:103], v12 offset:47104
  v_fma_f32 v188, v188, v88, v80
  v_mfma_f32_16x16x32_bf16 v[16:19], a[80:83], v[108:111], v[16:19]
  buffer_load_dwordx4 a[192:195], v1, s[12:15], s24 offen offset:0 sc1
  v_mfma_f32_16x16x32_bf16 v[28:31], a[84:87], v[108:111], v[28:31]
  v_fma_f32 v189, v189, v89, v81
  v_fma_f32 v190, v190, v90, v82
  v_mfma_f32_16x16x32_bf16 v[40:43], v[108:111], a[88:91], v[40:43]
  buffer_load_dwordx4 a[196:199], v1, s[12:15], s24 offen offset:1024 sc1
  v_mfma_f32_16x16x32_bf16 v[52:55], a[92:95], v[108:111], v[52:55]
  v_fma_f32 v191, v191, v91, v83
  v_cvt_pk_bf16_f32 v184, v184, v185
  v_mfma_f32_16x16x32_bf16 v[20:23], a[80:83], v[112:115], v[20:23]
  buffer_load_dwordx4 a[200:203], v1, s[12:15], s24 offen offset:2048 sc1
  v_mfma_f32_16x16x32_bf16 v[32:35], a[84:87], v[112:115], v[32:35]
  v_cvt_pk_bf16_f32 v185, v186, v187
  v_cvt_pk_bf16_f32 v186, v188, v189
  v_mfma_f32_16x16x32_bf16 v[44:47], v[112:115], a[88:91], v[44:47]
  s_cmp_eq_u32 s3, 3
  s_cbranch_scc1 SK15
  buffer_load_dwordx4 a[204:207], v1, s[12:15], s24 offen offset:3072 sc1
SK15:
  v_mfma_f32_16x16x32_bf16 v[56:59], a[92:95], v[112:115], v[56:59]
  s_waitcnt vmcnt(19) lgkmcnt(0)
  v_cvt_pk_bf16_f32 v187, v190, v191
  v_fma_f32 v144, v144, v84, v76
  v_mfma_f32_16x16x32_bf16 v[24:27], a[100:103], v[92:95], v[24:27]
  s_add_u32 s24, s24, 4096
  ds_read_b128 v[104:107], v13 offset:7168
  v_fma_f32 v145, v145, v85, v77
  v_mfma_f32_16x16x32_bf16 v[36:39], v[92:95], a[104:107], v[36:39]
  ds_read_b128 v[108:111], v13 offset:27648
  v_fma_f32 v146, v146, v86, v78
  v_mfma_f32_16x16x32_bf16 v[48:51], a[108:111], v[92:95], v[48:51]
  ds_read_b128 v[112:115], v13 offset:48128
  v_fma_f32 v147, v147, v87, v79
  v_mfma_f32_16x16x32_bf16 v[16:19], a[96:99], v[96:99], v[16:19]
  buffer_load_dwordx4 a[208:211], v1, s[12:15], s24 offen offset:0 sc1
  v_mfma_f32_16x16x32_bf16 v[28:31], a[100:103], v[96:99], v[28:31]
  ds_write_b128 v9, v[184:187] offset:4096
  v_mfma_f32_16x16x32_bf16 v[40:43], v[96:99], a[104:107], v[40:43]
  buffer_load_dwordx4 a[212:215], v1, s[12:15], s24 offen offset:1024 sc1
  v_mfma_f32_16x16x32_bf16 v[52:55], a[108:111], v[96:99], v[52:55]
  v_fma_f32 v148, v148, v88, v80
  v_fma_f32 v149, v149, v89, v81
  v_mfma_f32_16x16x32_bf16 v[20:23], a[96:99], v[100:103], v[20:23]
  buffer_load_dwordx4 a[216:219], v1, s[12:15], s24 offen offset:2048 sc1
  v_mfma_f32_16x16x32_bf16 v[32:35], a[100:103], v[100:103], v[32:35]
  v_fma_f32 v150, v150, v90, v82
  v_fma_f32 v151, v151, v91, v83
  v_mfma_f32_16x16x32_bf16 v[44:47], v[100:103], a[104:107], v[44:47]
  s_cmp_eq_u32 s3, 3
  s_cbranch_scc1 SK16
  buffer_load_dwordx4 a[220:223], v1, s[12:15], s24 offen offset:3072 sc1
SK16:
  v_mfma_f32_16x16x32_bf16 v[56:59], a[108:111], v[100:103], v[56:59]
  s_waitcnt vmcnt(19) lgkmcnt(1)
  v_cvt_pk_bf16_f32 v144, v144, v145
  v_cvt_pk_bf16_f32 v145, v146, v147
  s_add_u32 s24, s24, 4096
  s_waitcnt vmcnt(14)
  s_barrier
  s_cmp_lg_u32 s3, 0
  s_cbranch_scc1 SK17
  s_lshl_b32 s26, s2, 2
  s_add_u32 s26, s26, 34816
  buffer_store_dword v14, v10, s[12:15], s26 offen sc1
SK17:
  v_mfma_f32_16x16x32_bf16 v[24:27], a[116:119], v[104:107], v[24:27]
  s_mul_i32 s61, s5, 7
  ds_read_b128 v[92:95], v12 offset:8192
  s_mul_i32 s62, s5, 6
  v_mfma_f32_16x16x32_bf16 v[36:39], v[104:107], a[120:123], v[36:39]
  s_add_u32 s62, s62, 6
  ds_read_b128 v[96:99], v12 offset:28672
  s_and_b32 s50, s4, 0
  v_mfma_f32_16x16x32_bf16 v[48:51], a[124:127], v[104:107], v[48:51]
  s_movk_i32 s42, 2048
  ds_read_b128 v[100:103], v12 offset:49152
  s_mul_i32 s26, s5, 102400
  v_mfma_f32_16x16x32_bf16 v[16:19], a[112:115], v[108:111], v[16:19]
  buffer_load_dwordx4 a[224:227], v1, s[12:15], s24 offen offset:0 sc1
  v_mfma_f32_16x16x32_bf16 v[28:31], a[116:119], v[108:111], v[28:31]
  s_cmp_ge_u32 s5, 6
  s_cselect_b32 s61, s62, s61
  s_cselect_b32 s101, 6, 7
  v_mfma_f32_16x16x32_bf16 v[40:43], v[108:111], a[120:123], v[40:43]
  buffer_load_dwordx4 a[228:231], v1, s[12:15], s24 offen offset:1024 sc1
  v_mfma_f32_16x16x32_bf16 v[52:55], a[124:127], v[108:111], v[52:55]
  s_lshl_b32 s62, s3, 1
  s_cmp_eq_u32 s3, 3
  s_cselect_b32 s50, 0, s50
  v_mfma_f32_16x16x32_bf16 v[20:23], a[112:115], v[112:115], v[20:23]
  s_add_u32 s62, s62, 0
  s_xor_b32 s62, s62, s50
  s_add_u32 s98, s62, s61
  v_mfma_f32_16x16x32_bf16 v[32:35], a[116:119], v[112:115], v[32:35]
  s_mul_i32 s53, s98, 40960
  s_cmp_lt_u32 s62, s101
  s_cselect_b32 s62, 0, 1879048192
  v_mfma_f32_16x16x32_bf16 v[44:47], v[112:115], a[120:123], v[44:47]
  buffer_load_dwordx4 a[232:235], v1, s[12:15], s24 offen offset:2048 sc1
  v_mfma_f32_16x16x32_bf16 v[56:59], a[124:127], v[112:115], v[56:59]
  s_waitcnt lgkmcnt(0)
  v_add_u32 v11, s62, v1
  s_add_u32 s53, s53, 3506176
  v_mfma_f32_16x16x32_bf16 v[24:27], a[132:135], v[92:95], v[24:27]
  s_lshl_b32 s62, s3, 1
  ds_read_b128 v[104:107], v13 offset:9216
  s_add_u32 s62, s62, 1
  v_mfma_f32_16x16x32_bf16 v[36:39], v[92:95], a[136:139], v[36:39]
  s_xor_b32 s62, s62, s50
  ds_read_b128 v[108:111], v13 offset:29696
  s_add_u32 s99, s62, s61
  v_mfma_f32_16x16x32_bf16 v[48:51], a[140:143], v[92:95], v[48:51]
  s_mul_i32 s27, s99, 40960
  ds_read_b128 v[112:115], v13 offset:50176
  v_add_u32 v12, s39, v12
  v_mfma_f32_16x16x32_bf16 v[16:19], a[128:131], v[96:99], v[16:19]
  s_add_u32 s27, s27, 3506176
  s_mul_i32 s62, s5, 276480
  s_add_u32 s62, s62, 5945344
  v_mfma_f32_16x16x32_bf16 v[28:31], a[132:135], v[96:99], v[28:31]
  s_lshl_b32 s63, s5, 2
  s_add_u32 s63, s63, s3
  s_lshl_b32 s96, s63, 9
  v_mfma_f32_16x16x32_bf16 v[40:43], v[96:99], a[136:139], v[40:43]
  s_cmp_eq_u32 s3, 3
  s_cbranch_scc1 SK18
  buffer_load_dwordx4 a[236:239], v1, s[12:15], s24 offen offset:3072 sc1
SK18:
  v_mfma_f32_16x16x32_bf16 v[52:55], a[140:143], v[96:99], v[52:55]
  s_add_u32 s24, s24, 4096
  s_lshr_b32 s95, s63, 1
  s_lshl_b32 s95, s95, 8
  v_mfma_f32_16x16x32_bf16 v[20:23], a[128:131], v[100:103], v[20:23]
  s_and_b32 s63, s63, 1
  s_lshl_b32 s63, s63, 3
  s_add_u32 s95, s95, s63
  v_mfma_f32_16x16x32_bf16 v[32:35], a[132:135], v[100:103], v[32:35]
  s_cmp_eq_u32 s3, 3
  s_cselect_b32 s27, s62, s27
  s_cmov_b32 s42, 4096
  v_mfma_f32_16x16x32_bf16 v[44:47], v[100:103], a[136:139], v[44:47]
  buffer_load_dwordx4 a[240:243], v1, s[12:15], s24 offen offset:0 sc1
  v_mfma_f32_16x16x32_bf16 v[56:59], a[140:143], v[100:103], v[56:59]
  s_waitcnt vmcnt(16) lgkmcnt(0)
  s_mul_i32 s62, s3, 25600
  s_add_u32 s26, s26, s62
  v_mfma_f32_16x16x32_bf16 v[24:27], a[148:151], v[104:107], v[24:27]
  s_add_u32 s26, s26, 2686976
  ds_read_b128 v[92:95], v12 offset:0
  s_mul_i32 s62, s3, 10240
  v_mfma_f32_16x16x32_bf16 v[36:39], v[104:107], a[152:155], v[36:39]
  s_add_u32 m0, s62, 112704
  ds_read_b128 v[96:99], v12 offset:20480
  s_mul_i32 s62, s4, 81920
  v_mfma_f32_16x16x32_bf16 v[48:51], a[156:159], v[104:107], v[48:51]
  s_add_u32 s62, s62, 7929856
  ds_read_b128 v[100:103], v12 offset:40960
  v_add_u32 v13, s39, v13
  v_mfma_f32_16x16x32_bf16 v[16:19], a[144:147], v[108:111], v[16:19]
  buffer_load_dwordx4 a[244:247], v1, s[12:15], s24 offen offset:1024 sc1
  v_mfma_f32_16x16x32_bf16 v[28:31], a[148:151], v[108:111], v[28:31]
  s_add_u32 s96, s96, s62
  s_add_u32 s95, s95, s62
  s_add_u32 s95, s95, 16384
  v_mfma_f32_16x16x32_bf16 v[40:43], v[108:111], a[152:155], v[40:43]
  buffer_load_dwordx4 a[248:251], v1, s[12:15], s24 offen offset:2048 sc1
  v_mfma_f32_16x16x32_bf16 v[52:55], a[156:159], v[108:111], v[52:55]
  v_cvt_pk_bf16_f32 v146, v148, v149
  v_cvt_pk_bf16_f32 v147, v150, v151
  v_mfma_f32_16x16x32_bf16 v[20:23], a[144:147], v[112:115], v[20:23]
  ds_write_b128 v8, v[144:147] offset:4096
  v_mfma_f32_16x16x32_bf16 v[32:35], a[148:151], v[112:115], v[32:35]
  v_fma_f32 v176, v176, v68, v60
  v_fma_f32 v177, v177, v69, v61
  v_mfma_f32_16x16x32_bf16 v[44:47], v[112:115], a[152:155], v[44:47]
  s_cmp_eq_u32 s3, 3
  s_cbranch_scc1 SK19
  buffer_load_dwordx4 a[252:255], v1, s[12:15], s24 offen offset:3072 sc1
SK19:
  v_mfma_f32_16x16x32_bf16 v[56:59], a[156:159], v[112:115], v[56:59]
  s_waitcnt vmcnt(15) lgkmcnt(1)
  v_fma_f32 v178, v178, v70, v62
  v_fma_f32 v179, v179, v71, v63
  s_mov_b32 s25, 33792
  buffer_load_dwordx4 v[116:119], v1, s[12:15], s25 offen sc1
  v_mfma_f32_16x16x32_bf16 v[24:27], a[164:167], v[92:95], v[24:27]
  s_add_u32 s24, s24, 4096
  ds_read_b128 v[104:107], v13 offset:1024
  v_fma_f32 v180, v180, v72, v64
  v_mfma_f32_16x16x32_bf16 v[36:39], v[92:95], a[168:171], v[36:39]
  ds_read_b128 v[108:111], v13 offset:21504
  v_fma_f32 v181, v181, v73, v65
  v_mfma_f32_16x16x32_bf16 v[48:51], a[172:175], v[92:95], v[48:51]
  ds_read_b128 v[112:115], v13 offset:41984
  v_fma_f32 v182, v182, v74, v66
  v_mfma_f32_16x16x32_bf16 v[16:19], a[160:163], v[96:99], v[16:19]
  v_fma_f32 v183, v183, v75, v67
  v_cvt_pk_bf16_f32 v176, v176, v177
  v_mfma_f32_16x16x32_bf16 v[28:31], a[164:167], v[96:99], v[28:31]
  v_cvt_pk_bf16_f32 v177, v178, v179
  v_cvt_pk_bf16_f32 v178, v180, v181
  v_mfma_f32_16x16x32_bf16 v[40:43], v[96:99], a[168:171], v[40:43]
  buffer_load_dwordx4 v[192:195], v1, s[12:15], s24 offen offset:0 sc1
  v_mfma_f32_16x16x32_bf16 v[52:55], a[172:175], v[96:99], v[52:55]
  v_cvt_pk_bf16_f32 v179, v182, v183
  v_fma_f32 v136, v136, v68, v60
  v_mfma_f32_16x16x32_bf16 v[20:23], a[160:163], v[100:103], v[20:23]
  ds_write_b128 v9, v[176:179] offset:0
  v_mfma_f32_16x16x32_bf16 v[32:35], a[164:167], v[100:103], v[32:35]
  v_fma_f32 v137, v137, v69, v61
  v_fma_f32 v138, v138, v70, v62
  v_mfma_f32_16x16x32_bf16 v[44:47], v[100:103], a[168:171], v[44:47]
  buffer_load_dwordx4 v[196:199], v1, s[12:15], s24 offen offset:1024 sc1
  v_mfma_f32_16x16x32_bf16 v[56:59], a[172:175], v[100:103], v[56:59]
  s_waitcnt vmcnt(15) lgkmcnt(1)
  v_fma_f32 v139, v139, v71, v63
  v_fma_f32 v140, v140, v72, v64
  v_mfma_f32_16x16x32_bf16 v[24:27], a[180:183], v[104:107], v[24:27]
  ds_read_b128 v[92:95], v12 offset:2048
  v_fma_f32 v141, v141, v73, v65
  v_mfma_f32_16x16x32_bf16 v[36:39], v[104:107], a[184:187], v[36:39]
  ds_read_b128 v[96:99], v12 offset:22528
  v_fma_f32 v142, v142, v74, v66
  v_mfma_f32_16x16x32_bf16 v[48:51], a[188:191], v[104:107], v[48:51]
  ds_read_b128 v[100:103], v12 offset:43008
  v_fma_f32 v143, v143, v75, v67
  v_mfma_f32_16x16x32_bf16 v[16:19], a[176:179], v[108:111], v[16:19]
  buffer_load_dwordx4 v[200:203], v1, s[12:15], s24 offen offset:2048 sc1
  v_mfma_f32_16x16x32_bf16 v[28:31], a[180:183], v[108:111], v[28:31]
  v_cvt_pk_bf16_f32 v136, v136, v137
  v_cvt_pk_bf16_f32 v137, v138, v139
  v_mfma_f32_16x16x32_bf16 v[40:43], v[108:111], a[184:187], v[40:43]
  s_cmp_eq_u32 s3, 3
  s_cbranch_scc1 SK20
  buffer_load_dwordx4 v[204:207], v1, s[12:15], s24 offen offset:3072 sc1
SK20:
  v_mfma_f32_16x16x32_bf16 v[52:55], a[188:191], v[108:111], v[52:55]
  s_add_u32 s24, s24, 4096
  v_cvt_pk_bf16_f32 v138, v140, v141
  v_cvt_pk_bf16_f32 v139, v142, v143
  v_mfma_f32_16x16x32_bf16 v[20:23], a[176:179], v[112:115], v[20:23]
  ds_write_b128 v8, v[136:139] offset:0
  v_mfma_f32_16x16x32_bf16 v[32:35], a[180:183], v[112:115], v[32:35]
  s_mul_i32 s7, s3, 2560
  v_mov_b32 v180, v124
  v_mov_b32 v181, v125
  v_mfma_f32_16x16x32_bf16 v[44:47], v[112:115], a[184:187], v[44:47]
  buffer_load_dwordx4 v[208:211], v1, s[12:15], s24 offen offset:0 sc1
  v_mfma_f32_16x16x32_bf16 v[56:59], a[188:191], v[112:115], v[56:59]
  s_waitcnt vmcnt(14) lgkmcnt(1)
  v_mov_b32 v182, v126
  v_mov_b32 v183, v127
  v_mfma_f32_16x16x32_bf16 v[24:27], a[196:199], v[92:95], v[24:27]
  s_add_u32 s7, s7, 102400
  ds_read_b128 v[104:107], v13 offset:3072
  v_mov_b32 v184, v128
  v_mfma_f32_16x16x32_bf16 v[36:39], v[92:95], a[200:203], v[36:39]
  ds_read_b128 v[108:111], v13 offset:23552
  v_mov_b32 v185, v129
  v_mfma_f32_16x16x32_bf16 v[48:51], a[204:207], v[92:95], v[48:51]
  ds_read_b128 v[112:115], v13 offset:44032
  v_mov_b32 v186, v130
  v_mfma_f32_16x16x32_bf16 v[16:19], a[192:195], v[96:99], v[16:19]
  v_mov_b32 v187, v131
  v_mov_b32 v188, v132
  v_mfma_f32_16x16x32_bf16 v[28:31], a[196:199], v[96:99], v[28:31]
  v_mov_b32 v189, v133
  v_mov_b32 v190, v134
  v_mfma_f32_16x16x32_bf16 v[40:43], v[96:99], a[200:203], v[40:43]
  buffer_load_dwordx4 v[212:215], v1, s[12:15], s24 offen offset:1024 sc1
  v_mfma_f32_16x16x32_bf16 v[52:55], a[204:207], v[96:99], v[52:55]
  v_mov_b32 v191, v135
  v_mov_b32 v148, s100
  v_mfma_f32_16x16x32_bf16 v[20:23], a[192:195], v[100:103], v[20:23]
  v_mov_b32 v149, s100
  v_mov_b32 v150, s100
  v_mfma_f32_16x16x32_bf16 v[32:35], a[196:199], v[100:103], v[32:35]
  v_mov_b32 v151, s100
  v_lshlrev_b32 v4, 3, v2
  v_mfma_f32_16x16x32_bf16 v[44:47], v[100:103], a[200:203], v[44:47]
  buffer_load_dwordx4 v[216:219], v1, s[12:15], s24 offen offset:2048 sc1
  v_mfma_f32_16x16x32_bf16 v[56:59], a[204:207], v[100:103], v[56:59]
  s_waitcnt vmcnt(13) lgkmcnt(0)
  s_cmp_eq_u32 s3, 3
  s_cselect_b32 s7, 110144, s7
  v_mfma_f32_16x16x32_bf16 v[24:27], a[212:215], v[104:107], v[24:27]
  ds_read_b128 v[92:95], v12 offset:4096
  v_add_u32 v174, s7, v4
  v_mfma_f32_16x16x32_bf16 v[36:39], v[104:107], a[216:219], v[36:39]
  ds_read_b128 v[96:99], v12 offset:24576
  v_lshlrev_b32 v7, 2, v3
  v_mfma_f32_16x16x32_bf16 v[48:51], a[220:223], v[104:107], v[48:51]
  ds_read_b128 v[100:103], v12 offset:45056
  v_sub_u32 v7, v5, v7
  v_mfma_f32_16x16x32_bf16 v[16:19], a[208:211], v[108:111], v[16:19]
  s_cmp_eq_u32 s3, 3
  s_cbranch_scc1 SK21
  buffer_load_dwordx4 v[220:223], v1, s[12:15], s24 offen offset:3072 sc1
SK21:
  v_mfma_f32_16x16x32_bf16 v[28:31], a[212:215], v[108:111], v[28:31]
  s_add_u32 s24, s24, 4096
  v_mov_b32 v6, 0xf149f2ca
  v_subrev_u32 v164, 0, v7
  v_mfma_f32_16x16x32_bf16 v[40:43], v[108:111], a[216:219], v[40:43]
  buffer_load_dwordx4 v[224:227], v1, s[12:15], s24 offen offset:0 sc1
  v_mfma_f32_16x16x32_bf16 v[52:55], a[220:223], v[108:111], v[52:55]
  v_cmp_gt_u32 s[58:59], 8, v164
  v_cmp_gt_i32 s[56:57], -8, v164
  v_mfma_f32_16x16x32_bf16 v[20:23], a[208:211], v[112:115], v[20:23]
  v_cndmask_b32_e64 v152, v6, 0, s[58:59]
  v_cndmask_b32_e64 v156, v6, 0, s[56:57]
  v_mfma_f32_16x16x32_bf16 v[32:35], a[212:215], v[112:115], v[32:35]
  v_subrev_u32 v164, 1, v7
  v_cmp_gt_u32 s[58:59], 8, v164
  v_mfma_f32_16x16x32_bf16 v[44:47], v[112:115], a[216:219], v[44:47]
  buffer_load_dwordx4 v[228:231], v1, s[12:15], s24 offen offset:1024 sc1
  v_mfma_f32_16x16x32_bf16 v[56:59], a[220:223], v[112:115], v[56:59]
  s_waitcnt vmcnt(12) lgkmcnt(0)
  v_cmp_gt_i32 s[56:57], -8, v164
  v_cndmask_b32_e64 v153, v6, 0, s[58:59]
  s_mov_b32 s61, 0
  s_waitcnt vmcnt(8)
  v_xor_b32 v116, s94, v116
  v_xor_b32 v117, s94, v117
  v_xor_b32 v118, s94, v118
  v_xor_b32 v119, s94, v119
  v_or3_b32 v116, v116, v117, v118
  v_or_b32 v116, v116, v119
  v_cmp_ne_u32 vcc, 0, v116
  s_nop 3
  s_cbranch_vccz SYB_DONE
SYB:
  s_sleep 8
  buffer_load_dwordx4 v[116:119], v1, s[12:15], s25 offen sc1
  s_waitcnt vmcnt(0)
  v_xor_b32 v116, s94, v116
  v_xor_b32 v117, s94, v117
  v_xor_b32 v118, s94, v118
  v_xor_b32 v119, s94, v119
  v_or3_b32 v116, v116, v117, v118
  v_or_b32 v116, v116, v119
  v_cmp_ne_u32 vcc, 0, v116
  s_add_u32 s61, s61, 1
  s_cmp_gt_u32 s61, 262144
  s_cbranch_scc1 SYB_DONE
  s_nop 3
  s_cbranch_vccnz SYB
SYB_DONE:
  s_cmp_lg_u32 s2, 0
  s_cbranch_scc1 SK22
  s_mov_b32 s25, 49152
  buffer_store_dword v14, v10, s[12:15], s25 offen sc1
SK22:
  v_mfma_f32_16x16x32_bf16 v[24:27], a[228:231], v[92:95], v[24:27]
  ds_read_b128 v[104:107], v13 offset:5120
  v_cndmask_b32_e64 v157, v6, 0, s[56:57]
  v_mfma_f32_16x16x32_bf16 v[36:39], v[92:95], a[232:235], v[36:39]
  ds_read_b128 v[108:111], v13 offset:25600
  v_subrev_u32 v164, 2, v7
  v_mfma_f32_16x16x32_bf16 v[48:51], a[236:239], v[92:95], v[48:51]
  ds_read_b128 v[112:115], v13 offset:46080
  v_cmp_gt_u32 s[58:59], 8, v164
  v_mfma_f32_16x16x32_bf16 v[16:19], a[224:227], v[96:99], v[16:19]
  s_lshl_b32 s7, s3, 7
  v_cmp_gt_i32 s[56:57], -8, v164
  v_cndmask_b32_e64 v154, v6, 0, s[58:59]
  v_mfma_f32_16x16x32_bf16 v[28:31], a[228:231], v[96:99], v[28:31]
  s_add_u32 s7, s7, 107520
  v_cndmask_b32_e64 v158, v6, 0, s[56:57]
  v_subrev_u32 v164, 3, v7
  v_mfma_f32_16x16x32_bf16 v[40:43], v[96:99], a[232:235], v[40:43]
  buffer_load_dwordx4 v[232:235], v1, s[12:15], s24 offen offset:2048 sc1
  v_mfma_f32_16x16x32_bf16 v[52:55], a[236:239], v[96:99], v[52:55]
  v_cmp_gt_u32 s[58:59], 8, v164
  v_cmp_gt_i32 s[56:57], -8, v164
  v_mfma_f32_16x16x32_bf16 v[20:23], a[224:227], v[100:103], v[20:23]
  v_cndmask_b32_e64 v155, v6, 0, s[58:59]
  v_cndmask_b32_e64 v159, v6, 0, s[56:57]
  v_mfma_f32_16x16x32_bf16 v[32:35], a[228:231], v[100:103], v[32:35]
  v_cmp_gt_i32 s[56:57], -5, v7
  v_add_u32 v169, 102400, v4
  v_mfma_f32_16x16x32_bf16 v[44:47], v[100:103], a[232:235], v[44:47]
  s_cmp_eq_u32 s3, 3
  s_cbranch_scc1 SK23
  buffer_load_dwordx4 v[236:239], v1, s[12:15], s24 offen offset:3072 sc1
SK23:
  v_mfma_f32_16x16x32_bf16 v[56:59], a[236:239], v[100:103], v[56:59]
  s_waitcnt lgkmcnt(0)
  s_cmp_eq_u32 s4, 0
  s_cselect_b64 s[58:59], -1, 0
  v_mfma_f32_16x16x32_bf16 v[24:27], a[244:247], v[104:107], v[24:27]
  s_add_u32 s24, s24, 4096
  ds_read_b128 v[92:95], v12 offset:6144
  v_cndmask_b32_e64 v160, v156, v6, s[58:59]
  v_mfma_f32_16x16x32_bf16 v[36:39], v[104:107], a[248:251], v[36:39]
  ds_read_b128 v[96:99], v12 offset:26624
  v_cndmask_b32_e64 v161, v157, v6, s[58:59]
  v_mfma_f32_16x16x32_bf16 v[48:51], a[252:255], v[104:107], v[48:51]
  ds_read_b128 v[100:103], v12 offset:47104
  v_cndmask_b32_e64 v162, v158, v6, s[58:59]
  v_mfma_f32_16x16x32_bf16 v[16:19], a[240:243], v[108:111], v[16:19]
  buffer_load_dwordx4 v[240:243], v1, s[12:15], s24 offen offset:0 sc1
  v_mfma_f32_16x16x32_bf16 v[28:31], a[244:247], v[108:111], v[28:31]
  v_cndmask_b32_e64 v163, v159, v6, s[58:59]
  v_cmp_eq_u32 s[58:59], s3, v3
  v_mfma_f32_16x16x32_bf16 v[40:43], v[108:111], a[248:251], v[40:43]
  buffer_load_dwordx4 v[244:247], v1, s[12:15], s24 offen offset:1024 sc1
  v_mfma_f32_16x16x32_bf16 v[52:55], a[252:255], v[108:111], v[52:55]
  v_xor_b32 v164, 64, v169
  v_lshrrev_b32 v172, 2, v2
  v_mfma_f32_16x16x32_bf16 v[20:23], a[240:243], v[112:115], v[20:23]
  v_lshlrev_b32 v172, 3, v172
  v_add_u32 v172, s7, v172
  v_mfma_f32_16x16x32_bf16 v[32:35], a[244:247], v[112:115], v[32:35]
  v_xor_b32 v173, 64, v172
  v_mov_b32 v6, 110080
  v_mfma_f32_16x16x32_bf16 v[44:47], v[112:115], a[248:251], v[44:47]
  buffer_load_dwordx4 v[248:251], v1, s[12:15], s24 offen offset:2048 sc1
  v_mfma_f32_16x16x32_bf16 v[56:59], a[252:255], v[112:115], v[56:59]
  s_waitcnt vmcnt(9) lgkmcnt(0)
  v_add_u32 v7, 512, v169
  v_cndmask_b32_e64 v165, v6, v7, s[58:59]
  v_mfma_f32_16x16x32_bf16 v[24:27], v[196:199], v[92:95], v[24:27]
  ds_read_b128 v[104:107], v13 offset:7168
  v_add_u32 v7, 1024, v169
  v_mfma_f32_16x16x32_bf16 v[36:39], v[92:95], v[200:203], v[36:39]
  ds_read_b128 v[108:111], v13 offset:27648
  v_cndmask_b32_e64 v166, v6, v7, s[58:59]
  v_mfma_f32_16x16x32_bf16 v[48:51], v[204:207], v[92:95], v[48:51]
  ds_read_b128 v[112:115], v13 offset:48128
  v_add_u32 v7, 1536, v169
  v_mfma_f32_16x16x32_bf16 v[16:19], v[192:195], v[96:99], v[16:19]
  v_cndmask_b32_e64 v167, v6, v7, s[58:59]
  v_add_u32 v7, 2048, v169
  v_mfma_f32_16x16x32_bf16 v[28:31], v[196:199], v[96:99], v[28:31]
  v_cndmask_b32_e64 v168, v6, v7, s[58:59]
  v_and_b32 v6, 1, v3
  v_mfma_f32_16x16x32_bf16 v[40:43], v[96:99], v[200:203], v[40:43]
  s_cmp_eq_u32 s3, 3
  s_cbranch_scc1 SK24
  buffer_load_dwordx4 v[252:255], v1, s[12:15], s24 offen offset:3072 sc1
SK24:
  v_mfma_f32_16x16x32_bf16 v[52:55], v[204:207], v[96:99], v[52:55]
  s_add_u32 s24, s24, 4096
  v_cmp_eq_u32 s[58:59], 1, v6
  v_mul_u32_u24 v6, 20480, v6
  v_mfma_f32_16x16x32_bf16 v[20:23], v[192:195], v[100:103], v[20:23]
  v_lshl_add_u32 v6, v5, 4, v6
  v_lshrrev_b32 v7, 1, v3
  v_mfma_f32_16x16x32_bf16 v[32:35], v[196:199], v[100:103], v[32:35]
  v_lshl_add_u32 v175, v7, 8, v6
  v_mul_u32_u24 v7, 7340032, v7
  v_mfma_f32_16x16x32_bf16 v[44:47], v[100:103], v[200:203], v[44:47]
  buffer_load_dwordx4 v1, s[12:15], s26 offen offset:0 sc1 lds
  v_mfma_f32_16x16x32_bf16 v[56:59], v[204:207], v[100:103], v[56:59]
  s_waitcnt vmcnt(7) lgkmcnt(0)
  v_lshl_add_u32 v176, v7, 8, v6
  s_waitcnt lgkmcnt(0)
  s_barrier
  v_mfma_f32_16x16x32_bf16 v[24:27], v[212:215], v[104:107], v[24:27]
  ds_read_b128 v[92:95], v12 offset:8192
  v_mfma_f32_16x16x32_bf16 v[36:39], v[104:107], v[216:219], v[36:39]
  ds_read_b128 v[96:99], v12 offset:28672
  v_mfma_f32_16x16x32_bf16 v[48:51], v[220:223], v[104:107], v[48:51]
  ds_read_b128 v[100:103], v12 offset:49152
  v_mfma_f32_16x16x32_bf16 v[16:19], v[208:211], v[108:111], v[16:19]
  buffer_load_dwordx4 v1, s[12:15], s26 offen offset:1024 sc1 lds
  v_mfma_f32_16x16x32_bf16 v[28:31], v[212:215], v[108:111], v[28:31]
  v_mfma_f32_16x16x32_bf16 v[40:43], v[108:111], v[216:219], v[40:43]
  buffer_load_dwordx4 v1, s[12:15], s26 offen offset:2048 sc1 lds
  v_mfma_f32_16x16x32_bf16 v[52:55], v[220:223], v[108:111], v[52:55]
  v_mfma_f32_16x16x32_bf16 v[20:23], v[208:211], v[112:115], v[20:23]
  v_mfma_f32_16x16x32_bf16 v[32:35], v[212:215], v[112:115], v[32:35]
  v_mfma_f32_16x16x32_bf16 v[44:47], v[112:115], v[216:219], v[44:47]
  buffer_load_dwordx4 v1, s[12:15], s26 offen offset:3072 sc1 lds
  v_mfma_f32_16x16x32_bf16 v[56:59], v[220:223], v[112:115], v[56:59]
  s_waitcnt vmcnt(7) lgkmcnt(0)
  s_add_u32 s26, s26, 4096
  s_add_u32 m0, m0, 4096
  v_mfma_f32_16x16x32_bf16 v[24:27], v[228:231], v[92:95], v[24:27]
  ds_read_b128 v[104:107], v13 offset:9216
  v_mfma_f32_16x16x32_bf16 v[36:39], v[92:95], v[232:235], v[36:39]
  ds_read_b128 v[108:111], v13 offset:29696
  v_mfma_f32_16x16x32_bf16 v[48:51], v[236:239], v[92:95], v[48:51]
  ds_read_b128 v[112:115], v13 offset:50176
  v_add_u32 v12, s40, v12
  v_mfma_f32_16x16x32_bf16 v[16:19], v[224:227], v[96:99], v[16:19]
  v_mfma_f32_16x16x32_bf16 v[28:31], v[228:231], v[96:99], v[28:31]
  v_mfma_f32_16x16x32_bf16 v[40:43], v[96:99], v[232:235], v[40:43]
  buffer_load_dwordx4 v1, s[12:15], s26 offen offset:0 sc1 lds
  v_mfma_f32_16x16x32_bf16 v[52:55], v[236:239], v[96:99], v[52:55]
  v_mfma_f32_16x16x32_bf16 v[20:23], v[224:227], v[100:103], v[20:23]
  v_mfma_f32_16x16x32_bf16 v[32:35], v[228:231], v[100:103], v[32:35]
  v_mfma_f32_16x16x32_bf16 v[44:47], v[100:103], v[232:235], v[44:47]
  buffer_load_dwordx4 v1, s[12:15], s26 offen offset:1024 sc1 lds
  v_mfma_f32_16x16x32_bf16 v[56:59], v[236:239], v[100:103], v[56:59]
  s_waitcnt vmcnt(6) lgkmcnt(0)
  v_mfma_f32_16x16x32_bf16 v[24:27], v[244:247], v[104:107], v[24:27]
  ds_read_b128 v[92:95], v12 offset:0
  v_mfma_f32_16x16x32_bf16 v[36:39], v[104:107], v[248:251], v[36:39]
  ds_read_b128 v[96:99], v12 offset:20480
  v_mfma_f32_16x16x32_bf16 v[48:51], v[252:255], v[104:107], v[48:51]
  v_add_u32 v13, s40, v13
  v_mfma_f32_16x16x32_bf16 v[16:19], v[240:243], v[108:111], v[16:19]
  buffer_load_dwordx4 v1, s[12:15], s26 offen offset:2048 sc1 lds
  v_mfma_f32_16x16x32_bf16 v[28:31], v[244:247], v[108:111], v[28:31]
  v_mfma_f32_16x16x32_bf16 v[40:43], v[108:111], v[248:251], v[40:43]
  buffer_load_dwordx4 v1, s[12:15], s26 offen offset:3072 sc1 lds
  v_mfma_f32_16x16x32_bf16 v[52:55], v[252:255], v[108:111], v[52:55]
  s_add_u32 s26, s26, 4096
  s_add_u32 m0, m0, 4096
  v_mfma_f32_16x16x32_bf16 v[20:23], v[240:243], v[112:115], v[20:23]
  v_mfma_f32_16x16x32_bf16 v[32:35], v[244:247], v[112:115], v[32:35]
  v_mfma_f32_16x16x32_bf16 v[44:47], v[112:115], v[248:251], v[44:47]
  buffer_load_dwordx4 v1, s[12:15], s26 offen offset:0 sc1 lds
  v_mfma_f32_16x16x32_bf16 v[56:59], v[252:255], v[112:115], v[56:59]
  s_waitcnt lgkmcnt(0)
  v_mfma_f32_16x16x32_bf16 v[60:63], a[0:3], v[92:95], 0
  ds_read_b128 v[100:103], v13 offset:1024
  v_cvt_pk_bf16_f32 v48, v48, v49
  v_cvt_pk_bf16_f32 v49, v50, v51
  v_cvt_pk_bf16_f32 v52, v52, v53
  v_mfma_f32_16x16x32_bf16 v[68:71], a[4:7], v[92:95], 0
  ds_read_b128 v[104:107], v13 offset:21504
  ds_write_b64 v174, v[48:49] offset:0
  v_mfma_f32_16x16x32_bf16 v[76:79], v[92:95], a[8:11], 0
  v_cvt_pk_bf16_f32 v53, v54, v55
  v_cvt_pk_bf16_f32 v56, v56, v57
  v_cvt_pk_bf16_f32 v57, v58, v59
  v_cvt_pk_bf16_f32 v116, v24, v25
  v_mfma_f32_16x16x32_bf16 v[84:87], a[12:15], v[92:95], 0
  buffer_load_dwordx4 v1, s[12:15], s26 offen offset:1024 sc1 lds
  ds_write_b64 v174, v[52:53] offset:512
  v_mfma_f32_16x16x32_bf16 v[64:67], a[0:3], v[96:99], 0
  ds_write_b64 v174, v[56:57] offset:1024
  v_cvt_pk_bf16_f32 v117, v26, v27
  v_cvt_pk_bf16_f32 v120, v28, v29
  v_mfma_f32_16x16x32_bf16 v[72:75], a[4:7], v[96:99], 0
  s_add_u32 s26, s26, 2048
  v_cvt_pk_bf16_f32 v121, v30, v31
  v_cvt_pk_bf16_f32 v124, v32, v33
  v_cvt_pk_bf16_f32 v125, v34, v35
  v_cvt_pk_bf16_f32 v108, v16, v17
  v_mfma_f32_16x16x32_bf16 v[80:83], v[96:99], a[8:11], 0
  s_mul_i32 m0, s3, 15360
  v_cvt_pk_bf16_f32 v109, v18, v19
  v_cvt_pk_bf16_f32 v112, v20, v21
  v_cvt_pk_bf16_f32 v113, v22, v23
  v_mfma_f32_16x16x32_bf16 v[88:91], a[12:15], v[96:99], 0
  s_waitcnt lgkmcnt(3)
  s_waitcnt lgkmcnt(0)
  s_barrier
  v_mfma_f32_16x16x32_bf16 v[60:63], a[16:19], v[100:103], v[60:63]
  ds_read_b128 v[92:95], v12 offset:2048
  ds_read_b64 v[110:111], v165
  v_mov_b32_dpp v128, v116 row_ror:8 row_mask:0xf bank_mask:0xf
  v_mfma_f32_16x16x32_bf16 v[68:71], a[20:23], v[100:103], v[68:71]
  ds_read_b128 v[96:99], v12 offset:22528
  ds_read_b64 v[118:119], v169 offset:2560
  v_mov_b32_dpp v129, v117 row_ror:8 row_mask:0xf bank_mask:0xf
  v_mfma_f32_16x16x32_bf16 v[76:79], v[100:103], a[24:27], v[76:79]
  ds_read_b64 v[122:123], v169 offset:3072
  ds_read_b64 v[114:115], v166
  v_cvt_pk_bf16_f32 v132, v36, v37
  v_mfma_f32_16x16x32_bf16 v[84:87], a[28:31], v[100:103], v[84:87]
  buffer_load_dwordx4 v1, s[12:15], s26 offen offset:0 sc1 lds
  ds_read_b64 v[126:127], v169 offset:3584
  v_mfma_f32_16x16x32_bf16 v[64:67], a[16:19], v[104:107], v[64:67]
  ds_read_b64_tr_b16 v[140:141], v172 offset:0
  ds_read_b64_tr_b16 v[142:143], v172 offset:512
  v_cvt_pk_bf16_f32 v133, v38, v39
  v_mfma_f32_16x16x32_bf16 v[72:75], a[20:23], v[104:107], v[72:75]
  ds_read_b64_tr_b16 v[144:145], v172 offset:1024
  ds_read_b64 v[130:131], v164 offset:2560
  v_cvt_pk_bf16_f32 v134, v40, v41
  v_mfma_f32_16x16x32_bf16 v[80:83], v[104:107], a[24:27], v[80:83]
  buffer_load_dwordx4 v1, s[12:15], s26 offen offset:1024 sc1 lds
  ds_read_b64_tr_b16 v[146:147], v173
  v_mfma_f32_16x16x32_bf16 v[88:91], a[28:31], v[104:107], v[88:91]
  s_waitcnt lgkmcnt(9)
  v_cvt_pk_bf16_f32 v135, v42, v43
  v_cvt_pk_bf16_f32 v136, v44, v45
  v_cvt_pk_bf16_f32 v137, v46, v47
  v_mov_b32 v138, v132
  s_waitcnt lgkmcnt(8)
  v_mfma_f32_16x16x32_bf16 v[24:27], v[116:119], v[108:111], v[160:163]
  v_mov_b32 v170, v132
  v_mov_b32 v139, v133
  v_mov_b32 v171, v133
  s_waitcnt lgkmcnt(7)
  v_mfma_f32_16x16x32_bf16 v[16:19], v[120:123], v[108:111], v[152:155]
  s_waitcnt lgkmcnt(5)
  v_permlane32_swap_b32 v138, v170
  v_permlane32_swap_b32 v139, v171
  v_mfma_f32_16x16x32_bf16 v[20:23], v[124:127], v[112:115], v[152:155]
  v_mfma_f32_16x16x32_bf16 v[28:31], v[120:123], v[112:115], v[156:159]
  v_mfma_f32_16x16x32_bf16 v[60:63], a[32:35], v[92:95], v[60:63]
  ds_read_b128 v[100:103], v13 offset:3072
  v_mfma_f32_16x16x32_bf16 v[68:71], a[36:39], v[92:95], v[68:71]
  ds_read_b128 v[104:107], v13 offset:23552
  v_max_f32 v16, v16, v24
  v_max_f32 v17, v17, v25
  v_max_f32 v18, v18, v26
  v_mfma_f32_16x16x32_bf16 v[76:79], v[92:95], a[40:43], v[76:79]
  v_max_f32 v19, v19, v27
  v_max3_f32 v32, v16, v17, v18
  v_max_f32 v32, v32, v19
  v_max_f32 v20, v20, v28
  v_mfma_f32_16x16x32_bf16 v[84:87], a[44:47], v[92:95], v[84:87]
  buffer_load_dwordx4 v1, s[12:15], s26 offen offset:2048 sc1 lds
  v_max_f32 v21, v21, v29
  v_max_f32 v22, v22, v30
  v_mfma_f32_16x16x32_bf16 v[64:67], a[32:35], v[96:99], v[64:67]
  v_max_f32 v23, v23, v31
  v_max3_f32 v33, v20, v21, v22
  v_max_f32 v33, v33, v23
  v_mfma_f32_16x16x32_bf16 v[72:75], a[36:39], v[96:99], v[72:75]
  v_mfma_f32_16x16x32_bf16 v[80:83], v[96:99], a[40:43], v[80:83]
  buffer_load_dwordx4 v1, s[12:15], s26 offen offset:3072 sc1 lds
  v_permlane32_swap_b32 v32, v33
  v_mfma_f32_16x16x32_bf16 v[88:91], a[44:47], v[96:99], v[88:91]
  s_waitcnt lgkmcnt(0)
  v_max_f32 v32, v32, v33
  v_mov_b32 v33, v32
  s_add_u32 s26, s26, 4096
  s_add_u32 m0, m0, 4096
  v_mfma_f32_16x16x32_bf16 v[60:63], a[48:51], v[100:103], v[60:63]
  ds_read_b128 v[92:95], v12 offset:4096
  v_permlane16_swap_b32 v32, v33
  v_max_f32 v32, v32, v33
  v_mfma_f32_16x16x32_bf16 v[68:71], a[52:55], v[100:103], v[68:71]
  ds_read_b128 v[96:99], v12 offset:24576
  v_mul_f32 v33, s20, v32
  v_mul_f32 v32, s20, v32
  v_mfma_f32_16x16x32_bf16 v[76:79], v[100:103], a[56:59], v[76:79]
  v_mfma_f32_16x16x32_bf16 v[84:87], a[60:63], v[100:103], v[84:87]
  buffer_load_dwordx4 v1, s[12:15], s26 offen offset:0 sc1 lds
  v_permlane32_swap_b32 v32, v33
  v_mfma_f32_16x16x32_bf16 v[64:67], a[48:51], v[104:107], v[64:67]
  buffer_load_dwordx4 v1, s[12:15], s26 offen offset:1024 sc1 lds
  v_fma_f32 v16, v16, s20, -v32
  v_fma_f32 v17, v17, s20, -v32
  v_mfma_f32_16x16x32_bf16 v[72:75], a[52:55], v[104:107], v[72:75]
  v_exp_f32 v16, v16
  v_exp_f32 v17, v17
  v_mfma_f32_16x16x32_bf16 v[80:83], v[104:107], a[56:59], v[80:83]
  buffer_load_dwordx4 v1, s[12:15], s26 offen offset:2048 sc1 lds
  v_fma_f32 v18, v18, s20, -v32
  v_fma_f32 v19, v19, s20, -v32
  v_mfma_f32_16x16x32_bf16 v[88:91], a[60:63], v[104:107], v[88:91]
  s_waitcnt lgkmcnt(0)
  v_exp_f32 v18, v18
  v_exp_f32 v19, v19
  s_mov_b32 s45, 34816
  buffer_load_dwordx4 v[56:59], v1, s[12:15], s45 offen sc1
  v_mfma_f32_16x16x32_bf16 v[60:63], a[64:67], v[92:95], v[60:63]
  ds_read_b128 v[100:103], v13 offset:5120
  v_fma_f32 v20, v20, s20, -v33
  v_exp_f32 v20, v20
  v_mfma_f32_16x16x32_bf16 v[68:71], a[68:71], v[92:95], v[68:71]
  ds_read_b128 v[104:107], v13 offset:25600
  v_fma_f32 v21, v21, s20, -v33
  v_exp_f32 v21, v21
  v_mfma_f32_16x16x32_bf16 v[76:79], v[92:95], a[72:75], v[76:79]
  v_fma_f32 v22, v22, s20, -v33
  v_fma_f32 v23, v23, s20, -v33
  v_exp_f32 v22, v22
  v_mfma_f32_16x16x32_bf16 v[84:87], a[76:79], v[92:95], v[84:87]
  buffer_load_dwordx4 v1, s[12:15], s26 offen offset:3072 sc1 lds
  v_exp_f32 v23, v23
  v_mfma_f32_16x16x32_bf16 v[64:67], a[64:67], v[96:99], v[64:67]
  s_add_u32 s26, s26, 4096
  v_cvt_pk_bf16_f32 v24, v16, v17
  v_cvt_pk_bf16_f32 v25, v18, v19
  v_cndmask_b32_e64 v40, 0, v24, s[56:57]
  v_cndmask_b32_e64 v42, v24, 0, s[56:57]
  v_mfma_f32_16x16x32_bf16 v[72:75], a[68:71], v[96:99], v[72:75]
  s_add_u32 m0, m0, 4096
  v_cndmask_b32_e64 v41, 0, v25, s[56:57]
  v_cndmask_b32_e64 v43, v25, 0, s[56:57]
  v_cvt_pk_bf16_f32 v26, v20, v21
  v_cvt_pk_bf16_f32 v27, v22, v23
  v_mfma_f32_16x16x32_bf16 v[116:119], v[148:151], v[40:43], 0
  v_cndmask_b32_e64 v44, 0, v26, s[56:57]
  v_cndmask_b32_e64 v46, v26, 0, s[56:57]
  v_cndmask_b32_e64 v45, 0, v27, s[56:57]
  v_cndmask_b32_e64 v47, v27, 0, s[56:57]
  v_mfma_f32_16x16x32_bf16 v[48:51], v[132:135], v[40:43], 0
  v_mfma_f32_16x16x32_bf16 v[108:111], v[140:143], v[40:43], 0
  v_mfma_f32_16x16x32_bf16 v[120:123], v[148:151], v[44:47], 0
  v_mfma_f32_16x16x32_bf16 v[52:55], v[134:137], v[44:47], 0
  v_rcp_f32 v32, v116
  v_mfma_f32_16x16x32_bf16 v[112:115], v[142:145], v[44:47], 0
  v_mfma_f32_16x16x32_bf16 v[80:83], v[96:99], a[72:75], v[80:83]
  buffer_load_dwordx4 v1, s[12:15], s26 offen offset:0 sc1 lds
  v_mfma_f32_16x16x32_bf16 v[88:91], a[76:79], v[96:99], v[88:91]
  s_waitcnt lgkmcnt(0)
  v_mul_f32 v48, v48, v32
  v_mul_f32 v49, v49, v32
  v_rcp_f32 v33, v120
  v_mfma_f32_16x16x32_bf16 v[60:63], a[80:83], v[100:103], v[60:63]
  ds_read_b128 v[92:95], v12 offset:6144
  v_mul_f32 v50, v50, v32
  v_mul_f32 v51, v51, v32
  v_cvt_pk_bf16_f32 v16, v48, v49
  v_mfma_f32_16x16x32_bf16 v[68:71], a[84:87], v[100:103], v[68:71]
  ds_read_b128 v[96:99], v12 offset:26624
  v_cvt_pk_bf16_f32 v17, v50, v51
  v_mul_f32 v52, v52, v33
  v_mul_f32 v53, v53, v33
  v_mfma_f32_16x16x32_bf16 v[76:79], v[100:103], a[88:91], v[76:79]
  v_mul_f32 v54, v54, v33
  v_mul_f32 v55, v55, v33
  v_cvt_pk_bf16_f32 v18, v52, v53
  v_cvt_pk_bf16_f32 v19, v54, v55
  v_mfma_f32_16x16x32_bf16 v[84:87], a[92:95], v[100:103], v[84:87]
  buffer_load_dwordx4 v1, s[12:15], s26 offen offset:1024 sc1 lds
  v_permlane16_swap_b32 v16, v18
  v_mfma_f32_16x16x32_bf16 v[64:67], a[80:83], v[104:107], v[64:67]
  v_permlane16_swap_b32 v17, v19
  v_cndmask_b32_e64 v32, v32, v33, s[58:59]
  v_cndmask_b32_e64 v108, v108, v112, s[58:59]
  v_mfma_f32_16x16x32_bf16 v[72:75], a[84:87], v[104:107], v[72:75]
  buffer_store_dwordx4 v[16:19], v175, s[12:15], s96 offen sc1
  v_cndmask_b32_e64 v109, v109, v113, s[58:59]
  v_cndmask_b32_e64 v110, v110, v114, s[58:59]
  v_mfma_f32_16x16x32_bf16 v[80:83], v[104:107], a[88:91], v[80:83]
  buffer_load_dwordx4 v1, s[12:15], s26 offen offset:2048 sc1 lds
  v_cndmask_b32_e64 v111, v111, v115, s[58:59]
  v_mul_f32 v108, v108, v32
  v_mfma_f32_16x16x32_bf16 v[88:91], a[92:95], v[104:107], v[88:91]
  s_waitcnt lgkmcnt(0)
  v_mul_f32 v109, v109, v32
  v_mul_f32 v110, v110, v32
  v_mul_f32 v111, v111, v32
  v_cvt_pk_bf16_f32 v108, v108, v109
  v_mfma_f32_16x16x32_bf16 v[60:63], a[96:99], v[92:95], v[60:63]
  ds_read_b128 v[100:103], v13 offset:7168
  v_cvt_pk_bf16_f32 v109, v110, v111
  v_mfma_f32_16x16x32_bf16 v[68:71], a[100:103], v[92:95], v[68:71]
  ds_read_b128 v[104:107], v13 offset:27648
  buffer_store_dwordx2 v[108:109], v176, s[12:15], s95 offen sc1
  v_mfma_f32_16x16x32_bf16 v[76:79], v[92:95], a[104:107], v[76:79]
  v_mfma_f32_16x16x32_bf16 v[84:87], a[108:111], v[92:95], v[84:87]
  buffer_load_dwordx4 v1, s[12:15], s26 offen offset:3072 sc1 lds
  v_mfma_f32_16x16x32_bf16 v[64:67], a[96:99], v[96:99], v[64:67]
  s_add_u32 s26, s26, 4096
  s_add_u32 m0, m0, 4096
  v_mfma_f32_16x16x32_bf16 v[72:75], a[100:103], v[96:99], v[72:75]
  v_mfma_f32_16x16x32_bf16 v[80:83], v[96:99], a[104:107], v[80:83]
  buffer_load_dwordx4 v1, s[12:15], s26 offen offset:0 sc1 lds
  v_mfma_f32_16x16x32_bf16 v[88:91], a[108:111], v[96:99], v[88:91]
  s_waitcnt lgkmcnt(0)
  s_mov_b32 s61, 0
  s_waitcnt vmcnt(8)
  v_xor_b32 v56, s94, v56
  v_xor_b32 v57, s94, v57
  v_xor_b32 v58, s94, v58
  v_xor_b32 v59, s94, v59
  v_or3_b32 v56, v56, v57, v58
  v_or_b32 v56, v56, v59
  v_cmp_ne_u32 vcc, 0, v56
  s_nop 3
  s_cbranch_vccz SYC_DONE
SYC:
  s_sleep 8
  buffer_load_dwordx4 v[56:59], v1, s[12:15], s45 offen sc1
  s_waitcnt vmcnt(0)
  v_xor_b32 v56, s94, v56
  v_xor_b32 v57, s94, v57
  v_xor_b32 v58, s94, v58
  v_xor_b32 v59, s94, v59
  v_or3_b32 v56, v56, v57, v58
  v_or_b32 v56, v56, v59
  v_cmp_ne_u32 vcc, 0, v56
  s_add_u32 s61, s61, 1
  s_cmp_gt_u32 s61, 262144
  s_cbranch_scc1 SYC_DONE
  s_nop 3
  s_cbranch_vccnz SYC
SYC_DONE:
  v_mfma_f32_16x16x32_bf16 v[60:63], a[112:115], v[100:103], v[60:63]
  s_lshl_b32 s44, s3, 6
  ds_read_b128 v[92:95], v12 offset:8192
  v_add_u32 v40, s44, v2
  v_mov_b32 v41, 29440
  v_mfma_f32_16x16x32_bf16 v[68:71], a[116:119], v[100:103], v[68:71]
  s_movk_i32 s45, 79
  ds_read_b128 v[96:99], v12 offset:28672
  v_cmp_lt_u32 s[46:47], s45, v40
  s_mul_i32 s45, s5, 1280
  v_mfma_f32_16x16x32_bf16 v[76:79], v[100:103], a[120:123], v[76:79]
  s_add_u32 s45, s45, 21843968
  v_cndmask_b32_e64 v41, 0, v41, s[46:47]
  v_lshl_add_u32 v41, v40, 4, v41
  s_add_u32 s44, s23, 30720
  v_mfma_f32_16x16x32_bf16 v[84:87], a[124:127], v[100:103], v[84:87]
  buffer_load_dwordx4 v1, s[12:15], s26 offen offset:1024 sc1 lds
  v_lshlrev_b32 v42, 3, v40
  v_mfma_f32_16x16x32_bf16 v[64:67], a[112:115], v[104:107], v[64:67]
  buffer_load_dwordx4 v1, s[12:15], s26 offen offset:2048 sc1 lds
  v_add_u32 v42, 158720, v42
  v_mfma_f32_16x16x32_bf16 v[72:75], a[116:119], v[104:107], v[72:75]
  buffer_load_dwordx4 v[16:19], v1, s[12:15], s44 offen sc1
  s_add_u32 s44, s44, 4096
  v_mfma_f32_16x16x32_bf16 v[80:83], v[104:107], a[120:123], v[80:83]
  buffer_load_dwordx4 a[0:3], v11, s[12:15], s53 offen offset:0 sc1
  v_lshlrev_b32 v40, 1, v40
  v_mfma_f32_16x16x32_bf16 v[88:91], a[124:127], v[104:107], v[88:91]
  s_waitcnt lgkmcnt(0)
  buffer_load_dwordx4 v[20:23], v1, s[12:15], s44 offen sc1
  s_add_u32 s44, s44, 4096
  v_mfma_f32_16x16x32_bf16 v[60:63], a[128:131], v[92:95], v[60:63]
  s_lshl_b32 s62, s4, 1
  ds_read_b128 v[100:103], v13 offset:9216
  v_add_u32 v40, 158720, v40
  v_cndmask_b32_e64 v43, 0, 64, s[34:35]
  v_mfma_f32_16x16x32_bf16 v[68:71], a[132:135], v[92:95], v[68:71]
  s_and_b32 s7, s3, 1
  ds_read_b128 v[104:107], v13 offset:29696
  v_add_u32 v43, v43, v40
  s_add_u32 s62, s62, s7
  v_mfma_f32_16x16x32_bf16 v[76:79], v[92:95], a[136:139], v[76:79]
  v_add_u32 v12, s39, v12
  s_mul_i32 s62, s62, 40960
  s_lshr_b32 s63, s3, 1
  v_mfma_f32_16x16x32_bf16 v[84:87], a[140:143], v[92:95], v[84:87]
  buffer_load_dwordx4 a[4:7], v11, s[12:15], s53 offen offset:1024 sc1
  s_lshl_b32 s101, s63, 6
  v_mfma_f32_16x16x32_bf16 v[64:67], a[128:131], v[96:99], v[64:67]
  buffer_load_dwordx4 v[24:27], v1, s[12:15], s44 offen sc1
  s_add_u32 s44, s44, 4096
  v_mfma_f32_16x16x32_bf16 v[72:75], a[132:135], v[96:99], v[72:75]
  buffer_load_dwordx4 v[28:31], v1, s[12:15], s44 offen sc1
  s_add_u32 s44, s44, 4096
  v_mfma_f32_16x16x32_bf16 v[80:83], v[96:99], a[136:139], v[80:83]
  buffer_load_dwordx4 v[32:35], v1, s[12:15], s44 offen sc1
  s_mul_i32 s97, s5, 160
  v_mfma_f32_16x16x32_bf16 v[88:91], a[140:143], v[96:99], v[88:91]
  s_waitcnt lgkmcnt(0)
  buffer_load_dwordx4 v[36:39], v41, s[12:15], s45 offen sc1
  s_add_u32 s97, s97, s62
  v_mfma_f32_16x16x32_bf16 v[60:63], a[144:147], v[100:103], v[60:63]
  s_add_u32 s97, s97, s101
  ds_read_b128 v[92:95], v12 offset:0
  v_mul_u32_u24 v6, 2560, v5
  v_lshl_add_u32 v7, v3, 3, v6
  v_mfma_f32_16x16x32_bf16 v[68:71], a[148:151], v[100:103], v[68:71]
  s_mul_i32 s62, s63, 1879048192
  ds_read_b128 v[96:99], v12 offset:20480
  v_lshl_add_u32 v6, v3, 4, v6
  v_lshlrev_b32 v8, 4, v3
  v_mfma_f32_16x16x32_bf16 v[76:79], v[100:103], a[152:155], v[76:79]
  v_add_u32 v13, s39, v13
  v_lshlrev_b32 v9, 3, v3
  v_add_u32 v7, s62, v7
  v_mfma_f32_16x16x32_bf16 v[84:87], a[156:159], v[100:103], v[84:87]
  buffer_load_dwordx4 a[16:19], v11, s[12:15], s53 offen offset:2048 sc1
  s_lshl_b32 s24, s4, 2
  v_mfma_f32_16x16x32_bf16 v[64:67], a[144:147], v[104:107], v[64:67]
  ds_write_b64 v42, v[148:149] offset:3072
  s_add_u32 s24, s24, s7
  v_mfma_f32_16x16x32_bf16 v[72:75], a[148:151], v[104:107], v[72:75]
  s_mul_i32 s24, s24, 20480
  s_add_u32 s25, s24, 10551296
  s_mul_i32 s62, s63, 10240
  s_add_u32 s24, s24, s62
  v_mfma_f32_16x16x32_bf16 v[80:83], v[104:107], a[152:155], v[80:83]
  buffer_load_dwordx4 a[20:23], v11, s[12:15], s53 offen offset:3072 sc1
  s_add_u32 s24, s24, 7929856
  v_mfma_f32_16x16x32_bf16 v[88:91], a[156:159], v[104:107], v[88:91]
  s_waitcnt lgkmcnt(1)
  v_and_b32 v4, 3, v2
  v_mov_b32 v15, 161920
  v_cmp_eq_u32 vcc, 0, v4
  v_mfma_f32_16x16x32_bf16 v[60:63], a[160:163], v[92:95], v[60:63]
  s_add_u32 s53, s53, 4096
  ds_read_b128 v[100:103], v13 offset:1024
  v_mov_b32 v0, 160064
  v_cndmask_b32 v15, v15, v0, vcc
  v_mfma_f32_16x16x32_bf16 v[68:71], a[164:167], v[92:95], v[68:71]
  ds_read_b128 v[104:107], v13 offset:21504
  v_cmp_eq_u32 vcc, 1, v4
  v_mov_b32 v0, 158720
  v_mfma_f32_16x16x32_bf16 v[76:79], v[92:95], a[168:171], v[76:79]
  v_cndmask_b32 v15, v15, v0, vcc
  v_add_u32 v0, v15, v8
  v_add_u32 v15, v15, v9
  v_mfma_f32_16x16x32_bf16 v[84:87], a[172:175], v[92:95], v[84:87]
  buffer_load_dwordx4 a[32:35], v11, s[12:15], s53 offen offset:0 sc1
  v_mfma_f32_16x16x32_bf16 v[64:67], a[160:163], v[96:99], v[64:67]
  v_mfma_f32_16x16x32_bf16 v[72:75], a[164:167], v[96:99], v[72:75]
  v_mfma_f32_16x16x32_bf16 v[80:83], v[96:99], a[168:171], v[80:83]
  buffer_load_dwordx4 a[36:39], v11, s[12:15], s53 offen offset:1024 sc1
  v_mfma_f32_16x16x32_bf16 v[88:91], a[172:175], v[96:99], v[88:91]
  s_waitcnt lgkmcnt(0)
  s_waitcnt vmcnt(16)
  s_barrier
  s_cmp_lg_u32 s3, 0
  s_cbranch_scc1 SK25
  s_add_u32 s6, s52, 0
  buffer_store_dword v14, v10, s[12:15], s6 offen sc1
SK25:
  v_mfma_f32_16x16x32_bf16 v[60:63], a[176:179], v[100:103], v[60:63]
  ds_read_b128 v[92:95], v12 offset:2048
  v_mfma_f32_16x16x32_bf16 v[68:71], a[180:183], v[100:103], v[68:71]
  ds_read_b128 v[96:99], v12 offset:22528
  v_mfma_f32_16x16x32_bf16 v[76:79], v[100:103], a[184:187], v[76:79]
  v_mfma_f32_16x16x32_bf16 v[84:87], a[188:191], v[100:103], v[84:87]
  buffer_load_dwordx4 a[48:51], v11, s[12:15], s53 offen offset:2048 sc1
  v_mfma_f32_16x16x32_bf16 v[64:67], a[176:179], v[104:107], v[64:67]
  v_mfma_f32_16x16x32_bf16 v[72:75], a[180:183], v[104:107], v[72:75]
  v_mfma_f32_16x16x32_bf16 v[80:83], v[104:107], a[184:187], v[80:83]
  buffer_load_dwordx4 a[52:55], v11, s[12:15], s53 offen offset:3072 sc1
  v_mfma_f32_16x16x32_bf16 v[88:91], a[188:191], v[104:107], v[88:91]
  s_waitcnt lgkmcnt(0)
  s_add_u32 s53, s53, 4096
  v_mfma_f32_16x16x32_bf16 v[60:63], a[192:195], v[92:95], v[60:63]
  ds_read_b128 v[100:103], v13 offset:3072
  v_mfma_f32_16x16x32_bf16 v[68:71], a[196:199], v[92:95], v[68:71]
  ds_read_b128 v[104:107], v13 offset:23552
  v_mfma_f32_16x16x32_bf16 v[76:79], v[92:95], a[200:203], v[76:79]
  v_mfma_f32_16x16x32_bf16 v[84:87], a[204:207], v[92:95], v[84:87]
  buffer_load_dwordx4 a[64:67], v11, s[12:15], s53 offen offset:0 sc1
  v_mfma_f32_16x16x32_bf16 v[64:67], a[192:195], v[96:99], v[64:67]
  v_mfma_f32_16x16x32_bf16 v[72:75], a[196:199], v[96:99], v[72:75]
  v_mfma_f32_16x16x32_bf16 v[80:83], v[96:99], a[200:203], v[80:83]
  v_mfma_f32_16x16x32_bf16 v[88:91], a[204:207], v[96:99], v[88:91]
  s_waitcnt lgkmcnt(0)
  v_mfma_f32_16x16x32_bf16 v[60:63], a[208:211], v[100:103], v[60:63]
  ds_read_b128 v[92:95], v12 offset:4096
  v_mfma_f32_16x16x32_bf16 v[68:71], a[212:215], v[100:103], v[68:71]
  ds_read_b128 v[96:99], v12 offset:24576
  v_mfma_f32_16x16x32_bf16 v[76:79], v[100:103], a[216:219], v[76:79]
  s_waitcnt vmcnt(14)
  v_add_f32_dpp v16, v16, v16 quad_perm:[1,0,3,2] row_mask:0xf bank_mask:0xf
  v_add_f32_dpp v17, v17, v17 quad_perm:[1,0,3,2] row_mask:0xf bank_mask:0xf
  v_add_f32_dpp v18, v18, v18 quad_perm:[1,0,3,2] row_mask:0xf bank_mask:0xf
  v_mfma_f32_16x16x32_bf16 v[84:87], a[220:223], v[100:103], v[84:87]
  buffer_load_dwordx4 a[68:71], v11, s[12:15], s53 offen offset:1024 sc1
  v_add_f32_dpp v19, v19, v19 quad_perm:[1,0,3,2] row_mask:0xf bank_mask:0xf
  v_mfma_f32_16x16x32_bf16 v[64:67], a[208:211], v[104:107], v[64:67]
  s_waitcnt vmcnt(13)
  v_add_f32_dpp v20, v20, v20 quad_perm:[1,0,3,2] row_mask:0xf bank_mask:0xf
  v_add_f32_dpp v21, v21, v21 quad_perm:[1,0,3,2] row_mask:0xf bank_mask:0xf
  v_add_f32_dpp v22, v22, v22 quad_perm:[1,0,3,2] row_mask:0xf bank_mask:0xf
  v_mfma_f32_16x16x32_bf16 v[72:75], a[212:215], v[104:107], v[72:75]
  v_add_f32_dpp v23, v23, v23 quad_perm:[1,0,3,2] row_mask:0xf bank_mask:0xf
  v_cndmask_b32_e64 v16, v16, v17, s[32:33]
  v_cndmask_b32_e64 v18, v18, v19, s[32:33]
  v_mfma_f32_16x16x32_bf16 v[80:83], v[104:107], a[216:219], v[80:83]
  buffer_load_dwordx4 a[80:83], v11, s[12:15], s53 offen offset:2048 sc1
  v_cndmask_b32_e64 v20, v20, v21, s[32:33]
  v_mfma_f32_16x16x32_bf16 v[88:91], a[220:223], v[104:107], v[88:91]
  s_waitcnt lgkmcnt(0)
  v_cndmask_b32_e64 v22, v22, v23, s[32:33]
  v_mfma_f32_16x16x32_bf16 v[60:63], a[224:227], v[92:95], v[60:63]
  ds_read_b128 v[100:103], v13 offset:5120
  v_mfma_f32_16x16x32_bf16 v[68:71], a[228:231], v[92:95], v[68:71]
  ds_read_b128 v[104:107], v13 offset:25600
  s_waitcnt vmcnt(12)
  v_add_f32_dpp v24, v24, v24 quad_perm:[1,0,3,2] row_mask:0xf bank_mask:0xf
  v_add_f32_dpp v25, v25, v25 quad_perm:[1,0,3,2] row_mask:0xf bank_mask:0xf
  v_mfma_f32_16x16x32_bf16 v[76:79], v[92:95], a[232:235], v[76:79]
  s_waitcnt vmcnt(11)
  v_add_f32_dpp v26, v26, v26 quad_perm:[1,0,3,2] row_mask:0xf bank_mask:0xf
  v_add_f32_dpp v27, v27, v27 quad_perm:[1,0,3,2] row_mask:0xf bank_mask:0xf
  v_add_f32_dpp v28, v28, v28 quad_perm:[1,0,3,2] row_mask:0xf bank_mask:0xf
  v_mfma_f32_16x16x32_bf16 v[84:87], a[236:239], v[92:95], v[84:87]
  buffer_load_dwordx4 a[84:87], v11, s[12:15], s53 offen offset:3072 sc1
  v_add_f32_dpp v29, v29, v29 quad_perm:[1,0,3,2] row_mask:0xf bank_mask:0xf
  v_mfma_f32_16x16x32_bf16 v[64:67], a[224:227], v[96:99], v[64:67]
  s_add_u32 s53, s53, 4096
  v_add_f32_dpp v30, v30, v30 quad_perm:[1,0,3,2] row_mask:0xf bank_mask:0xf
  v_add_f32_dpp v31, v31, v31 quad_perm:[1,0,3,2] row_mask:0xf bank_mask:0xf
  s_waitcnt vmcnt(11)
  v_add_f32_dpp v32, v32, v32 quad_perm:[1,0,3,2] row_mask:0xf bank_mask:0xf
  v_mfma_f32_16x16x32_bf16 v[72:75], a[228:231], v[96:99], v[72:75]
  v_add_f32_dpp v33, v33, v33 quad_perm:[1,0,3,2] row_mask:0xf bank_mask:0xf
  v_add_f32_dpp v34, v34, v34 quad_perm:[1,0,3,2] row_mask:0xf bank_mask:0xf
  v_add_f32_dpp v35, v35, v35 quad_perm:[1,0,3,2] row_mask:0xf bank_mask:0xf
  v_mfma_f32_16x16x32_bf16 v[80:83], v[96:99], a[232:235], v[80:83]
  buffer_load_dwordx4 a[96:99], v11, s[12:15], s53 offen offset:0 sc1
  s_waitcnt vmcnt(11)
  v_add_f32_dpp v36, v36, v36 quad_perm:[1,0,3,2] row_mask:0xf bank_mask:0xf
  v_mfma_f32_16x16x32_bf16 v[88:91], a[236:239], v[96:99], v[88:91]
  s_waitcnt lgkmcnt(0)
  v_add_f32_dpp v37, v37, v37 quad_perm:[1,0,3,2] row_mask:0xf bank_mask:0xf
  v_add_f32_dpp v38, v38, v38 quad_perm:[1,0,3,2] row_mask:0xf bank_mask:0xf
  v_add_f32_dpp v39, v39, v39 quad_perm:[1,0,3,2] row_mask:0xf bank_mask:0xf
  v_mfma_f32_16x16x32_bf16 v[60:63], a[240:243], v[100:103], v[60:63]
  ds_read_b128 v[92:95], v12 offset:6144
  v_cndmask_b32_e64 v24, v24, v25, s[32:33]
  v_cndmask_b32_e64 v26, v26, v27, s[32:33]
  v_mfma_f32_16x16x32_bf16 v[68:71], a[244:247], v[100:103], v[68:71]
  ds_read_b128 v[96:99], v12 offset:26624
  v_cndmask_b32_e64 v28, v28, v29, s[32:33]
  v_cndmask_b32_e64 v30, v30, v31, s[32:33]
  v_mfma_f32_16x16x32_bf16 v[76:79], v[100:103], a[248:251], v[76:79]
  v_cndmask_b32_e64 v32, v32, v33, s[32:33]
  v_cndmask_b32_e64 v34, v34, v35, s[32:33]
  v_cndmask_b32_e64 v36, v36, v37, s[32:33]
  v_mfma_f32_16x16x32_bf16 v[84:87], a[252:255], v[100:103], v[84:87]
  buffer_load_dwordx4 a[100:103], v11, s[12:15], s53 offen offset:1024 sc1
  v_cndmask_b32_e64 v38, v38, v39, s[32:33]
  v_mfma_f32_16x16x32_bf16 v[64:67], a[240:243], v[104:107], v[64:67]
  v_add_f32_dpp v16, v16, v16 quad_perm:[2,3,0,1] row_mask:0xf bank_mask:0xf
  v_add_f32_dpp v18, v18, v18 quad_perm:[2,3,0,1] row_mask:0xf bank_mask:0xf
  v_add_f32_dpp v20, v20, v20 quad_perm:[2,3,0,1] row_mask:0xf bank_mask:0xf
  v_mfma_f32_16x16x32_bf16 v[72:75], a[244:247], v[104:107], v[72:75]
  v_add_f32_dpp v22, v22, v22 quad_perm:[2,3,0,1] row_mask:0xf bank_mask:0xf
  v_add_f32_dpp v24, v24, v24 quad_perm:[2,3,0,1] row_mask:0xf bank_mask:0xf
  v_add_f32_dpp v26, v26, v26 quad_perm:[2,3,0,1] row_mask:0xf bank_mask:0xf
  v_mfma_f32_16x16x32_bf16 v[80:83], v[104:107], a[248:251], v[80:83]
  buffer_load_dwordx4 a[112:115], v11, s[12:15], s53 offen offset:2048 sc1
  v_add_f32_dpp v28, v28, v28 quad_perm:[2,3,0,1] row_mask:0xf bank_mask:0xf
  v_mfma_f32_16x16x32_bf16 v[88:91], a[252:255], v[104:107], v[88:91]
  s_waitcnt lgkmcnt(0)
  v_add_f32_dpp v30, v30, v30 quad_perm:[2,3,0,1] row_mask:0xf bank_mask:0xf
  v_add_f32_dpp v32, v32, v32 quad_perm:[2,3,0,1] row_mask:0xf bank_mask:0xf
  v_add_f32_dpp v34, v34, v34 quad_perm:[2,3,0,1] row_mask:0xf bank_mask:0xf
  v_mfma_f32_16x16x32_bf16 v[60:63], v[192:195], v[92:95], v[60:63]
  ds_read_b128 v[100:103], v13 offset:7168
  v_add_f32_dpp v36, v36, v36 quad_perm:[2,3,0,1] row_mask:0xf bank_mask:0xf
  v_add_f32_dpp v38, v38, v38 quad_perm:[2,3,0,1] row_mask:0xf bank_mask:0xf
  v_mfma_f32_16x16x32_bf16 v[68:71], v[196:199], v[92:95], v[68:71]
  ds_read_b128 v[104:107], v13 offset:27648
  v_cndmask_b32_e64 v16, v16, v18, s[36:37]
  v_cndmask_b32_e64 v20, v20, v22, s[36:37]
  v_mfma_f32_16x16x32_bf16 v[76:79], v[92:95], v[200:203], v[76:79]
  v_cndmask_b32_e64 v24, v24, v26, s[36:37]
  v_cndmask_b32_e64 v28, v28, v30, s[36:37]
  v_cndmask_b32_e64 v32, v32, v34, s[36:37]
  v_mfma_f32_16x16x32_bf16 v[84:87], v[204:207], v[92:95], v[84:87]
  buffer_load_dwordx4 a[116:119], v11, s[12:15], s53 offen offset:3072 sc1
  v_cndmask_b32_e64 v36, v36, v38, s[36:37]
  v_mfma_f32_16x16x32_bf16 v[64:67], v[192:195], v[96:99], v[64:67]
  s_add_u32 s53, s53, 4096
  v_cvt_pk_bf16_f32 v16, 0, v16
  v_cvt_pk_bf16_f32 v20, 0, v20
  v_cvt_pk_bf16_f32 v24, 0, v24
  v_mfma_f32_16x16x32_bf16 v[72:75], v[196:199], v[96:99], v[72:75]
  ds_write_b16_d16_hi v40, v16 offset:0
  v_add_f32 v25, 1.0, v24
  v_mfma_f32_16x16x32_bf16 v[80:83], v[96:99], v[200:203], v[80:83]
  ds_write_b16_d16_hi v40, v20 offset:512
  v_cvt_pk_bf16_f32 v25, 0, v25
  v_mfma_f32_16x16x32_bf16 v[88:91], v[204:207], v[96:99], v[88:91]
  s_waitcnt lgkmcnt(2)
  v_cndmask_b32_e64 v24, v24, v25, s[34:35]
  v_cvt_pk_bf16_f32 v28, 0, v28
  v_add_f32 v28, 1.0, v28
  v_mfma_f32_16x16x32_bf16 v[60:63], v[208:211], v[100:103], v[60:63]
  ds_read_b128 v[92:95], v12 offset:8192
  v_cvt_pk_bf16_f32 v28, 0, v28
  v_cvt_pk_bf16_f32 v32, 0, v32
  v_mfma_f32_16x16x32_bf16 v[68:71], v[212:215], v[100:103], v[68:71]
  ds_read_b128 v[96:99], v12 offset:28672
  v_add_f32 v32, 1.0, v32
  v_cvt_pk_bf16_f32 v32, 0, v32
  v_mfma_f32_16x16x32_bf16 v[76:79], v[100:103], v[216:219], v[76:79]
  ds_write_b16_d16_hi v43, v24 offset:1024
  v_cvt_pk_bf16_f32 v36, 0, v36
  v_mfma_f32_16x16x32_bf16 v[84:87], v[220:223], v[100:103], v[84:87]
  buffer_load_dwordx4 a[128:131], v11, s[12:15], s53 offen offset:0 sc1
  v_mfma_f32_16x16x32_bf16 v[64:67], v[208:211], v[104:107], v[64:67]
  ds_write_b16_d16_hi v40, v28 offset:1600
  v_mfma_f32_16x16x32_bf16 v[72:75], v[212:215], v[104:107], v[72:75]
  ds_write_b16_d16_hi v40, v32 offset:2112
  v_mfma_f32_16x16x32_bf16 v[80:83], v[104:107], v[216:219], v[80:83]
  buffer_load_dwordx4 a[132:135], v11, s[12:15], s53 offen offset:1024 sc1
  v_mfma_f32_16x16x32_bf16 v[88:91], v[220:223], v[104:107], v[88:91]
  s_waitcnt lgkmcnt(3)
  ds_write_b16_d16_hi v40, v36 offset:2624
  v_mfma_f32_16x16x32_bf16 v[60:63], v[224:227], v[92:95], v[60:63]
  ds_read_b128 v[100:103], v13 offset:9216
  v_mfma_f32_16x16x32_bf16 v[68:71], v[228:231], v[92:95], v[68:71]
  ds_read_b128 v[104:107], v13 offset:29696
  v_mfma_f32_16x16x32_bf16 v[76:79], v[92:95], v[232:235], v[76:79]
  v_mfma_f32_16x16x32_bf16 v[84:87], v[236:239], v[92:95], v[84:87]
  buffer_load_dwordx4 a[144:147], v11, s[12:15], s53 offen offset:2048 sc1
  v_mfma_f32_16x16x32_bf16 v[64:67], v[224:227], v[96:99], v[64:67]
  v_mfma_f32_16x16x32_bf16 v[72:75], v[228:231], v[96:99], v[72:75]
  v_mfma_f32_16x16x32_bf16 v[80:83], v[96:99], v[232:235], v[80:83]
  buffer_load_dwordx4 a[148:151], v11, s[12:15], s53 offen offset:3072 sc1
  v_mfma_f32_16x16x32_bf16 v[88:91], v[236:239], v[96:99], v[88:91]
  s_waitcnt lgkmcnt(0)
  s_add_u32 s53, s53, 4096
  v_mfma_f32_16x16x32_bf16 v[60:63], v[240:243], v[100:103], v[60:63]
  v_mfma_f32_16x16x32_bf16 v[68:71], v[244:247], v[100:103], v[68:71]
  v_mfma_f32_16x16x32_bf16 v[76:79], v[100:103], v[248:251], v[76:79]
  v_mfma_f32_16x16x32_bf16 v[84:87], v[252:255], v[100:103], v[84:87]
  buffer_load_dwordx4 a[160:163], v11, s[12:15], s53 offen offset:0 sc1
  v_mfma_f32_16x16x32_bf16 v[64:67], v[240:243], v[104:107], v[64:67]
  v_mfma_f32_16x16x32_bf16 v[72:75], v[244:247], v[104:107], v[72:75]
  v_mfma_f32_16x16x32_bf16 v[80:83], v[104:107], v[248:251], v[80:83]
  buffer_load_dwordx4 a[164:167], v11, s[12:15], s53 offen offset:1024 sc1
  v_mfma_f32_16x16x32_bf16 v[88:91], v[252:255], v[104:107], v[88:91]
  s_nop 1
  v_cvt_pk_bf16_f32 v84, v84, v85
  buffer_load_dwordx4 a[176:179], v11, s[12:15], s53 offen offset:2048 sc1
  v_cvt_pk_bf16_f32 v85, v86, v87
  ds_write_b64 v174, v[84:85] offset:1536
  s_nop 1
  v_cvt_pk_bf16_f32 v88, v88, v89
  v_cvt_pk_bf16_f32 v89, v90, v91
  ds_write_b64 v174, v[88:89] offset:2048
  buffer_load_dwordx4 a[180:183], v11, s[12:15], s53 offen offset:3072 sc1
  s_add_u32 s53, s53, 4096
  v_cvt_pk_bf16_f32 v120, v68, v69
  v_cvt_pk_bf16_f32 v121, v70, v71
  v_cvt_pk_bf16_f32 v124, v72, v73
  v_cvt_pk_bf16_f32 v125, v74, v75
  v_cvt_pk_bf16_f32 v108, v60, v61
  v_cvt_pk_bf16_f32 v109, v62, v63
  v_cvt_pk_bf16_f32 v112, v64, v65
  v_cvt_pk_bf16_f32 v113, v66, v67
  s_waitcnt lgkmcnt(0)
  s_barrier
  ds_read_b64 v[110:111], v167
  ds_read_b64 v[122:123], v169 offset:4096
  ds_read_b64 v[114:115], v168
  ds_read_b64 v[126:127], v169 offset:4608
  ds_read_b64_tr_b16 v[142:143], v172 offset:1536
  ds_read_b64_tr_b16 v[144:145], v172 offset:2048
  v_mov_b32 v132, v138
  v_mov_b32 v140, v146
  v_mov_b32 v133, v139
  v_mov_b32 v141, v147
  v_cvt_pk_bf16_f32 v134, v76, v77
  v_cvt_pk_bf16_f32 v135, v78, v79
  v_cvt_pk_bf16_f32 v136, v80, v81
  v_cvt_pk_bf16_f32 v137, v82, v83
  s_waitcnt lgkmcnt(4)
  v_mfma_f32_16x16x32_bf16 v[60:63], v[120:123], v[108:111], v[152:155]
  v_mfma_f32_16x16x32_bf16 v[68:71], v[128:131], v[108:111], v[160:163]
  s_waitcnt lgkmcnt(2)
  v_mfma_f32_16x16x32_bf16 v[64:67], v[124:127], v[112:115], v[152:155]
  v_mfma_f32_16x16x32_bf16 v[72:75], v[120:123], v[112:115], v[156:159]
  s_cmp_lg_u32 s3, 0
  s_cbranch_scc1 PI0
  s_load_dwordx8 s[28:35], s[54:55], 0 glc
PI0:
  s_add_u32 s96, s96, 40960
  buffer_load_dwordx4 a[192:195], v11, s[12:15], s53 offen offset:0 sc1
  s_add_u32 s95, s95, 40960
  v_max_f32 v60, v60, v68
  v_max_f32 v61, v61, v69
  v_max_f32 v62, v62, v70
  v_max_f32 v63, v63, v71
  v_max3_f32 v84, v60, v61, v62
  v_max_f32 v84, v84, v63
  v_max_f32 v64, v64, v72
  v_max_f32 v65, v65, v73
  v_max_f32 v66, v66, v74
  v_max_f32 v67, v67, v75
  v_max3_f32 v85, v64, v65, v66
  v_max_f32 v85, v85, v67
  s_nop 1
  v_permlane32_swap_b32 v84, v85
  v_max_f32 v84, v84, v85
  v_mov_b32 v85, v84
  s_nop 1
  v_permlane16_swap_b32 v84, v85
  v_max_f32 v84, v84, v85
  v_mul_f32 v85, s20, v84
  v_mul_f32 v84, s20, v84
  buffer_load_dwordx4 a[196:199], v11, s[12:15], s53 offen offset:1024 sc1
  s_nop 0
  v_permlane32_swap_b32 v84, v85
  v_fma_f32 v60, v60, s20, -v84
  v_fma_f32 v61, v61, s20, -v84
  v_fma_f32 v62, v62, s20, -v84
  v_fma_f32 v63, v63, s20, -v84
  v_fma_f32 v64, v64, s20, -v85
  v_fma_f32 v65, v65, s20, -v85
  v_fma_f32 v66, v66, s20, -v85
  v_fma_f32 v67, v67, s20, -v85
  v_exp_f32 v60, v60
  v_exp_f32 v61, v61
  v_exp_f32 v62, v62
  v_exp_f32 v63, v63
  v_exp_f32 v64, v64
  v_cvt_pk_bf16_f32 v68, v60, v61
  v_cvt_pk_bf16_f32 v69, v62, v63
  v_cndmask_b32_e64 v76, 0, v68, s[56:57]
  buffer_load_dwordx4 a[208:211], v11, s[12:15], s53 offen offset:2048 sc1
  v_cndmask_b32_e64 v78, v68, 0, s[56:57]
  v_cndmask_b32_e64 v77, 0, v69, s[56:57]
  v_cndmask_b32_e64 v79, v69, 0, s[56:57]
  v_exp_f32 v65, v65
  s_nop 0
  v_mfma_f32_16x16x32_bf16 v[116:119], v[148:151], v[76:79], 0
  v_mfma_f32_16x16x32_bf16 v[92:95], v[132:135], v[76:79], 0
  s_waitcnt lgkmcnt(1)
  v_exp_f32 v66, v66
  v_exp_f32 v67, v67
  v_mfma_f32_16x16x32_bf16 v[108:111], v[140:143], v[76:79], 0
  v_cvt_pk_bf16_f32 v70, v64, v65
  v_cvt_pk_bf16_f32 v71, v66, v67
  v_cndmask_b32_e64 v80, 0, v70, s[56:57]
  v_cndmask_b32_e64 v82, v70, 0, s[56:57]
  v_cndmask_b32_e64 v81, 0, v71, s[56:57]
  v_cndmask_b32_e64 v83, v71, 0, s[56:57]
  buffer_load_dwordx4 a[212:215], v11, s[12:15], s53 offen offset:3072 sc1
  s_add_u32 s53, s53, 4096
  v_rcp_f32 v84, v116
  v_mfma_f32_16x16x32_bf16 v[120:123], v[148:151], v[80:83], 0
  v_mfma_f32_16x16x32_bf16 v[96:99], v[134:137], v[80:83], 0
  s_waitcnt lgkmcnt(0)
  v_mfma_f32_16x16x32_bf16 v[112:115], v[142:145], v[80:83], 0
  v_mul_f32 v92, v92, v84
  v_mul_f32 v93, v93, v84
  v_mul_f32 v94, v94, v84
  v_mul_f32 v95, v95, v84
  v_cvt_pk_bf16_f32 v60, v92, v93
  v_cvt_pk_bf16_f32 v61, v94, v95
  v_rcp_f32 v85, v120
  s_nop 0
  v_mul_f32 v96, v96, v85
  v_mul_f32 v97, v97, v85
  v_mul_f32 v98, v98, v85
  buffer_load_dwordx4 a[224:227], v11, s[12:15], s53 offen offset:0 sc1
  v_mul_f32 v99, v99, v85
  v_cvt_pk_bf16_f32 v62, v96, v97
  v_cvt_pk_bf16_f32 v63, v98, v99
  v_cndmask_b32_e64 v84, v84, v85, s[58:59]
  v_cndmask_b32_e64 v108, v108, v112, s[58:59]
  v_permlane16_swap_b32 v60, v62
  v_permlane16_swap_b32 v61, v63
  buffer_store_dwordx4 v[60:63], v175, s[12:15], s96 offen sc1
  v_cndmask_b32_e64 v109, v109, v113, s[58:59]
  v_cndmask_b32_e64 v110, v110, v114, s[58:59]
  v_cndmask_b32_e64 v111, v111, v115, s[58:59]
  v_mul_f32 v108, v108, v84
  v_mul_f32 v109, v109, v84
  v_mul_f32 v110, v110, v84
  v_mul_f32 v111, v111, v84
  v_cvt_pk_bf16_f32 v108, v108, v109
  v_cvt_pk_bf16_f32 v109, v110, v111
  buffer_store_dwordx2 v[108:109], v176, s[12:15], s95 offen sc1
  s_waitcnt lgkmcnt(0)
  s_mov_b32 s61, 0
  s_cmp_lg_u32 s3, 0
  s_cbranch_scc1 ACQ0_DONE
ACQ0:
  s_xor_b32 s28, s28, s94
  s_xor_b32 s29, s29, s94
  s_xor_b32 s30, s30, s94
  s_xor_b32 s31, s31, s94
  s_xor_b32 s32, s32, s94
  s_xor_b32 s33, s33, s94
  s_xor_b32 s34, s34, s94
  s_xor_b32 s35, s35, s94
  s_or_b64 s[28:29], s[28:29], s[30:31]
  s_or_b64 s[28:29], s[28:29], s[32:33]
  s_or_b64 s[28:29], s[28:29], s[34:35]
  s_cbranch_scc0 ACQ0_DONE
  s_load_dwordx8 s[28:35], s[54:55], 0 glc
  s_waitcnt lgkmcnt(0)
  s_add_u32 s61, s61, 1
  s_cmp_lt_u32 s61, 262144
  s_cbranch_scc1 ACQ0
ACQ0_DONE:
  s_barrier
  buffer_load_dwordx4 v[16:19], v1, s[12:15], s24 offen offset:0 sc1
  buffer_load_dwordx4 v[20:23], v1, s[12:15], s24 offen offset:1024 sc1
  s_mul_i32 s6, s63, 20480
  s_add_u32 s6, s6, 112704
  v_add_u32 v12, s6, v1
  s_mul_i32 s6, s63, 30720
  v_add_u32 v13, s6, v1
  s_mul_i32 s48, s3, 14
  s_cmp_eq_u32 s3, 3
  s_cselect_b32 s48, 41, s48
  s_mul_i32 s49, s5, 54
  s_add_u32 s48, s48, s49
  s_mul_i32 s48, s48, 5120
  s_mul_i32 s49, s3, 10240
  ds_read_b128 v[56:59], v0 offset:0
  ds_read_b128 v[60:63], v0 offset:64
  ds_read_b128 v[64:67], v0 offset:160
  ds_read_b128 v[68:71], v0 offset:224
  ds_read_b128 v[72:75], v0 offset:320
  ds_read_b128 v[76:79], v0 offset:384
  ds_read_b128 v[80:83], v0 offset:480
  ds_read_b128 v[84:87], v0 offset:544
  s_waitcnt lgkmcnt(7)
  v_mfma_f32_16x16x32_bf16 v[144:147], v[56:59], a[0:3], 0
  ds_read_b128 v[88:91], v0 offset:640
  v_mfma_f32_16x16x32_bf16 v[148:151], v[56:59], a[4:7], 0
  buffer_load_dwordx4 v[24:27], v1, s[12:15], s24 offen offset:2048 sc1
  s_waitcnt vmcnt(31) lgkmcnt(7)
  v_mfma_f32_16x16x32_bf16 v[144:147], v[60:63], a[16:19], v[144:147]
  ds_read_b128 v[56:59], v0 offset:704
  s_waitcnt vmcnt(30)
  v_mfma_f32_16x16x32_bf16 v[148:151], v[60:63], a[20:23], v[148:151]
  s_waitcnt vmcnt(29) lgkmcnt(7)
  v_mfma_f32_16x16x32_bf16 v[144:147], v[64:67], a[32:35], v[144:147]
  ds_read_b128 v[60:63], v0 offset:800
  s_waitcnt vmcnt(28)
  v_mfma_f32_16x16x32_bf16 v[148:151], v[64:67], a[36:39], v[148:151]
  s_waitcnt vmcnt(27) lgkmcnt(7)
  v_mfma_f32_16x16x32_bf16 v[144:147], v[68:71], a[48:51], v[144:147]
  s_waitcnt vmcnt(26)
  v_mfma_f32_16x16x32_bf16 v[148:151], v[68:71], a[52:55], v[148:151]
  buffer_load_dwordx4 v[28:31], v1, s[12:15], s24 offen offset:3072 sc1
  s_waitcnt vmcnt(26) lgkmcnt(6)
  v_mfma_f32_16x16x32_bf16 v[144:147], v[72:75], a[64:67], v[144:147]
  s_add_u32 s24, s24, 4096
  s_waitcnt vmcnt(25)
  v_mfma_f32_16x16x32_bf16 v[148:151], v[72:75], a[68:71], v[148:151]
  s_waitcnt vmcnt(24) lgkmcnt(5)
  v_mfma_f32_16x16x32_bf16 v[144:147], v[76:79], a[80:83], v[144:147]
  buffer_load_dwordx4 v[32:35], v1, s[12:15], s24 offen offset:0 sc1
  s_waitcnt vmcnt(24)
  v_mfma_f32_16x16x32_bf16 v[148:151], v[76:79], a[84:87], v[148:151]
  s_waitcnt vmcnt(23) lgkmcnt(4)
  v_mfma_f32_16x16x32_bf16 v[144:147], v[80:83], a[96:99], v[144:147]
  s_waitcnt vmcnt(22)
  v_mfma_f32_16x16x32_bf16 v[148:151], v[80:83], a[100:103], v[148:151]
  buffer_load_dwordx4 v[36:39], v1, s[12:15], s24 offen offset:1024 sc1
  s_waitcnt vmcnt(22) lgkmcnt(3)
  v_mfma_f32_16x16x32_bf16 v[144:147], v[84:87], a[112:115], v[144:147]
  s_waitcnt vmcnt(21)
  v_mfma_f32_16x16x32_bf16 v[148:151], v[84:87], a[116:119], v[148:151]
  s_waitcnt vmcnt(20) lgkmcnt(2)
  v_mfma_f32_16x16x32_bf16 v[144:147], v[88:91], a[128:131], v[144:147]
  buffer_load_dwordx4 v[40:43], v1, s[12:15], s24 offen offset:2048 sc1
  s_waitcnt vmcnt(20)
  v_mfma_f32_16x16x32_bf16 v[148:151], v[88:91], a[132:135], v[148:151]
  s_waitcnt vmcnt(19) lgkmcnt(1)
  v_mfma_f32_16x16x32_bf16 v[144:147], v[56:59], a[144:147], v[144:147]
  s_waitcnt vmcnt(18)
  v_mfma_f32_16x16x32_bf16 v[148:151], v[56:59], a[148:151], v[148:151]
  buffer_load_dwordx4 v[44:47], v1, s[12:15], s24 offen offset:3072 sc1
  s_waitcnt vmcnt(18) lgkmcnt(0)
  v_mfma_f32_16x16x32_bf16 v[144:147], v[60:63], a[160:163], v[144:147]
  s_add_u32 s24, s24, 4096
  s_waitcnt vmcnt(17)
  v_mfma_f32_16x16x32_bf16 v[148:151], v[60:63], a[164:167], v[148:151]
  ds_read_b128 v[56:59], v12 offset:0
  ds_read_b128 v[60:63], v12 offset:1024
  ds_read_b128 v[64:67], v12 offset:4096
  ds_read_b128 v[68:71], v12 offset:2048
  ds_read_b128 v[72:75], v12 offset:3072
  ds_read_b128 v[76:79], v12 offset:5120
  ds_read_b128 v[80:83], v12 offset:6144
  ds_read_b128 v[84:87], v12 offset:9216
  v_add_u32 v4, 158720, v9
  s_add_u32 s6, s101, 158720
  v_add_u32 v112, s6, v8
  s_mul_i32 s7, s5, 160
  ds_read_b128 v[130:133], v112 offset:2624
  ds_read_b64 v[134:135], v4 offset:2752
  v_add_u32 v112, s7, v112
  v_add_u32 v4, s7, v4
  ds_read_b128 v[158:161], v112 offset:1344
  ds_read_b64 v[162:163], v4 offset:1472
  ds_read_b128 v[170:173], v112
  ds_read_b64 v[174:175], v4 offset:128
  s_waitcnt vmcnt(7) lgkmcnt(13)
  v_mfma_f32_16x16x32_bf16 v[92:95], v[56:59], v[16:19], 0
  s_waitcnt lgkmcnt(12)
  ds_read_b128 v[88:91], v12 offset:7168
  buffer_load_dwordx4 v[48:51], v1, s[12:15], s24 offen offset:0 sc1
  v_mfma_f32_16x16x32_bf16 v[96:99], v[60:63], v[16:19], 0
  s_waitcnt lgkmcnt(12)
  ds_read_b128 v[56:59], v12 offset:8192
  v_add_u32 v176, s60, v1
  v_mfma_f32_16x16x32_bf16 v[100:103], v[64:67], v[16:19], 0
  s_waitcnt lgkmcnt(12)
  ds_read_b128 v[60:63], v13 offset:0
  v_xor_b32 v177, 2048, v176
  v_mfma_f32_16x16x32_bf16 v[104:107], v[68:71], v[16:19], 0
  s_waitcnt lgkmcnt(12)
  ds_read_b128 v[64:67], v13 offset:1024
  buffer_load_dwordx4 v[52:55], v1, s[12:15], s24 offen offset:1024 sc1
  v_mfma_f32_16x16x32_bf16 v[108:111], v[72:75], v[16:19], 0
  s_waitcnt vmcnt(8) lgkmcnt(12)
  ds_read_b128 v[68:71], v13 offset:4096
  v_lshrrev_b32 v178, 1, v176
  v_mfma_f32_16x16x32_bf16 v[92:95], v[76:79], v[20:23], v[92:95]
  s_waitcnt lgkmcnt(12)
  ds_read_b128 v[72:75], v13 offset:2048
  buffer_load_dwordx4 a[228:231], v11, s[12:15], s53 offen offset:1024 sc1
  s_add_u32 s24, s24, 32768
  s_barrier
  s_cmp_lg_u32 s3, 0
  s_cbranch_scc1 SK26
  s_add_u32 s6, s52, 4096
  buffer_store_dword v14, v10, s[12:15], s6 offen sc1
SK26:
  v_mfma_f32_16x16x32_bf16 v[96:99], v[80:83], v[20:23], v[96:99]
  s_waitcnt lgkmcnt(12)
  ds_read_b128 v[76:79], v13 offset:3072
  v_lshrrev_b32 v179, 1, v1
  v_mfma_f32_16x16x32_bf16 v[100:103], v[84:87], v[20:23], v[100:103]
  s_waitcnt lgkmcnt(6)
  ds_read_b128 v[80:83], v13 offset:5120
  v_add_u32 v176, 102400, v176
  v_mfma_f32_16x16x32_bf16 v[104:107], v[88:91], v[20:23], v[104:107]
  s_waitcnt lgkmcnt(6)
  ds_read_b128 v[84:87], v13 offset:6144
  buffer_load_dwordx4 a[240:243], v11, s[12:15], s53 offen offset:2048 sc1
  v_mfma_f32_16x16x32_bf16 v[108:111], v[56:59], v[20:23], v[108:111]
  s_waitcnt vmcnt(9) lgkmcnt(6)
  ds_read_b128 v[88:91], v13 offset:9216
  v_lshlrev_b32 v124, 16, v130
  v_mfma_f32_16x16x32_bf16 v[92:95], v[60:63], v[24:27], v[92:95]
  s_waitcnt lgkmcnt(6)
  ds_read_b128 v[56:59], v13 offset:7168
  v_and_b32 v125, 0xffff0000, v130
  v_mfma_f32_16x16x32_bf16 v[96:99], v[64:67], v[24:27], v[96:99]
  s_waitcnt lgkmcnt(6)
  ds_read_b128 v[60:63], v13 offset:8192
  buffer_load_dwordx4 a[244:247], v11, s[12:15], s53 offen offset:3072 sc1
  v_mfma_f32_16x16x32_bf16 v[100:103], v[68:71], v[24:27], v[100:103]
  s_waitcnt lgkmcnt(6)
  ds_read_b128 v[64:67], v13 offset:10240
  v_lshlrev_b32 v126, 16, v131
  v_mfma_f32_16x16x32_bf16 v[104:107], v[72:75], v[24:27], v[104:107]
  s_waitcnt lgkmcnt(6)
  ds_read_b128 v[68:71], v13 offset:11264
  v_and_b32 v127, 0xffff0000, v131
  v_mfma_f32_16x16x32_bf16 v[108:111], v[76:79], v[24:27], v[108:111]
  s_waitcnt vmcnt(9) lgkmcnt(6)
  ds_read_b128 v[72:75], v13 offset:14336
  s_add_u32 s53, s53, 4096
  buffer_load_dwordx4 v[192:195], v11, s[12:15], s53 offen offset:0 sc1
  v_mfma_f32_16x16x32_bf16 v[92:95], v[80:83], v[28:31], v[92:95]
  s_waitcnt lgkmcnt(6)
  ds_read_b128 v[76:79], v13 offset:12288
  v_lshlrev_b32 v128, 16, v132
  v_mfma_f32_16x16x32_bf16 v[96:99], v[84:87], v[28:31], v[96:99]
  s_waitcnt lgkmcnt(6)
  ds_read_b128 v[80:83], v13 offset:13312
  v_and_b32 v129, 0xffff0000, v132
  v_mfma_f32_16x16x32_bf16 v[100:103], v[88:91], v[28:31], v[100:103]
  s_waitcnt lgkmcnt(6)
  ds_read_b128 v[84:87], v12 offset:10240
  buffer_load_dwordx4 v[196:199], v11, s[12:15], s53 offen offset:1024 sc1
  v_mfma_f32_16x16x32_bf16 v[104:107], v[56:59], v[28:31], v[104:107]
  s_waitcnt lgkmcnt(6)
  ds_read_b128 v[88:91], v12 offset:11264
  v_lshlrev_b32 v130, 16, v133
  v_mfma_f32_16x16x32_bf16 v[108:111], v[60:63], v[28:31], v[108:111]
  s_waitcnt vmcnt(10) lgkmcnt(6)
  ds_read_b128 v[56:59], v12 offset:14336
  buffer_load_dwordx4 v[208:211], v11, s[12:15], s53 offen offset:2048 sc1
  v_mfma_f32_16x16x32_bf16 v[92:95], v[64:67], v[32:35], v[92:95]
  s_waitcnt lgkmcnt(6)
  ds_read_b128 v[60:63], v12 offset:12288
  v_and_b32 v131, 0xffff0000, v133
  v_mfma_f32_16x16x32_bf16 v[96:99], v[68:71], v[32:35], v[96:99]
  s_waitcnt lgkmcnt(6)
  ds_read_b128 v[64:67], v12 offset:13312
  v_lshlrev_b32 v152, 16, v158
  v_mfma_f32_16x16x32_bf16 v[100:103], v[72:75], v[32:35], v[100:103]
  s_waitcnt lgkmcnt(6)
  ds_read_b128 v[68:71], v12 offset:15360
  buffer_load_dwordx4 v[212:215], v11, s[12:15], s53 offen offset:3072 sc1
  v_mfma_f32_16x16x32_bf16 v[104:107], v[76:79], v[32:35], v[104:107]
  s_waitcnt lgkmcnt(6)
  ds_read_b128 v[72:75], v12 offset:16384
  v_and_b32 v153, 0xffff0000, v158
  v_mfma_f32_16x16x32_bf16 v[108:111], v[80:83], v[32:35], v[108:111]
  s_waitcnt vmcnt(11) lgkmcnt(6)
  ds_read_b128 v[76:79], v12 offset:19456
  v_lshlrev_b32 v154, 16, v159
  v_mfma_f32_16x16x32_bf16 v[92:95], v[84:87], v[36:39], v[92:95]
  s_waitcnt lgkmcnt(6)
  ds_read_b128 v[80:83], v12 offset:17408
  s_add_u32 s53, s53, 4096
  buffer_load_dwordx4 v[224:227], v11, s[12:15], s53 offen offset:0 sc1
  v_mfma_f32_16x16x32_bf16 v[96:99], v[88:91], v[36:39], v[96:99]
  s_waitcnt lgkmcnt(6)
  ds_read_b128 v[84:87], v12 offset:18432
  v_and_b32 v155, 0xffff0000, v159
  v_mfma_f32_16x16x32_bf16 v[100:103], v[56:59], v[36:39], v[100:103]
  s_waitcnt lgkmcnt(6)
  ds_read_b128 v[88:91], v13 offset:15360
  v_lshlrev_b32 v156, 16, v160
  v_mfma_f32_16x16x32_bf16 v[104:107], v[60:63], v[36:39], v[104:107]
  s_waitcnt lgkmcnt(6)
  ds_read_b128 v[56:59], v13 offset:16384
  buffer_load_dwordx4 v[228:231], v11, s[12:15], s53 offen offset:1024 sc1
  v_mfma_f32_16x16x32_bf16 v[108:111], v[64:67], v[36:39], v[108:111]
  s_waitcnt vmcnt(12) lgkmcnt(6)
  ds_read_b128 v[60:63], v13 offset:19456
  v_and_b32 v157, 0xffff0000, v160
  v_mfma_f32_16x16x32_bf16 v[92:95], v[68:71], v[40:43], v[92:95]
  s_waitcnt lgkmcnt(6)
  ds_read_b128 v[64:67], v13 offset:17408
  v_lshlrev_b32 v158, 16, v161
  v_mfma_f32_16x16x32_bf16 v[96:99], v[72:75], v[40:43], v[96:99]
  s_waitcnt lgkmcnt(6)
  ds_read_b128 v[68:71], v13 offset:18432
  buffer_load_dwordx4 v[240:243], v11, s[12:15], s53 offen offset:2048 sc1
  v_mfma_f32_16x16x32_bf16 v[100:103], v[76:79], v[40:43], v[100:103]
  s_waitcnt vmcnt(10) lgkmcnt(6)
  ds_read_b128 v[72:75], v13 offset:20480
  v_and_b32 v159, 0xffff0000, v161
  v_mfma_f32_16x16x32_bf16 v[104:107], v[80:83], v[40:43], v[104:107]
  s_waitcnt lgkmcnt(6)
  ds_read_b128 v[76:79], v13 offset:21504
  v_lshlrev_b32 v160, 16, v162
  v_mfma_f32_16x16x32_bf16 v[108:111], v[84:87], v[40:43], v[108:111]
  s_waitcnt lgkmcnt(6)
  ds_read_b128 v[80:83], v13 offset:24576
  buffer_load_dwordx4 v[244:247], v11, s[12:15], s53 offen offset:3072 sc1
  v_mfma_f32_16x16x32_bf16 v[92:95], v[88:91], v[44:47], v[92:95]
  s_waitcnt lgkmcnt(6)
  ds_read_b128 v[84:87], v13 offset:22528
  v_and_b32 v161, 0xffff0000, v162
  v_mfma_f32_16x16x32_bf16 v[96:99], v[56:59], v[44:47], v[96:99]
  s_waitcnt lgkmcnt(6)
  ds_read_b128 v[88:91], v13 offset:23552
  v_lshlrev_b32 v162, 16, v163
  v_mfma_f32_16x16x32_bf16 v[100:103], v[60:63], v[44:47], v[100:103]
  s_waitcnt lgkmcnt(6)
  ds_read_b128 v[56:59], v13 offset:27648
  s_add_u32 s53, s53, 4096
  s_add_u32 m0, s49, 61440
  s_add_u32 s43, s48, 5718016
  buffer_load_dwordx4 v1, s[12:15], s43 offen offset:0 sc1 lds
  v_mfma_f32_16x16x32_bf16 v[104:107], v[64:67], v[44:47], v[104:107]
  s_waitcnt lgkmcnt(6)
  ds_read_b128 v[60:63], v13 offset:28672
  v_and_b32 v163, 0xffff0000, v163
  v_mfma_f32_16x16x32_bf16 v[108:111], v[68:71], v[44:47], v[108:111]
  s_waitcnt lgkmcnt(6)
  ds_read_b128 v[64:67], v13 offset:29696
  buffer_load_dwordx4 v1, s[12:15], s43 offen offset:1024 sc1 lds
  v_mfma_f32_16x16x32_bf16 v[92:95], v[72:75], v[48:51], v[92:95]
  s_waitcnt lgkmcnt(6)
  ds_read_b128 v[68:71], v13 offset:25600
  v_lshlrev_b32 v164, 16, v170
  v_mfma_f32_16x16x32_bf16 v[96:99], v[76:79], v[48:51], v[96:99]
  s_waitcnt lgkmcnt(6)
  ds_read_b128 v[72:75], v13 offset:26624
  v_and_b32 v165, 0xffff0000, v170
  v_mfma_f32_16x16x32_bf16 v[100:103], v[80:83], v[48:51], v[100:103]
  s_waitcnt lgkmcnt(6)
  buffer_load_dwordx4 v1, s[12:15], s43 offen offset:2048 sc1 lds
  v_mfma_f32_16x16x32_bf16 v[104:107], v[84:87], v[48:51], v[104:107]
  s_waitcnt lgkmcnt(5)
  s_cmp_lt_u32 s3, 2
  s_cselect_b32 s62, -1, 0
  v_mfma_f32_16x16x32_bf16 v[108:111], v[88:91], v[48:51], v[108:111]
  s_waitcnt lgkmcnt(4)
  v_and_b32 v134, s62, v134
  v_and_b32 v135, s62, v135
  v_mfma_f32_16x16x32_bf16 v[104:107], v[56:59], v[52:55], v[104:107]
  s_waitcnt lgkmcnt(3)
  buffer_load_dwordx4 v1, s[12:15], s43 offen offset:3072 sc1 lds
  v_mfma_f32_16x16x32_bf16 v[108:111], v[60:63], v[52:55], v[108:111]
  s_waitcnt lgkmcnt(2)
  v_lshlrev_b32 v132, 16, v134
  v_and_b32 v133, 0xffff0000, v134
  v_mfma_f32_16x16x32_bf16 v[100:103], v[64:67], v[52:55], v[100:103]
  s_waitcnt lgkmcnt(1)
  v_lshlrev_b32 v134, 16, v135
  v_and_b32 v135, 0xffff0000, v135
  v_mfma_f32_16x16x32_bf16 v[92:95], v[68:71], v[52:55], v[92:95]
  s_waitcnt lgkmcnt(0)
  s_add_u32 m0, s49, 65536
  s_add_u32 s43, s48, 5722112
  buffer_load_dwordx4 v1, s[12:15], s43 offen offset:0 sc1 lds
  v_mfma_f32_16x16x32_bf16 v[96:99], v[72:75], v[52:55], v[96:99]
  s_lshl_b32 s96, s5, 1
  v_lshlrev_b32 v166, 16, v171
  v_and_b32 v167, 0xffff0000, v171
  v_lshlrev_b32 v168, 16, v172
  v_and_b32 v169, 0xffff0000, v172
  v_lshlrev_b32 v170, 16, v173
  v_and_b32 v171, 0xffff0000, v173
  v_lshlrev_b32 v172, 16, v174
  v_and_b32 v173, 0xffff0000, v174
  v_lshlrev_b32 v174, 16, v175
  v_and_b32 v175, 0xffff0000, v175
  v_add_u32 v177, 102400, v177
  v_add_u32 v178, 110592, v178
  v_add_u32 v179, 110592, v179
  s_add_u32 s96, s96, s63
  s_lshl_b32 s96, s96, 10
  s_add_u32 s96, s96, s25
  s_lshr_b32 s95, s5, 1
  s_lshl_b32 s95, s95, 10
  s_add_u32 s95, s95, s25
  s_and_b32 s7, s5, 1
  s_lshl_b32 s7, s7, 3
  s_add_u32 s95, s95, s7
  s_add_u32 s95, s95, 16384
  s_lshl_b32 s26, s4, 14
  s_lshl_b32 s7, s5, 10
  s_add_u32 s26, s26, s7
  s_add_u32 s26, s26, 21299200
  s_cmp_lg_u32 s3, 0
  s_cmov_b32 s26, 100663296
  v_lshlrev_b32 v56, 16, v180
  v_and_b32 v57, 0xffff0000, v180
  v_lshlrev_b32 v58, 16, v181
  v_and_b32 v59, 0xffff0000, v181
  ds_write_b128 v176, v[104:107]
  ds_write_b128 v176, v[108:111] offset:4096
  ds_write_b128 v176, v[100:103] offset:51264
  s_waitcnt lgkmcnt(0)
  s_barrier
  ds_read_b128 v[112:115], v177
  ds_read_b128 v[116:119], v177 offset:4096
  ds_read_b128 v[120:123], v177 offset:51264
  v_lshlrev_b32 v60, 16, v182
  v_and_b32 v61, 0xffff0000, v182
  v_lshlrev_b32 v62, 16, v183
  v_and_b32 v63, 0xffff0000, v183
  v_lshlrev_b32 v64, 16, v184
  v_and_b32 v65, 0xffff0000, v184
  v_lshlrev_b32 v66, 16, v185
  v_and_b32 v67, 0xffff0000, v185
  v_pk_fma_f32 v[56:57], v[92:93], v[124:125], v[56:57]
  v_pk_fma_f32 v[58:59], v[94:95], v[126:127], v[58:59]
  v_pk_fma_f32 v[60:61], v[96:97], v[128:129], v[60:61]
  v_pk_fma_f32 v[62:63], v[98:99], v[130:131], v[62:63]
  v_pk_fma_f32 v[64:65], v[100:101], v[132:133], v[64:65]
  v_pk_fma_f32 v[66:67], v[102:103], v[134:135], v[66:67]
  s_waitcnt lgkmcnt(2)
  v_pk_fma_f32 v[56:57], v[112:113], v[124:125], v[56:57]
  v_pk_fma_f32 v[58:59], v[114:115], v[126:127], v[58:59]
  s_waitcnt lgkmcnt(1)
  v_pk_fma_f32 v[60:61], v[116:117], v[128:129], v[60:61]
  v_pk_fma_f32 v[62:63], v[118:119], v[130:131], v[62:63]
  s_waitcnt lgkmcnt(0)
  v_pk_fma_f32 v[64:65], v[120:121], v[132:133], v[64:65]
  v_pk_fma_f32 v[66:67], v[122:123], v[134:135], v[66:67]
  s_cmp_lg_u32 s3, 0
  s_cbranch_scc1 PI1
  s_load_dwordx8 s[28:35], s[54:55], 4096 glc
PI1:
  v_pk_mul_f32 v[68:69], v[56:57], v[152:153]
  v_pk_mul_f32 v[70:71], v[58:59], v[154:155]
  v_pk_mul_f32 v[72:73], v[60:61], v[156:157]
  v_pk_mul_f32 v[74:75], v[62:63], v[158:159]
  v_pk_mul_f32 v[76:77], v[64:65], v[160:161]
  v_pk_mul_f32 v[78:79], v[66:67], v[162:163]
  v_cvt_pk_bf16_f32 v112, v68, v69
  v_cvt_pk_bf16_f32 v113, v70, v71
  v_cvt_pk_bf16_f32 v114, v72, v73
  v_cvt_pk_bf16_f32 v115, v74, v75
  v_cvt_pk_bf16_f32 v116, v76, v77
  v_cvt_pk_bf16_f32 v117, v78, v79
  buffer_store_dwordx4 v[112:115], v1, s[12:15], s96 offen sc1
  s_cmp_ge_u32 s3, 2
  s_cbranch_scc1 SK27
  buffer_store_dwordx2 v[116:117], v1, s[12:15], s95 offen sc1
SK27:
  v_pk_add_f32 v[80:81], v[56:57], v[58:59]
  v_pk_mul_f32 v[82:83], v[56:57], v[56:57]
  v_pk_add_f32 v[84:85], v[68:69], v[70:71]
  v_pk_mul_f32 v[86:87], v[68:69], v[152:153]
  v_pk_mul_f32 v[88:89], v[68:69], v[68:69]
  v_pk_mul_f32 v[90:91], v[68:69], v[164:165]
  v_pk_fma_f32 v[82:83], v[58:59], v[58:59], v[82:83]
  v_pk_fma_f32 v[86:87], v[70:71], v[154:155], v[86:87]
  v_pk_fma_f32 v[88:89], v[70:71], v[70:71], v[88:89]
  v_pk_fma_f32 v[90:91], v[70:71], v[166:167], v[90:91]
  v_pk_add_f32 v[80:81], v[80:81], v[60:61]
  v_pk_fma_f32 v[82:83], v[60:61], v[60:61], v[82:83]
  v_pk_add_f32 v[84:85], v[84:85], v[72:73]
  v_pk_fma_f32 v[86:87], v[72:73], v[156:157], v[86:87]
  v_pk_fma_f32 v[88:89], v[72:73], v[72:73], v[88:89]
  v_pk_fma_f32 v[90:91], v[72:73], v[168:169], v[90:91]
  v_pk_add_f32 v[80:81], v[80:81], v[62:63]
  v_pk_fma_f32 v[82:83], v[62:63], v[62:63], v[82:83]
  v_pk_add_f32 v[84:85], v[84:85], v[74:75]
  v_pk_fma_f32 v[86:87], v[74:75], v[158:159], v[86:87]
  v_pk_fma_f32 v[88:89], v[74:75], v[74:75], v[88:89]
  v_pk_fma_f32 v[90:91], v[74:75], v[170:171], v[90:91]
  v_pk_add_f32 v[80:81], v[80:81], v[64:65]
  v_pk_fma_f32 v[82:83], v[64:65], v[64:65], v[82:83]
  v_pk_add_f32 v[84:85], v[84:85], v[76:77]
  v_pk_fma_f32 v[86:87], v[76:77], v[160:161], v[86:87]
  v_pk_fma_f32 v[88:89], v[76:77], v[76:77], v[88:89]
  v_pk_fma_f32 v[90:91], v[76:77], v[172:173], v[90:91]
  v_pk_add_f32 v[80:81], v[80:81], v[66:67]
  v_pk_fma_f32 v[82:83], v[66:67], v[66:67], v[82:83]
  v_pk_add_f32 v[84:85], v[84:85], v[78:79]
  v_pk_fma_f32 v[86:87], v[78:79], v[162:163], v[86:87]
  v_pk_fma_f32 v[88:89], v[78:79], v[78:79], v[88:89]
  v_pk_fma_f32 v[90:91], v[78:79], v[174:175], v[90:91]
  v_add_f32 v92, v80, v81
  v_add_f32 v93, v82, v83
  v_add_f32 v94, v84, v85
  v_add_f32 v95, v86, v87
  v_add_f32 v96, v88, v89
  v_add_f32 v97, v90, v91
  v_permlane32_swap_b32 v92, v93
  v_permlane32_swap_b32 v94, v95
  v_permlane32_swap_b32 v96, v97
  v_add_f32 v92, v92, v93
  v_add_f32 v94, v94, v95
  v_add_f32 v93, v96, v97
  v_add_f32 v95, v96, v97
  v_permlane16_swap_b32 v92, v94
  s_nop 0
  v_permlane16_swap_b32 v93, v95
  v_add_f32 v92, v92, v94
  v_add_f32 v93, v93, v95
  ds_write_b64 v178, v[92:93]
  s_waitcnt lgkmcnt(0)
  s_mov_b32 s61, 0
  s_cmp_lg_u32 s3, 0
  s_cbranch_scc1 ACQ1_DONE
ACQ1:
  s_xor_b32 s28, s28, s94
  s_xor_b32 s29, s29, s94
  s_xor_b32 s30, s30, s94
  s_xor_b32 s31, s31, s94
  s_xor_b32 s32, s32, s94
  s_xor_b32 s33, s33, s94
  s_xor_b32 s34, s34, s94
  s_xor_b32 s35, s35, s94
  s_or_b64 s[28:29], s[28:29], s[30:31]
  s_or_b64 s[28:29], s[28:29], s[32:33]
  s_or_b64 s[28:29], s[28:29], s[34:35]
  s_cbranch_scc0 ACQ1_DONE
  s_load_dwordx8 s[28:35], s[54:55], 4096 glc
  s_waitcnt lgkmcnt(0)
  s_add_u32 s61, s61, 1
  s_cmp_lt_u32 s61, 262144
  s_cbranch_scc1 ACQ1
ACQ1_DONE:
  s_barrier
  ds_read_b64 v[92:93], v179 offset:0
  ds_read_b64 v[94:95], v179 offset:512
  ds_read_b64 v[96:97], v179 offset:1024
  ds_read_b64 v[98:99], v179 offset:1536
  v_cvt_pk_bf16_f32 v180, v56, v57
  v_cvt_pk_bf16_f32 v181, v58, v59
  v_cvt_pk_bf16_f32 v182, v60, v61
  v_cvt_pk_bf16_f32 v183, v62, v63
  v_cvt_pk_bf16_f32 v184, v64, v65
  v_cvt_pk_bf16_f32 v185, v66, v67
  s_waitcnt lgkmcnt(1)
  v_pk_add_f32 v[92:93], v[92:93], v[96:97]
  s_waitcnt lgkmcnt(0)
  v_pk_add_f32 v[94:95], v[94:95], v[98:99]
  buffer_store_dwordx4 v[92:95], v1, s[12:15], s26 offen sc1
  buffer_load_dwordx4 v[16:19], v1, s[12:15], s24 offen offset:0 sc1
  buffer_load_dwordx4 v[20:23], v1, s[12:15], s24 offen offset:1024 sc1
  ds_read_b128 v[64:67], v0 offset:864
  ds_read_b128 v[68:71], v0 offset:960
  ds_read_b128 v[72:75], v0 offset:1024
  ds_read_b128 v[76:79], v0 offset:1120
  ds_read_b128 v[80:83], v0 offset:1184
  ds_read_b64 v[84:85], v15 offset:128
  ds_read_b64 v[86:87], v15 offset:288
  ds_read_b64 v[88:89], v15 offset:448
  ds_read_b64 v[90:91], v15 offset:608
  ds_read_b64 v[56:57], v15 offset:768
  ds_read_b64 v[58:59], v15 offset:928
  s_lshl_b32 s6, s50, 5
  v_xor_b32 v4, s6, v2
  s_lshl_b32 s6, s3, 7
  s_add_u32 s6, s6, 157760
  v_lshl_add_u32 v4, v4, 1, s6
  v_mov_b32 v108, 0
  ds_read_u16_d16_hi v108, v4
  s_waitcnt vmcnt(3)
  s_barrier
  s_cmp_lg_u32 s3, 0
  s_cbranch_scc1 SK28
  s_add_u32 s6, s52, 8192
  buffer_store_dword v14, v10, s[12:15], s6 offen sc1
SK28:
  s_waitcnt lgkmcnt(11)
  v_mfma_f32_16x16x32_bf16 v[144:147], v[64:67], a[176:179], v[144:147]
  ds_read_b64 v[60:61], v15 offset:1088
  ds_read_b64 v[62:63], v15 offset:1248
  v_mfma_f32_16x16x32_bf16 v[148:151], v[64:67], a[180:183], v[148:151]
  buffer_load_dwordx4 v[24:27], v1, s[12:15], s24 offen offset:2048 sc1
  s_waitcnt lgkmcnt(12)
  v_mfma_f32_16x16x32_bf16 v[144:147], v[68:71], a[192:195], v[144:147]
  v_mfma_f32_16x16x32_bf16 v[148:151], v[68:71], a[196:199], v[148:151]
  s_waitcnt lgkmcnt(11)
  v_mfma_f32_16x16x32_bf16 v[144:147], v[72:75], a[208:211], v[144:147]
  buffer_load_dwordx4 v[28:31], v1, s[12:15], s24 offen offset:3072 sc1
  v_mfma_f32_16x16x32_bf16 v[148:151], v[72:75], a[212:215], v[148:151]
  s_add_u32 s24, s24, 4096
  s_waitcnt lgkmcnt(10)
  v_mfma_f32_16x16x32_bf16 v[144:147], v[76:79], a[224:227], v[144:147]
  v_mfma_f32_16x16x32_bf16 v[148:151], v[76:79], a[228:231], v[148:151]
  buffer_load_dwordx4 v[32:35], v1, s[12:15], s24 offen offset:0 sc1
  s_waitcnt lgkmcnt(9)
  v_mfma_f32_16x16x32_bf16 v[144:147], v[80:83], a[240:243], v[144:147]
  v_mfma_f32_16x16x32_bf16 v[148:151], v[80:83], a[244:247], v[148:151]
  s_waitcnt lgkmcnt(7)
  v_mfma_f32_16x16x32_bf16 v[144:147], v[84:87], v[192:195], v[144:147]
  buffer_load_dwordx4 v[36:39], v1, s[12:15], s24 offen offset:1024 sc1
  v_mfma_f32_16x16x32_bf16 v[148:151], v[84:87], v[196:199], v[148:151]
  s_waitcnt lgkmcnt(5)
  v_mfma_f32_16x16x32_bf16 v[144:147], v[88:91], v[208:211], v[144:147]
  v_mfma_f32_16x16x32_bf16 v[148:151], v[88:91], v[212:215], v[148:151]
  buffer_load_dwordx4 v[40:43], v1, s[12:15], s24 offen offset:2048 sc1
  s_waitcnt lgkmcnt(3)
  v_mfma_f32_16x16x32_bf16 v[144:147], v[56:59], v[224:227], v[144:147]
  v_mfma_f32_16x16x32_bf16 v[148:151], v[56:59], v[228:231], v[148:151]
  s_waitcnt lgkmcnt(0)
  v_mfma_f32_16x16x32_bf16 v[144:147], v[60:63], v[240:243], v[144:147]
  buffer_load_dwordx4 v[44:47], v1, s[12:15], s24 offen offset:3072 sc1
  v_mfma_f32_16x16x32_bf16 v[148:151], v[60:63], v[244:247], v[148:151]
  s_add_u32 s24, s24, 4096
  v_mov_b32 v109, v108
  s_nop 1
  v_permlane16_swap_b32 v108, v109
  v_mov_b32 v110, v108
  v_mov_b32 v111, v109
  s_nop 0
  v_permlane32_swap_b32 v108, v110
  v_permlane32_swap_b32 v109, v111
  v_cvt_pk_bf16_f32 v137, v146, v108
  v_cvt_pk_bf16_f32 v136, v144, v145
  v_lshlrev_b32 v120, 16, v136
  v_and_b32 v121, 0xffff0000, v136
  v_lshlrev_b32 v122, 16, v137
  v_sub_f32 v120, v144, v120
  v_sub_f32 v121, v145, v121
  v_sub_f32 v122, v146, v122
  v_cvt_pk_bf16_f32 v138, v120, v121
  v_cvt_pk_bf16_f32 v139, v122, 0
  v_cvt_pk_bf16_f32 v141, v150, v109
  v_cvt_pk_bf16_f32 v140, v148, v149
  v_lshlrev_b32 v120, 16, v140
  v_and_b32 v121, 0xffff0000, v140
  v_lshlrev_b32 v122, 16, v141
  v_sub_f32 v120, v148, v120
  v_sub_f32 v121, v149, v121
  v_sub_f32 v122, v150, v122
  v_cvt_pk_bf16_f32 v142, v120, v121
  v_cvt_pk_bf16_f32 v143, v122, 0
  v_mov_b32 v144, v110
  v_mov_b32 v148, v111
  ds_read_b128 v[56:59], v12 offset:0
  ds_read_b128 v[60:63], v12 offset:1024
  ds_read_b128 v[64:67], v12 offset:4096
  ds_read_b128 v[68:71], v12 offset:2048
  ds_read_b128 v[72:75], v12 offset:3072
  ds_read_b128 v[76:79], v12 offset:5120
  ds_read_b128 v[80:83], v12 offset:6144
  ds_read_b128 v[84:87], v12 offset:9216
  s_waitcnt vmcnt(7) lgkmcnt(7)
  v_mfma_f32_16x16x32_bf16 v[92:95], v[56:59], v[16:19], 0
  s_waitcnt lgkmcnt(6)
  ds_read_b128 v[88:91], v12 offset:7168
  buffer_load_dwordx4 v[48:51], v1, s[12:15], s24 offen offset:0 sc1
  v_mfma_f32_16x16x32_bf16 v[96:99], v[60:63], v[16:19], 0
  s_waitcnt lgkmcnt(6)
  ds_read_b128 v[56:59], v12 offset:8192
  s_add_u32 s96, s96, 40960
  s_cmp_lg_u32 s3, 0
  s_cbranch_scc1 SK29
  s_add_u32 s6, s52, 28672
  buffer_store_dword v14, v10, s[12:15], s6 offen sc1
SK29:
  v_mfma_f32_16x16x32_bf16 v[100:103], v[64:67], v[16:19], 0
  s_waitcnt lgkmcnt(6)
  ds_read_b128 v[60:63], v13 offset:0
  s_add_u32 s95, s95, 40960
  v_mfma_f32_16x16x32_bf16 v[104:107], v[68:71], v[16:19], 0
  s_waitcnt lgkmcnt(6)
  ds_read_b128 v[64:67], v13 offset:1024
  buffer_load_dwordx4 v[52:55], v1, s[12:15], s24 offen offset:1024 sc1
  v_mfma_f32_16x16x32_bf16 v[108:111], v[72:75], v[16:19], 0
  s_waitcnt vmcnt(8) lgkmcnt(6)
  ds_read_b128 v[68:71], v13 offset:4096
  s_add_u32 s26, s26, 8192
  v_mfma_f32_16x16x32_bf16 v[92:95], v[76:79], v[20:23], v[92:95]
  s_waitcnt lgkmcnt(6)
  ds_read_b128 v[72:75], v13 offset:2048
  buffer_load_dwordx4 v1, s[12:15], s43 offen offset:1024 sc1 lds
  v_mfma_f32_16x16x32_bf16 v[96:99], v[80:83], v[20:23], v[96:99]
  s_waitcnt lgkmcnt(6)
  ds_read_b128 v[76:79], v13 offset:3072
  s_add_u32 s24, s24, 32768
  v_mfma_f32_16x16x32_bf16 v[100:103], v[84:87], v[20:23], v[100:103]
  s_waitcnt lgkmcnt(6)
  ds_read_b128 v[80:83], v13 offset:5120
  v_mfma_f32_16x16x32_bf16 v[104:107], v[88:91], v[20:23], v[104:107]
  s_waitcnt lgkmcnt(6)
  ds_read_b128 v[84:87], v13 offset:6144
  buffer_load_dwordx4 v1, s[12:15], s43 offen offset:2048 sc1 lds
  v_mfma_f32_16x16x32_bf16 v[108:111], v[56:59], v[20:23], v[108:111]
  s_waitcnt vmcnt(9) lgkmcnt(6)
  ds_read_b128 v[88:91], v13 offset:9216
  v_mfma_f32_16x16x32_bf16 v[92:95], v[60:63], v[24:27], v[92:95]
  s_waitcnt lgkmcnt(6)
  ds_read_b128 v[56:59], v13 offset:7168
  v_mfma_f32_16x16x32_bf16 v[96:99], v[64:67], v[24:27], v[96:99]
  s_waitcnt lgkmcnt(6)
  ds_read_b128 v[60:63], v13 offset:8192
  buffer_load_dwordx4 v1, s[12:15], s43 offen offset:3072 sc1 lds
  v_mfma_f32_16x16x32_bf16 v[100:103], v[68:71], v[24:27], v[100:103]
  s_waitcnt lgkmcnt(6)
  ds_read_b128 v[64:67], v13 offset:10240
  v_mfma_f32_16x16x32_bf16 v[104:107], v[72:75], v[24:27], v[104:107]
  s_waitcnt lgkmcnt(6)
  ds_read_b128 v[68:71], v13 offset:11264
  v_mfma_f32_16x16x32_bf16 v[108:111], v[76:79], v[24:27], v[108:111]
  s_waitcnt vmcnt(9) lgkmcnt(6)
  ds_read_b128 v[72:75], v13 offset:14336
  s_add_u32 m0, s49, 69632
  s_add_u32 s43, s48, 5726208
  buffer_load_dwordx4 v1, s[12:15], s43 offen offset:0 sc1 lds
  v_mfma_f32_16x16x32_bf16 v[92:95], v[80:83], v[28:31], v[92:95]
  s_waitcnt lgkmcnt(6)
  ds_read_b128 v[76:79], v13 offset:12288
  v_mfma_f32_16x16x32_bf16 v[96:99], v[84:87], v[28:31], v[96:99]
  s_waitcnt lgkmcnt(6)
  ds_read_b128 v[80:83], v13 offset:13312
  v_mfma_f32_16x16x32_bf16 v[100:103], v[88:91], v[28:31], v[100:103]
  s_waitcnt lgkmcnt(6)
  ds_read_b128 v[84:87], v12 offset:10240
  buffer_load_dwordx4 v1, s[12:15], s43 offen offset:1024 sc1 lds
  v_mfma_f32_16x16x32_bf16 v[104:107], v[56:59], v[28:31], v[104:107]
  s_waitcnt lgkmcnt(6)
  ds_read_b128 v[88:91], v12 offset:11264
  v_mfma_f32_16x16x32_bf16 v[108:111], v[60:63], v[28:31], v[108:111]
  s_waitcnt vmcnt(10) lgkmcnt(6)
  ds_read_b128 v[56:59], v12 offset:14336
  buffer_load_dwordx4 a[8:11], v1, s[12:15], s27 offen offset:0 sc1
  v_mfma_f32_16x16x32_bf16 v[92:95], v[64:67], v[32:35], v[92:95]
  s_waitcnt lgkmcnt(6)
  ds_read_b128 v[60:63], v12 offset:12288
  v_mfma_f32_16x16x32_bf16 v[96:99], v[68:71], v[32:35], v[96:99]
  s_waitcnt lgkmcnt(6)
  ds_read_b128 v[64:67], v12 offset:13312
  v_mfma_f32_16x16x32_bf16 v[100:103], v[72:75], v[32:35], v[100:103]
  s_waitcnt lgkmcnt(6)
  ds_read_b128 v[68:71], v12 offset:15360
  buffer_load_dwordx4 a[12:15], v1, s[12:15], s27 offen offset:1024 sc1
  v_mfma_f32_16x16x32_bf16 v[104:107], v[76:79], v[32:35], v[104:107]
  s_waitcnt lgkmcnt(6)
  ds_read_b128 v[72:75], v12 offset:16384
  s_add_u32 s27, s27, s42
  v_mfma_f32_16x16x32_bf16 v[108:111], v[80:83], v[32:35], v[108:111]
  s_waitcnt vmcnt(11) lgkmcnt(6)
  ds_read_b128 v[76:79], v12 offset:19456
  v_mfma_f32_16x16x32_bf16 v[92:95], v[84:87], v[36:39], v[92:95]
  s_waitcnt lgkmcnt(6)
  ds_read_b128 v[80:83], v12 offset:17408
  buffer_load_dwordx4 a[24:27], v1, s[12:15], s27 offen offset:0 sc1
  v_mfma_f32_16x16x32_bf16 v[96:99], v[88:91], v[36:39], v[96:99]
  s_waitcnt lgkmcnt(6)
  ds_read_b128 v[84:87], v12 offset:18432
  v_mfma_f32_16x16x32_bf16 v[100:103], v[56:59], v[36:39], v[100:103]
  s_waitcnt lgkmcnt(6)
  ds_read_b128 v[88:91], v13 offset:15360
  v_mfma_f32_16x16x32_bf16 v[104:107], v[60:63], v[36:39], v[104:107]
  s_waitcnt lgkmcnt(6)
  ds_read_b128 v[56:59], v13 offset:16384
  buffer_load_dwordx4 a[28:31], v1, s[12:15], s27 offen offset:1024 sc1
  v_mfma_f32_16x16x32_bf16 v[108:111], v[64:67], v[36:39], v[108:111]
  s_waitcnt vmcnt(12) lgkmcnt(6)
  ds_read_b128 v[60:63], v13 offset:19456
  s_add_u32 s27, s27, s42
  v_mfma_f32_16x16x32_bf16 v[92:95], v[68:71], v[40:43], v[92:95]
  s_waitcnt lgkmcnt(6)
  ds_read_b128 v[64:67], v13 offset:17408
  v_mfma_f32_16x16x32_bf16 v[96:99], v[72:75], v[40:43], v[96:99]
  s_waitcnt lgkmcnt(6)
  ds_read_b128 v[68:71], v13 offset:18432
  buffer_load_dwordx4 a[40:43], v1, s[12:15], s27 offen offset:0 sc1
  v_mfma_f32_16x16x32_bf16 v[100:103], v[76:79], v[40:43], v[100:103]
  s_waitcnt lgkmcnt(6)
  ds_read_b128 v[72:75], v13 offset:20480
  v_mfma_f32_16x16x32_bf16 v[104:107], v[80:83], v[40:43], v[104:107]
  s_waitcnt lgkmcnt(6)
  ds_read_b128 v[76:79], v13 offset:21504
  s_cmp_lg_u32 s3, 0
  s_cbranch_scc1 PI2
  s_load_dwordx8 s[28:35], s[54:55], 8192 glc
PI2:
  v_mfma_f32_16x16x32_bf16 v[108:111], v[84:87], v[40:43], v[108:111]
  s_waitcnt vmcnt(12) lgkmcnt(6)
  ds_read_b128 v[80:83], v13 offset:24576
  buffer_load_dwordx4 a[44:47], v1, s[12:15], s27 offen offset:1024 sc1
  v_mfma_f32_16x16x32_bf16 v[92:95], v[88:91], v[44:47], v[92:95]
  s_waitcnt lgkmcnt(6)
  ds_read_b128 v[84:87], v13 offset:22528
  s_add_u32 s27, s27, s42
  v_mfma_f32_16x16x32_bf16 v[96:99], v[56:59], v[44:47], v[96:99]
  s_waitcnt lgkmcnt(6)
  ds_read_b128 v[88:91], v13 offset:23552
  v_mfma_f32_16x16x32_bf16 v[100:103], v[60:63], v[44:47], v[100:103]
  s_waitcnt lgkmcnt(6)
  ds_read_b128 v[56:59], v13 offset:27648
  buffer_load_dwordx4 a[56:59], v1, s[12:15], s27 offen offset:0 sc1
  v_mfma_f32_16x16x32_bf16 v[104:107], v[64:67], v[44:47], v[104:107]
  s_waitcnt vmcnt(12) lgkmcnt(6)
  ds_read_b128 v[60:63], v13 offset:28672
  v_mfma_f32_16x16x32_bf16 v[108:111], v[68:71], v[44:47], v[108:111]
  s_waitcnt lgkmcnt(6)
  ds_read_b128 v[64:67], v13 offset:29696
  buffer_load_dwordx4 a[60:63], v1, s[12:15], s27 offen offset:1024 sc1
  v_mfma_f32_16x16x32_bf16 v[92:95], v[72:75], v[48:51], v[92:95]
  s_waitcnt lgkmcnt(6)
  ds_read_b128 v[68:71], v13 offset:25600
  s_add_u32 s27, s27, s42
  v_mfma_f32_16x16x32_bf16 v[96:99], v[76:79], v[48:51], v[96:99]
  s_waitcnt lgkmcnt(6)
  ds_read_b128 v[72:75], v13 offset:26624
  v_mfma_f32_16x16x32_bf16 v[100:103], v[80:83], v[48:51], v[100:103]
  s_waitcnt lgkmcnt(6)
  buffer_load_dwordx4 a[72:75], v1, s[12:15], s27 offen offset:0 sc1
  v_mfma_f32_16x16x32_bf16 v[104:107], v[84:87], v[48:51], v[104:107]
  s_waitcnt lgkmcnt(5)
  v_mfma_f32_16x16x32_bf16 v[108:111], v[88:91], v[48:51], v[108:111]
  s_waitcnt lgkmcnt(4)
  v_mfma_f32_16x16x32_bf16 v[104:107], v[56:59], v[52:55], v[104:107]
  s_waitcnt lgkmcnt(3)
  buffer_load_dwordx4 a[76:79], v1, s[12:15], s27 offen offset:1024 sc1
  v_mfma_f32_16x16x32_bf16 v[108:111], v[60:63], v[52:55], v[108:111]
  s_waitcnt lgkmcnt(2)
  s_add_u32 s27, s27, s42
  v_mfma_f32_16x16x32_bf16 v[100:103], v[64:67], v[52:55], v[100:103]
  s_waitcnt lgkmcnt(1)
  v_mfma_f32_16x16x32_bf16 v[92:95], v[68:71], v[52:55], v[92:95]
  s_waitcnt lgkmcnt(0)
  buffer_load_dwordx4 a[88:91], v1, s[12:15], s27 offen offset:0 sc1
  v_mfma_f32_16x16x32_bf16 v[96:99], v[72:75], v[52:55], v[96:99]
  v_lshlrev_b32 v56, 16, v186
  v_and_b32 v57, 0xffff0000, v186
  v_lshlrev_b32 v58, 16, v187
  v_and_b32 v59, 0xffff0000, v187
  ds_write_b128 v176, v[104:107]
  ds_write_b128 v176, v[108:111] offset:4096
  ds_write_b128 v176, v[100:103] offset:51264
  s_waitcnt lgkmcnt(0)
  s_mov_b32 s61, 0
  s_cmp_lg_u32 s3, 0
  s_cbranch_scc1 ACQ2_DONE
ACQ2:
  s_xor_b32 s28, s28, s94
  s_xor_b32 s29, s29, s94
  s_xor_b32 s30, s30, s94
  s_xor_b32 s31, s31, s94
  s_xor_b32 s32, s32, s94
  s_xor_b32 s33, s33, s94
  s_xor_b32 s34, s34, s94
  s_xor_b32 s35, s35, s94
  s_or_b64 s[28:29], s[28:29], s[30:31]
  s_or_b64 s[28:29], s[28:29], s[32:33]
  s_or_b64 s[28:29], s[28:29], s[34:35]
  s_cbranch_scc0 ACQ2_DONE
  s_load_dwordx8 s[28:35], s[54:55], 8192 glc
  s_waitcnt lgkmcnt(0)
  s_add_u32 s61, s61, 1
  s_cmp_lt_u32 s61, 262144
  s_cbranch_scc1 ACQ2
ACQ2_DONE:
  s_barrier
  s_mul_i32 s25, s4, 81920
  s_add_u32 s25, s25, 10551296
  s_mul_i32 s23, s3, 5120
  s_add_u32 m0, s23, 0
  s_add_u32 s101, s23, s25
  s_add_u32 s101, s101, 0
  buffer_load_dwordx4 v1, s[12:15], s101 offen offset:0 sc1 lds
  buffer_load_dwordx4 v1, s[12:15], s101 offen offset:1024 sc1 lds
  ds_read_b128 v[112:115], v177
  ds_read_b128 v[116:119], v177 offset:4096
  ds_read_b128 v[120:123], v177 offset:51264
  v_lshlrev_b32 v60, 16, v188
  v_and_b32 v61, 0xffff0000, v188
  v_lshlrev_b32 v62, 16, v189
  v_and_b32 v63, 0xffff0000, v189
  v_lshlrev_b32 v64, 16, v190
  v_and_b32 v65, 0xffff0000, v190
  v_lshlrev_b32 v66, 16, v191
  v_and_b32 v67, 0xffff0000, v191
  v_pk_fma_f32 v[56:57], v[92:93], v[124:125], v[56:57]
  v_pk_fma_f32 v[58:59], v[94:95], v[126:127], v[58:59]
  v_pk_fma_f32 v[60:61], v[96:97], v[128:129], v[60:61]
  v_pk_fma_f32 v[62:63], v[98:99], v[130:131], v[62:63]
  v_pk_fma_f32 v[64:65], v[100:101], v[132:133], v[64:65]
  v_pk_fma_f32 v[66:67], v[102:103], v[134:135], v[66:67]
  s_waitcnt lgkmcnt(2)
  v_pk_fma_f32 v[56:57], v[112:113], v[124:125], v[56:57]
  v_pk_fma_f32 v[58:59], v[114:115], v[126:127], v[58:59]
  s_waitcnt lgkmcnt(1)
  v_pk_fma_f32 v[60:61], v[116:117], v[128:129], v[60:61]
  v_pk_fma_f32 v[62:63], v[118:119], v[130:131], v[62:63]
  s_waitcnt lgkmcnt(0)
  v_pk_fma_f32 v[64:65], v[120:121], v[132:133], v[64:65]
  v_pk_fma_f32 v[66:67], v[122:123], v[134:135], v[66:67]
  s_cmp_lg_u32 s3, 3
  s_cbranch_scc1 PI7
  s_load_dwordx8 s[28:35], s[54:55], 28672 glc
PI7:
  buffer_load_dwordx4 v1, s[12:15], s101 offen offset:2048 sc1 lds
  buffer_load_dwordx4 v1, s[12:15], s101 offen offset:3072 sc1 lds
  s_add_u32 m0, s23, 4096
  s_add_u32 s101, s23, s25
  s_add_u32 s101, s101, 4096
  buffer_load_dwordx4 v1, s[12:15], s101 offen offset:0 sc1 lds
  v_pk_mul_f32 v[68:69], v[56:57], v[152:153]
  v_pk_mul_f32 v[70:71], v[58:59], v[154:155]
  v_pk_mul_f32 v[72:73], v[60:61], v[156:157]
  v_pk_mul_f32 v[74:75], v[62:63], v[158:159]
  v_pk_mul_f32 v[76:77], v[64:65], v[160:161]
  v_pk_mul_f32 v[78:79], v[66:67], v[162:163]
  v_cvt_pk_bf16_f32 v112, v68, v69
  v_cvt_pk_bf16_f32 v113, v70, v71
  v_cvt_pk_bf16_f32 v114, v72, v73
  v_cvt_pk_bf16_f32 v115, v74, v75
  v_cvt_pk_bf16_f32 v116, v76, v77
  v_cvt_pk_bf16_f32 v117, v78, v79
  buffer_store_dwordx4 v[112:115], v1, s[12:15], s96 offen sc1
  s_cmp_ge_u32 s3, 2
  s_cbranch_scc1 SK30
  buffer_store_dwordx2 v[116:117], v1, s[12:15], s95 offen sc1
SK30:
  v_pk_add_f32 v[80:81], v[56:57], v[58:59]
  v_pk_mul_f32 v[82:83], v[56:57], v[56:57]
  v_pk_add_f32 v[84:85], v[68:69], v[70:71]
  s_add_u32 m0, s23, 20480
  s_add_u32 s101, s23, s25
  s_add_u32 s101, s101, 20480
  buffer_load_dwordx4 v1, s[12:15], s101 offen offset:0 sc1 lds
  v_pk_mul_f32 v[86:87], v[68:69], v[152:153]
  v_pk_mul_f32 v[88:89], v[68:69], v[68:69]
  v_pk_mul_f32 v[90:91], v[68:69], v[164:165]
  v_pk_fma_f32 v[82:83], v[58:59], v[58:59], v[82:83]
  v_pk_fma_f32 v[86:87], v[70:71], v[154:155], v[86:87]
  v_pk_fma_f32 v[88:89], v[70:71], v[70:71], v[88:89]
  v_pk_fma_f32 v[90:91], v[70:71], v[166:167], v[90:91]
  v_pk_add_f32 v[80:81], v[80:81], v[60:61]
  v_pk_fma_f32 v[82:83], v[60:61], v[60:61], v[82:83]
  v_pk_add_f32 v[84:85], v[84:85], v[72:73]
  v_pk_fma_f32 v[86:87], v[72:73], v[156:157], v[86:87]
  v_pk_fma_f32 v[88:89], v[72:73], v[72:73], v[88:89]
  v_pk_fma_f32 v[90:91], v[72:73], v[168:169], v[90:91]
  buffer_load_dwordx4 v1, s[12:15], s101 offen offset:1024 sc1 lds
  v_pk_add_f32 v[80:81], v[80:81], v[62:63]
  v_pk_fma_f32 v[82:83], v[62:63], v[62:63], v[82:83]
  v_pk_add_f32 v[84:85], v[84:85], v[74:75]
  v_pk_fma_f32 v[86:87], v[74:75], v[158:159], v[86:87]
  v_pk_fma_f32 v[88:89], v[74:75], v[74:75], v[88:89]
  v_pk_fma_f32 v[90:91], v[74:75], v[170:171], v[90:91]
  v_pk_add_f32 v[80:81], v[80:81], v[64:65]
  v_pk_fma_f32 v[82:83], v[64:65], v[64:65], v[82:83]
  v_pk_add_f32 v[84:85], v[84:85], v[76:77]
  v_pk_fma_f32 v[86:87], v[76:77], v[160:161], v[86:87]
  v_pk_fma_f32 v[88:89], v[76:77], v[76:77], v[88:89]
  v_pk_fma_f32 v[90:91], v[76:77], v[172:173], v[90:91]
  v_pk_add_f32 v[80:81], v[80:81], v[66:67]
  buffer_load_dwordx4 v1, s[12:15], s101 offen offset:2048 sc1 lds
  v_pk_fma_f32 v[82:83], v[66:67], v[66:67], v[82:83]
  v_pk_add_f32 v[84:85], v[84:85], v[78:79]
  v_pk_fma_f32 v[86:87], v[78:79], v[162:163], v[86:87]
  v_pk_fma_f32 v[88:89], v[78:79], v[78:79], v[88:89]
  v_pk_fma_f32 v[90:91], v[78:79], v[174:175], v[90:91]
  v_add_f32 v92, v80, v81
  v_add_f32 v93, v82, v83
  v_add_f32 v94, v84, v85
  v_add_f32 v95, v86, v87
  v_add_f32 v96, v88, v89
  v_add_f32 v97, v90, v91
  v_permlane32_swap_b32 v92, v93
  v_permlane32_swap_b32 v94, v95
  buffer_load_dwordx4 v1, s[12:15], s101 offen offset:3072 sc1 lds
  v_permlane32_swap_b32 v96, v97
  v_add_f32 v92, v92, v93
  v_add_f32 v94, v94, v95
  v_add_f32 v93, v96, v97
  v_add_f32 v95, v96, v97
  v_permlane16_swap_b32 v92, v94
  s_nop 0
  v_permlane16_swap_b32 v93, v95
  v_add_f32 v92, v92, v94
  v_add_f32 v93, v93, v95
  s_add_u32 m0, s23, 24576
  s_add_u32 s101, s23, s25
  s_add_u32 s101, s101, 24576
  buffer_load_dwordx4 v1, s[12:15], s101 offen offset:0 sc1 lds
  ds_write_b64 v178, v[92:93]
  s_waitcnt lgkmcnt(0)
  s_mov_b32 s61, 0
  s_cmp_lg_u32 s3, 3
  s_cbranch_scc1 ACQ7_DONE
ACQ7:
  s_xor_b32 s28, s28, s94
  s_xor_b32 s29, s29, s94
  s_xor_b32 s30, s30, s94
  s_xor_b32 s31, s31, s94
  s_xor_b32 s32, s32, s94
  s_xor_b32 s33, s33, s94
  s_xor_b32 s34, s34, s94
  s_xor_b32 s35, s35, s94
  s_or_b64 s[28:29], s[28:29], s[30:31]
  s_or_b64 s[28:29], s[28:29], s[32:33]
  s_or_b64 s[28:29], s[28:29], s[34:35]
  s_cbranch_scc0 ACQ7_DONE
  s_load_dwordx8 s[28:35], s[54:55], 28672 glc
  s_waitcnt lgkmcnt(0)
  s_add_u32 s61, s61, 1
  s_cmp_lt_u32 s61, 262144
  s_cbranch_scc1 ACQ7
ACQ7_DONE:
  s_barrier
  ds_read_b64 v[92:93], v179 offset:0
  ds_read_b64 v[94:95], v179 offset:512
  ds_read_b64 v[96:97], v179 offset:1024
  ds_read_b64 v[98:99], v179 offset:1536
  v_cvt_pk_bf16_f32 v186, v56, v57
  v_cvt_pk_bf16_f32 v187, v58, v59
  v_cvt_pk_bf16_f32 v188, v60, v61
  v_cvt_pk_bf16_f32 v189, v62, v63
  v_cvt_pk_bf16_f32 v190, v64, v65
  v_cvt_pk_bf16_f32 v191, v66, v67
  s_waitcnt lgkmcnt(1)
  v_pk_add_f32 v[92:93], v[92:93], v[96:97]
  s_waitcnt lgkmcnt(0)
  v_pk_add_f32 v[94:95], v[94:95], v[98:99]
  buffer_store_dwordx4 v[92:95], v1, s[12:15], s26 offen sc1
  v_add_u32 v4, 102400, v1
  s_mul_i32 s26, s3, 14
  s_cmp_eq_u32 s3, 3
  s_cselect_b32 s26, 41, s26
  s_mul_i32 s95, s5, 276480
  s_add_u32 s95, s95, 5718016
  s_mul_i32 s24, s26, 5120
  s_add_u32 s24, s24, s95
  s_add_u32 s24, s24, 15360
  s_mul_i32 s53, s4, 221184
  s_add_u32 s53, s53, 13172736
  s_lshl_b32 s98, s98, 12
  s_add_u32 s98, s98, s53
  s_lshl_b32 s99, s99, 12
  s_add_u32 s99, s99, s53
  s_cmp_eq_u32 s3, 3
  s_cbranch_scc1 HELP
  s_waitcnt vmcnt(6)
  s_barrier
  s_cmp_lg_u32 s3, 0
  s_cbranch_scc1 SK31
  s_add_u32 s6, s52, 12288
  buffer_store_dword v14, v10, s[12:15], s6 offen sc1
SK31:
  ds_read_b128 v[16:19], v1 offset:0
  ds_read_b128 v[20:23], v1 offset:1024
  ds_read_b128 v[24:27], v1 offset:2048
  ds_read_b128 v[28:31], v1 offset:3072
  ds_read_b128 v[128:131], v1 offset:4096
  s_waitcnt lgkmcnt(4)
  v_mfma_f32_16x16x32_bf16 v[64:67], a[0:3], v[16:19], 0
  ds_read_b128 v[132:135], v1 offset:5120
  v_mfma_f32_16x16x32_bf16 v[68:71], a[4:7], v[16:19], 0
  s_waitcnt lgkmcnt(4)
  v_mfma_f32_16x16x32_bf16 v[64:67], a[16:19], v[20:23], v[64:67]
  ds_read_b128 v[16:19], v1 offset:6144
  v_mfma_f32_16x16x32_bf16 v[68:71], a[20:23], v[20:23], v[68:71]
  s_waitcnt lgkmcnt(4)
  buffer_load_dwordx4 a[92:95], v1, s[12:15], s27 offen offset:1024 sc1
  v_mfma_f32_16x16x32_bf16 v[64:67], a[32:35], v[24:27], v[64:67]
  s_add_u32 s27, s27, s42
  ds_read_b128 v[20:23], v1 offset:7168
  v_mfma_f32_16x16x32_bf16 v[68:71], a[36:39], v[24:27], v[68:71]
  s_waitcnt lgkmcnt(4)
  buffer_load_dwordx4 a[104:107], v1, s[12:15], s27 offen offset:0 sc1
  v_mfma_f32_16x16x32_bf16 v[64:67], a[48:51], v[28:31], v[64:67]
  ds_read_b128 v[24:27], v1 offset:8192
  v_mfma_f32_16x16x32_bf16 v[68:71], a[52:55], v[28:31], v[68:71]
  s_waitcnt lgkmcnt(4)
  v_mfma_f32_16x16x32_bf16 v[64:67], a[64:67], v[128:131], v[64:67]
  ds_read_b128 v[28:31], v1 offset:9216
  v_mfma_f32_16x16x32_bf16 v[68:71], a[68:71], v[128:131], v[68:71]
  s_waitcnt lgkmcnt(4)
  buffer_load_dwordx4 a[108:111], v1, s[12:15], s27 offen offset:1024 sc1
  v_mfma_f32_16x16x32_bf16 v[64:67], a[80:83], v[132:135], v[64:67]
  s_add_u32 s27, s27, s42
  ds_read_b128 v[128:131], v1 offset:10240
  v_mfma_f32_16x16x32_bf16 v[68:71], a[84:87], v[132:135], v[68:71]
  s_waitcnt lgkmcnt(4)
  buffer_load_dwordx4 a[120:123], v1, s[12:15], s27 offen offset:0 sc1
  v_mfma_f32_16x16x32_bf16 v[64:67], a[96:99], v[16:19], v[64:67]
  ds_read_b128 v[132:135], v1 offset:11264
  v_mfma_f32_16x16x32_bf16 v[68:71], a[100:103], v[16:19], v[68:71]
  s_waitcnt lgkmcnt(4)
  v_mfma_f32_16x16x32_bf16 v[64:67], a[112:115], v[20:23], v[64:67]
  ds_read_b128 v[16:19], v1 offset:12288
  v_mfma_f32_16x16x32_bf16 v[68:71], a[116:119], v[20:23], v[68:71]
  s_waitcnt lgkmcnt(4)
  buffer_load_dwordx4 a[124:127], v1, s[12:15], s27 offen offset:1024 sc1
  v_mfma_f32_16x16x32_bf16 v[64:67], a[128:131], v[24:27], v[64:67]
  s_add_u32 s27, s27, s42
  ds_read_b128 v[20:23], v1 offset:13312
  v_mfma_f32_16x16x32_bf16 v[68:71], a[132:135], v[24:27], v[68:71]
  s_waitcnt lgkmcnt(4)
  buffer_load_dwordx4 a[136:139], v1, s[12:15], s27 offen offset:0 sc1
  v_mfma_f32_16x16x32_bf16 v[64:67], a[144:147], v[28:31], v[64:67]
  ds_read_b128 v[24:27], v1 offset:14336
  v_mfma_f32_16x16x32_bf16 v[68:71], a[148:151], v[28:31], v[68:71]
  s_waitcnt lgkmcnt(4)
  buffer_load_dwordx4 a[140:143], v1, s[12:15], s27 offen offset:1024 sc1
  v_mfma_f32_16x16x32_bf16 v[64:67], a[160:163], v[128:131], v[64:67]
  s_add_u32 s27, s27, s42
  ds_read_b128 v[28:31], v1 offset:15360
  v_mfma_f32_16x16x32_bf16 v[68:71], a[164:167], v[128:131], v[68:71]
  s_waitcnt lgkmcnt(4)
  v_mfma_f32_16x16x32_bf16 v[64:67], a[176:179], v[132:135], v[64:67]
  ds_read_b128 v[128:131], v1 offset:16384
  v_mfma_f32_16x16x32_bf16 v[68:71], a[180:183], v[132:135], v[68:71]
  s_waitcnt lgkmcnt(4)
  buffer_load_dwordx4 a[152:155], v1, s[12:15], s27 offen offset:0 sc1
  v_mfma_f32_16x16x32_bf16 v[64:67], a[192:195], v[16:19], v[64:67]
  ds_read_b128 v[132:135], v1 offset:17408
  v_mfma_f32_16x16x32_bf16 v[68:71], a[196:199], v[16:19], v[68:71]
  s_waitcnt lgkmcnt(4)
  buffer_load_dwordx4 a[156:159], v1, s[12:15], s27 offen offset:1024 sc1
  v_mfma_f32_16x16x32_bf16 v[64:67], a[208:211], v[20:23], v[64:67]
  ds_read_b128 v[16:19], v1 offset:18432
  v_mfma_f32_16x16x32_bf16 v[68:71], a[212:215], v[20:23], v[68:71]
  s_waitcnt lgkmcnt(4)
  v_mfma_f32_16x16x32_bf16 v[64:67], a[224:227], v[24:27], v[64:67]
  ds_read_b128 v[20:23], v1 offset:19456
  v_mfma_f32_16x16x32_bf16 v[68:71], a[228:231], v[24:27], v[68:71]
  s_waitcnt lgkmcnt(4)
  buffer_load_dwordx4 a[168:171], v1, s[12:15], s27 offen offset:2048 sc1
  s_waitcnt vmcnt(11)
  s_barrier
  v_mfma_f32_16x16x32_bf16 v[64:67], a[240:243], v[28:31], v[64:67]
  ds_read_b128 v[24:27], v1 offset:20480
  v_mfma_f32_16x16x32_bf16 v[68:71], a[244:247], v[28:31], v[68:71]
  s_waitcnt lgkmcnt(4)
  buffer_load_dwordx4 a[172:175], v1, s[12:15], s27 offen offset:3072 sc1
  v_mfma_f32_16x16x32_bf16 v[64:67], v[192:195], v[128:131], v[64:67]
  s_add_u32 s27, s27, 4096
  ds_read_b128 v[28:31], v1 offset:21504
  v_mfma_f32_16x16x32_bf16 v[68:71], v[196:199], v[128:131], v[68:71]
  s_waitcnt lgkmcnt(4)
  v_mfma_f32_16x16x32_bf16 v[64:67], v[208:211], v[132:135], v[64:67]
  ds_read_b128 v[128:131], v1 offset:22528
  v_mfma_f32_16x16x32_bf16 v[68:71], v[212:215], v[132:135], v[68:71]
  s_waitcnt lgkmcnt(4)
  buffer_load_dwordx4 a[184:187], v1, s[12:15], s27 offen offset:0 sc1
  s_waitcnt vmcnt(12)
  s_cmp_lg_u32 s3, 0
  s_cbranch_scc1 SK32
  s_add_u32 s6, s52, 28704
  buffer_store_dword v14, v10, s[12:15], s6 offen sc1
SK32:
  v_mfma_f32_16x16x32_bf16 v[64:67], v[224:227], v[16:19], v[64:67]
  ds_read_b128 v[132:135], v1 offset:23552
  v_mfma_f32_16x16x32_bf16 v[68:71], v[228:231], v[16:19], v[68:71]
  s_waitcnt lgkmcnt(4)
  buffer_load_dwordx4 a[188:191], v1, s[12:15], s27 offen offset:1024 sc1
  v_mfma_f32_16x16x32_bf16 v[64:67], v[240:243], v[20:23], v[64:67]
  ds_read_b128 v[16:19], v1 offset:24576
  v_mfma_f32_16x16x32_bf16 v[68:71], v[244:247], v[20:23], v[68:71]
  s_waitcnt lgkmcnt(4)
  buffer_load_dwordx4 a[200:203], v1, s[12:15], s27 offen offset:2048 sc1
  v_mfma_f32_16x16x32_bf16 v[80:83], a[0:3], v[24:27], 0
  ds_read_b128 v[20:23], v1 offset:25600
  v_mfma_f32_16x16x32_bf16 v[84:87], a[4:7], v[24:27], 0
  s_waitcnt lgkmcnt(4)
  v_mfma_f32_16x16x32_bf16 v[80:83], a[16:19], v[28:31], v[80:83]
  ds_read_b128 v[24:27], v1 offset:26624
  v_mfma_f32_16x16x32_bf16 v[84:87], a[20:23], v[28:31], v[84:87]
  s_waitcnt lgkmcnt(4)
  buffer_load_dwordx4 a[204:207], v1, s[12:15], s27 offen offset:3072 sc1
  v_mfma_f32_16x16x32_bf16 v[80:83], a[32:35], v[128:131], v[80:83]
  s_add_u32 s27, s27, 4096
  ds_read_b128 v[28:31], v1 offset:27648
  v_mfma_f32_16x16x32_bf16 v[84:87], a[36:39], v[128:131], v[84:87]
  s_waitcnt lgkmcnt(4)
  buffer_load_dwordx4 a[216:219], v1, s[12:15], s27 offen offset:0 sc1
  v_mfma_f32_16x16x32_bf16 v[80:83], a[48:51], v[132:135], v[80:83]
  ds_read_b128 v[128:131], v1 offset:28672
  v_mfma_f32_16x16x32_bf16 v[84:87], a[52:55], v[132:135], v[84:87]
  s_waitcnt lgkmcnt(4)
  v_mfma_f32_16x16x32_bf16 v[80:83], a[64:67], v[16:19], v[80:83]
  ds_read_b128 v[132:135], v1 offset:29696
  v_mfma_f32_16x16x32_bf16 v[84:87], a[68:71], v[16:19], v[84:87]
  s_waitcnt lgkmcnt(4)
  buffer_load_dwordx4 a[220:223], v1, s[12:15], s27 offen offset:1024 sc1
  v_mfma_f32_16x16x32_bf16 v[80:83], a[80:83], v[20:23], v[80:83]
  ds_read_b128 v[16:19], v1 offset:30720
  v_mfma_f32_16x16x32_bf16 v[84:87], a[84:87], v[20:23], v[84:87]
  s_waitcnt lgkmcnt(4)
  buffer_load_dwordx4 a[232:235], v1, s[12:15], s27 offen offset:2048 sc1
  v_mfma_f32_16x16x32_bf16 v[80:83], a[96:99], v[24:27], v[80:83]
  ds_read_b128 v[20:23], v1 offset:31744
  v_mfma_f32_16x16x32_bf16 v[84:87], a[100:103], v[24:27], v[84:87]
  s_waitcnt lgkmcnt(4)
  v_mfma_f32_16x16x32_bf16 v[80:83], a[112:115], v[28:31], v[80:83]
  ds_read_b128 v[24:27], v1 offset:32768
  v_mfma_f32_16x16x32_bf16 v[84:87], a[116:119], v[28:31], v[84:87]
  s_waitcnt lgkmcnt(4)
  buffer_load_dwordx4 a[236:239], v1, s[12:15], s27 offen offset:3072 sc1
  v_mfma_f32_16x16x32_bf16 v[80:83], a[128:131], v[128:131], v[80:83]
  s_add_u32 s27, s27, 4096
  ds_read_b128 v[28:31], v1 offset:33792
  v_mfma_f32_16x16x32_bf16 v[84:87], a[132:135], v[128:131], v[84:87]
  s_waitcnt lgkmcnt(4)
  buffer_load_dwordx4 a[248:251], v1, s[12:15], s27 offen offset:0 sc1
  v_mfma_f32_16x16x32_bf16 v[80:83], a[144:147], v[132:135], v[80:83]
  ds_read_b128 v[128:131], v1 offset:34816
  v_mfma_f32_16x16x32_bf16 v[84:87], a[148:151], v[132:135], v[84:87]
  s_waitcnt lgkmcnt(4)
  buffer_load_dwordx4 a[252:255], v1, s[12:15], s27 offen offset:1024 sc1
  v_mfma_f32_16x16x32_bf16 v[80:83], a[160:163], v[16:19], v[80:83]
  ds_read_b128 v[132:135], v1 offset:35840
  v_mfma_f32_16x16x32_bf16 v[84:87], a[164:167], v[16:19], v[84:87]
  s_waitcnt lgkmcnt(4)
  v_mfma_f32_16x16x32_bf16 v[80:83], a[176:179], v[20:23], v[80:83]
  ds_read_b128 v[16:19], v1 offset:36864
  v_mfma_f32_16x16x32_bf16 v[84:87], a[180:183], v[20:23], v[84:87]
  s_waitcnt lgkmcnt(4)
  buffer_load_dwordx4 v[200:203], v1, s[12:15], s27 offen offset:2048 sc1
  v_mfma_f32_16x16x32_bf16 v[80:83], a[192:195], v[24:27], v[80:83]
  ds_read_b128 v[20:23], v1 offset:37888
  v_mfma_f32_16x16x32_bf16 v[84:87], a[196:199], v[24:27], v[84:87]
  s_waitcnt lgkmcnt(4)
  buffer_load_dwordx4 v[204:207], v1, s[12:15], s27 offen offset:3072 sc1
  v_mfma_f32_16x16x32_bf16 v[80:83], a[208:211], v[28:31], v[80:83]
  s_add_u32 s27, s27, 4096
  ds_read_b128 v[24:27], v1 offset:38912
  v_mfma_f32_16x16x32_bf16 v[84:87], a[212:215], v[28:31], v[84:87]
  s_waitcnt lgkmcnt(4)
  v_mfma_f32_16x16x32_bf16 v[80:83], a[224:227], v[128:131], v[80:83]
  ds_read_b128 v[28:31], v1 offset:39936
  v_mfma_f32_16x16x32_bf16 v[84:87], a[228:231], v[128:131], v[84:87]
  s_waitcnt lgkmcnt(4)
  buffer_load_dwordx4 v[216:219], v1, s[12:15], s27 offen offset:0 sc1
  v_mfma_f32_16x16x32_bf16 v[80:83], a[240:243], v[132:135], v[80:83]
  ds_read_b128 v[128:131], v0 offset:0
  v_mfma_f32_16x16x32_bf16 v[84:87], a[244:247], v[132:135], v[84:87]
  s_waitcnt lgkmcnt(4)
  buffer_load_dwordx4 v[220:223], v1, s[12:15], s27 offen offset:1024 sc1
  v_mfma_f32_16x16x32_bf16 v[80:83], v[192:195], v[16:19], v[80:83]
  ds_read_b128 v[132:135], v1 offset:0
  v_mfma_f32_16x16x32_bf16 v[84:87], v[196:199], v[16:19], v[84:87]
  s_waitcnt lgkmcnt(4)
  v_mfma_f32_16x16x32_bf16 v[80:83], v[208:211], v[20:23], v[80:83]
  ds_read_b128 v[16:19], v1 offset:20480
  v_mfma_f32_16x16x32_bf16 v[84:87], v[212:215], v[20:23], v[84:87]
  s_waitcnt lgkmcnt(4)
  buffer_load_dwordx4 v[232:235], v1, s[12:15], s27 offen offset:2048 sc1
  v_mfma_f32_16x16x32_bf16 v[80:83], v[224:227], v[24:27], v[80:83]
  ds_read_b128 v[20:23], v0 offset:64
  v_mfma_f32_16x16x32_bf16 v[84:87], v[228:231], v[24:27], v[84:87]
  s_waitcnt lgkmcnt(4)
  buffer_load_dwordx4 v[236:239], v1, s[12:15], s27 offen offset:3072 sc1
  v_mfma_f32_16x16x32_bf16 v[80:83], v[240:243], v[28:31], v[80:83]
  s_add_u32 s27, s27, 4096
  ds_read_b128 v[24:27], v1 offset:1024
  v_mfma_f32_16x16x32_bf16 v[84:87], v[244:247], v[28:31], v[84:87]
  s_waitcnt lgkmcnt(4)
  buffer_load_dwordx4 v[248:251], v1, s[12:15], s27 offen offset:0 sc1
  v_mfma_f32_16x16x32_bf16 v[168:171], v[128:131], a[8:11], 0
  ds_read_b128 v[28:31], v1 offset:21504
  v_mfma_f32_16x16x32_bf16 v[172:175], v[128:131], a[12:15], 0
  s_waitcnt lgkmcnt(4)
  v_mfma_f32_16x16x32_bf16 v[72:75], a[8:11], v[132:135], 0
  ds_read_b128 v[128:131], v0 offset:160
  v_mfma_f32_16x16x32_bf16 v[76:79], a[12:15], v[132:135], 0
  s_waitcnt lgkmcnt(4)
  buffer_load_dwordx4 v[252:255], v1, s[12:15], s27 offen offset:1024 sc1
  s_barrier
  v_mfma_f32_16x16x32_bf16 v[88:91], a[8:11], v[16:19], 0
  ds_read_b128 v[132:135], v1 offset:2048
  v_mfma_f32_16x16x32_bf16 v[92:95], a[12:15], v[16:19], 0
  s_waitcnt lgkmcnt(4)
  ds_read_b128 v[32:35], v4 offset:0
  v_mfma_f32_16x16x32_bf16 v[168:171], v[20:23], a[24:27], v[168:171]
  ds_read_b128 v[16:19], v1 offset:22528
  v_mfma_f32_16x16x32_bf16 v[172:175], v[20:23], a[28:31], v[172:175]
  s_waitcnt lgkmcnt(5)
  ds_read_b128 v[48:51], v4 offset:4096
  v_mfma_f32_16x16x32_bf16 v[72:75], a[24:27], v[24:27], v[72:75]
  ds_read_b128 v[20:23], v0 offset:224
  v_mfma_f32_16x16x32_bf16 v[76:79], a[28:31], v[24:27], v[76:79]
  s_waitcnt lgkmcnt(6)
  ds_read_b128 v[36:39], v4 offset:1024
  v_mfma_f32_16x16x32_bf16 v[88:91], a[24:27], v[28:31], v[88:91]
  ds_read_b128 v[24:27], v1 offset:3072
  v_mfma_f32_16x16x32_bf16 v[92:95], a[28:31], v[28:31], v[92:95]
  s_waitcnt lgkmcnt(7)
  ds_read_b128 v[52:55], v4 offset:5120
  s_waitcnt lgkmcnt(6)
  v_mfma_f32_16x16x32_bf16 v[64:67], v[136:139], v[32:35], v[64:67]
  v_mfma_f32_16x16x32_bf16 v[68:71], v[140:143], v[32:35], v[68:71]
  v_mfma_f32_16x16x32_bf16 v[168:171], v[128:131], a[40:43], v[168:171]
  ds_read_b128 v[28:31], v1 offset:23552
  v_mfma_f32_16x16x32_bf16 v[172:175], v[128:131], a[44:47], v[172:175]
  s_waitcnt lgkmcnt(3)
  v_mfma_f32_16x16x32_bf16 v[80:83], v[136:139], v[36:39], v[80:83]
  v_mfma_f32_16x16x32_bf16 v[84:87], v[140:143], v[36:39], v[84:87]
  v_mfma_f32_16x16x32_bf16 v[72:75], a[40:43], v[132:135], v[72:75]
  ds_read_b128 v[128:131], v0 offset:320
  v_mul_f32 v152, v64, v64
  v_mfma_f32_16x16x32_bf16 v[76:79], a[44:47], v[132:135], v[76:79]
  v_mul_f32 v153, v65, v65
  v_mul_f32 v154, v66, v66
  v_mfma_f32_16x16x32_bf16 v[88:91], a[40:43], v[16:19], v[88:91]
  ds_read_b128 v[132:135], v1 offset:4096
  v_mul_f32 v155, v67, v67
  v_mfma_f32_16x16x32_bf16 v[92:95], a[44:47], v[16:19], v[92:95]
  v_mul_f32 v156, v68, v68
  v_mul_f32 v157, v69, v69
  v_mfma_f32_16x16x32_bf16 v[168:171], v[20:23], a[56:59], v[168:171]
  ds_read_b128 v[16:19], v1 offset:24576
  v_mul_f32 v158, v70, v70
  v_mfma_f32_16x16x32_bf16 v[172:175], v[20:23], a[60:63], v[172:175]
  s_waitcnt lgkmcnt(5)
  v_mul_f32 v159, v71, v71
  v_fma_f32 v152, v152, v49, v48
  v_mfma_f32_16x16x32_bf16 v[72:75], a[56:59], v[24:27], v[72:75]
  ds_read_b128 v[20:23], v0 offset:384
  v_fma_f32 v153, v153, v49, v48
  v_mfma_f32_16x16x32_bf16 v[76:79], a[60:63], v[24:27], v[76:79]
  s_waitcnt lgkmcnt(4)
  v_fma_f32 v154, v154, v49, v48
  v_fma_f32 v155, v155, v49, v48
  v_mfma_f32_16x16x32_bf16 v[88:91], a[56:59], v[28:31], v[88:91]
  ds_read_b128 v[24:27], v1 offset:5120
  v_fma_f32 v156, v156, v49, v48
  v_mfma_f32_16x16x32_bf16 v[92:95], a[60:63], v[28:31], v[92:95]
  s_waitcnt lgkmcnt(4)
  v_fma_f32 v157, v157, v49, v48
  v_fma_f32 v158, v158, v49, v48
  v_mfma_f32_16x16x32_bf16 v[168:171], v[128:131], a[72:75], v[168:171]
  ds_read_b128 v[28:31], v1 offset:25600
  v_fma_f32 v159, v159, v49, v48
  v_mfma_f32_16x16x32_bf16 v[172:175], v[128:131], a[76:79], v[172:175]
  s_waitcnt lgkmcnt(4)
  v_mul_f32 v152, v152, v64
  v_mul_f32 v153, v153, v65
  v_mfma_f32_16x16x32_bf16 v[72:75], a[72:75], v[132:135], v[72:75]
  ds_read_b128 v[128:131], v0 offset:480
  v_mul_f32 v154, v154, v66
  v_mfma_f32_16x16x32_bf16 v[76:79], a[76:79], v[132:135], v[76:79]
  s_waitcnt lgkmcnt(4)
  v_exp_f32 v152, v152
  v_mfma_f32_16x16x32_bf16 v[88:91], a[72:75], v[16:19], v[88:91]
  ds_read_b128 v[132:135], v1 offset:6144
  v_mul_f32 v155, v155, v67
  v_mfma_f32_16x16x32_bf16 v[92:95], a[76:79], v[16:19], v[92:95]
  s_waitcnt vmcnt(28) lgkmcnt(4)
  v_exp_f32 v153, v153
  v_mfma_f32_16x16x32_bf16 v[168:171], v[20:23], a[88:91], v[168:171]
  ds_read_b128 v[16:19], v1 offset:26624
  v_mul_f32 v156, v156, v68
  v_mfma_f32_16x16x32_bf16 v[172:175], v[20:23], a[92:95], v[172:175]
  s_waitcnt lgkmcnt(4)
  v_exp_f32 v154, v154
  v_mfma_f32_16x16x32_bf16 v[72:75], a[88:91], v[24:27], v[72:75]
  ds_read_b128 v[20:23], v0 offset:544
  v_mul_f32 v157, v157, v69
  v_mfma_f32_16x16x32_bf16 v[76:79], a[92:95], v[24:27], v[76:79]
  s_waitcnt lgkmcnt(4)
  v_exp_f32 v155, v155
  v_mfma_f32_16x16x32_bf16 v[88:91], a[88:91], v[28:31], v[88:91]
  ds_read_b128 v[24:27], v1 offset:7168
  v_mul_f32 v158, v158, v70
  v_mfma_f32_16x16x32_bf16 v[92:95], a[92:95], v[28:31], v[92:95]
  s_waitcnt vmcnt(26) lgkmcnt(4)
  v_exp_f32 v156, v156
  v_mfma_f32_16x16x32_bf16 v[168:171], v[128:131], a[104:107], v[168:171]
  ds_read_b128 v[28:31], v1 offset:27648
  v_mul_f32 v159, v159, v71
  v_mfma_f32_16x16x32_bf16 v[172:175], v[128:131], a[108:111], v[172:175]
  s_waitcnt lgkmcnt(4)
  v_exp_f32 v157, v157
  v_mfma_f32_16x16x32_bf16 v[72:75], a[104:107], v[132:135], v[72:75]
  ds_read_b128 v[128:131], v0 offset:640
  v_fma_f32 v152, v152, v50, v50
  v_mfma_f32_16x16x32_bf16 v[76:79], a[108:111], v[132:135], v[76:79]
  s_waitcnt lgkmcnt(4)
  v_exp_f32 v158, v158
  v_mfma_f32_16x16x32_bf16 v[88:91], a[104:107], v[16:19], v[88:91]
  ds_read_b128 v[132:135], v1 offset:8192
  v_fma_f32 v153, v153, v50, v50
  v_mfma_f32_16x16x32_bf16 v[92:95], a[108:111], v[16:19], v[92:95]
  s_waitcnt vmcnt(24) lgkmcnt(4)
  v_exp_f32 v159, v159
  v_mfma_f32_16x16x32_bf16 v[168:171], v[20:23], a[120:123], v[168:171]
  ds_read_b128 v[16:19], v1 offset:28672
  v_fma_f32 v154, v154, v50, v50
  v_mfma_f32_16x16x32_bf16 v[172:175], v[20:23], a[124:127], v[172:175]
  s_waitcnt lgkmcnt(4)
  v_rcp_f32 v152, v152
  v_mfma_f32_16x16x32_bf16 v[72:75], a[120:123], v[24:27], v[72:75]
  ds_read_b128 v[20:23], v0 offset:704
  v_fma_f32 v155, v155, v50, v50
  v_mfma_f32_16x16x32_bf16 v[76:79], a[124:127], v[24:27], v[76:79]
  s_waitcnt lgkmcnt(4)
  v_rcp_f32 v153, v153
  v_mfma_f32_16x16x32_bf16 v[88:91], a[120:123], v[28:31], v[88:91]
  ds_read_b128 v[24:27], v1 offset:9216
  v_fma_f32 v156, v156, v50, v50
  v_mfma_f32_16x16x32_bf16 v[92:95], a[124:127], v[28:31], v[92:95]
  s_waitcnt vmcnt(22) lgkmcnt(4)
  v_rcp_f32 v154, v154
  v_mfma_f32_16x16x32_bf16 v[168:171], v[128:131], a[136:139], v[168:171]
  ds_read_b128 v[28:31], v1 offset:29696
  v_fma_f32 v157, v157, v50, v50
  v_mfma_f32_16x16x32_bf16 v[172:175], v[128:131], a[140:143], v[172:175]
  s_waitcnt lgkmcnt(4)
  v_rcp_f32 v155, v155
  v_mfma_f32_16x16x32_bf16 v[72:75], a[136:139], v[132:135], v[72:75]
  ds_read_b128 v[128:131], v0 offset:800
  v_fma_f32 v158, v158, v50, v50
  v_mfma_f32_16x16x32_bf16 v[76:79], a[140:143], v[132:135], v[76:79]
  s_waitcnt lgkmcnt(4)
  v_rcp_f32 v156, v156
  v_mfma_f32_16x16x32_bf16 v[88:91], a[136:139], v[16:19], v[88:91]
  ds_read_b128 v[132:135], v1 offset:10240
  v_fma_f32 v159, v159, v50, v50
  v_mfma_f32_16x16x32_bf16 v[92:95], a[140:143], v[16:19], v[92:95]
  s_waitcnt vmcnt(20) lgkmcnt(4)
  v_rcp_f32 v157, v157
  v_mfma_f32_16x16x32_bf16 v[168:171], v[20:23], a[152:155], v[168:171]
  ds_read_b128 v[16:19], v1 offset:30720
  v_mul_f32 v152, v152, v64
  v_mfma_f32_16x16x32_bf16 v[172:175], v[20:23], a[156:159], v[172:175]
  s_waitcnt lgkmcnt(4)
  v_rcp_f32 v158, v158
  v_mfma_f32_16x16x32_bf16 v[72:75], a[152:155], v[24:27], v[72:75]
  ds_read_b128 v[20:23], v0 offset:864
  v_mul_f32 v153, v153, v65
  v_mfma_f32_16x16x32_bf16 v[76:79], a[156:159], v[24:27], v[76:79]
  s_waitcnt lgkmcnt(4)
  v_rcp_f32 v159, v159
  v_mfma_f32_16x16x32_bf16 v[88:91], a[152:155], v[28:31], v[88:91]
  ds_read_b128 v[24:27], v1 offset:11264
  v_mul_f32 v154, v154, v66
  v_mfma_f32_16x16x32_bf16 v[92:95], a[156:159], v[28:31], v[92:95]
  s_waitcnt vmcnt(18) lgkmcnt(4)
  v_mul_f32 v155, v155, v67
  v_mul_f32 v156, v156, v68
  v_mfma_f32_16x16x32_bf16 v[168:171], v[128:131], a[168:171], v[168:171]
  ds_read_b128 v[28:31], v1 offset:31744
  v_mul_f32 v157, v157, v69
  v_mfma_f32_16x16x32_bf16 v[172:175], v[128:131], a[172:175], v[172:175]
  s_waitcnt lgkmcnt(4)
  v_mul_f32 v158, v158, v70
  v_mul_f32 v159, v159, v71
  v_mfma_f32_16x16x32_bf16 v[72:75], a[168:171], v[132:135], v[72:75]
  ds_read_b128 v[128:131], v0 offset:960
  v_cvt_pk_bf16_f32 v64, v152, v153
  v_mfma_f32_16x16x32_bf16 v[76:79], a[172:175], v[132:135], v[76:79]
  s_waitcnt lgkmcnt(4)
  v_cvt_pk_bf16_f32 v65, v154, v155
  v_cvt_pk_bf16_f32 v66, v156, v157
  v_mfma_f32_16x16x32_bf16 v[88:91], a[168:171], v[16:19], v[88:91]
  ds_read_b128 v[132:135], v1 offset:12288
  v_cvt_pk_bf16_f32 v67, v158, v159
  v_mfma_f32_16x16x32_bf16 v[92:95], a[172:175], v[16:19], v[92:95]
  s_waitcnt vmcnt(16) lgkmcnt(4)
  buffer_store_dwordx4 v[64:67], v11, s[12:15], s98 offen offset:0 sc1
  v_mfma_f32_16x16x32_bf16 v[168:171], v[20:23], a[184:187], v[168:171]
  ds_read_b128 v[16:19], v1 offset:32768
  v_mul_f32 v160, v80, v80
  v_mfma_f32_16x16x32_bf16 v[172:175], v[20:23], a[188:191], v[172:175]
  s_waitcnt lgkmcnt(4)
  v_mul_f32 v161, v81, v81
  v_mul_f32 v162, v82, v82
  v_mfma_f32_16x16x32_bf16 v[72:75], a[184:187], v[24:27], v[72:75]
  ds_read_b128 v[20:23], v0 offset:1024
  v_mul_f32 v163, v83, v83
  v_mfma_f32_16x16x32_bf16 v[76:79], a[188:191], v[24:27], v[76:79]
  s_waitcnt lgkmcnt(4)
  v_mul_f32 v164, v84, v84
  v_mul_f32 v165, v85, v85
  v_mfma_f32_16x16x32_bf16 v[88:91], a[184:187], v[28:31], v[88:91]
  ds_read_b128 v[24:27], v1 offset:13312
  v_mul_f32 v166, v86, v86
  v_mfma_f32_16x16x32_bf16 v[92:95], a[188:191], v[28:31], v[92:95]
  s_waitcnt vmcnt(15) lgkmcnt(4)
  v_mul_f32 v167, v87, v87
  v_fma_f32 v160, v160, v53, v52
  v_mfma_f32_16x16x32_bf16 v[168:171], v[128:131], a[200:203], v[168:171]
  ds_read_b128 v[28:31], v1 offset:33792
  v_fma_f32 v161, v161, v53, v52
  v_mfma_f32_16x16x32_bf16 v[172:175], v[128:131], a[204:207], v[172:175]
  s_waitcnt lgkmcnt(4)
  v_fma_f32 v162, v162, v53, v52
  v_fma_f32 v163, v163, v53, v52
  v_mfma_f32_16x16x32_bf16 v[72:75], a[200:203], v[132:135], v[72:75]
  ds_read_b128 v[128:131], v0 offset:1120
  v_fma_f32 v164, v164, v53, v52
  v_mfma_f32_16x16x32_bf16 v[76:79], a[204:207], v[132:135], v[76:79]
  s_waitcnt lgkmcnt(4)
  v_fma_f32 v165, v165, v53, v52
  v_fma_f32 v166, v166, v53, v52
  v_mfma_f32_16x16x32_bf16 v[88:91], a[200:203], v[16:19], v[88:91]
  ds_read_b128 v[132:135], v1 offset:14336
  v_fma_f32 v167, v167, v53, v52
  v_mfma_f32_16x16x32_bf16 v[92:95], a[204:207], v[16:19], v[92:95]
  s_waitcnt vmcnt(13) lgkmcnt(4)
  v_mul_f32 v160, v160, v80
  v_mul_f32 v161, v161, v81
  v_mfma_f32_16x16x32_bf16 v[168:171], v[20:23], a[216:219], v[168:171]
  ds_read_b128 v[16:19], v1 offset:34816
  v_mul_f32 v162, v162, v82
  v_mfma_f32_16x16x32_bf16 v[172:175], v[20:23], a[220:223], v[172:175]
  s_waitcnt lgkmcnt(4)
  v_exp_f32 v160, v160
  v_mfma_f32_16x16x32_bf16 v[72:75], a[216:219], v[24:27], v[72:75]
  ds_read_b128 v[20:23], v0 offset:1184
  v_mul_f32 v163, v163, v83
  v_mfma_f32_16x16x32_bf16 v[76:79], a[220:223], v[24:27], v[76:79]
  s_waitcnt lgkmcnt(4)
  v_exp_f32 v161, v161
  v_mfma_f32_16x16x32_bf16 v[88:91], a[216:219], v[28:31], v[88:91]
  ds_read_b128 v[24:27], v1 offset:15360
  v_mul_f32 v164, v164, v84
  v_mfma_f32_16x16x32_bf16 v[92:95], a[220:223], v[28:31], v[92:95]
  s_waitcnt vmcnt(11) lgkmcnt(4)
  v_exp_f32 v162, v162
  v_mfma_f32_16x16x32_bf16 v[168:171], v[128:131], a[232:235], v[168:171]
  ds_read_b128 v[28:31], v1 offset:35840
  v_mul_f32 v165, v165, v85
  v_mfma_f32_16x16x32_bf16 v[172:175], v[128:131], a[236:239], v[172:175]
  s_waitcnt lgkmcnt(4)
  v_exp_f32 v163, v163
  v_mfma_f32_16x16x32_bf16 v[72:75], a[232:235], v[132:135], v[72:75]
  ds_read_b64 v[128:129], v15 offset:128
  ds_read_b64 v[130:131], v15 offset:288
  v_mfma_f32_16x16x32_bf16 v[76:79], a[236:239], v[132:135], v[76:79]
  s_waitcnt lgkmcnt(5)
  v_exp_f32 v164, v164
  v_mfma_f32_16x16x32_bf16 v[88:91], a[232:235], v[16:19], v[88:91]
  ds_read_b128 v[132:135], v1 offset:16384
  v_mul_f32 v166, v166, v86
  v_mfma_f32_16x16x32_bf16 v[92:95], a[236:239], v[16:19], v[92:95]
  s_waitcnt vmcnt(9) lgkmcnt(5)
  v_exp_f32 v165, v165
  v_mfma_f32_16x16x32_bf16 v[168:171], v[20:23], a[248:251], v[168:171]
  ds_read_b128 v[16:19], v1 offset:36864
  v_mul_f32 v167, v167, v87
  v_mfma_f32_16x16x32_bf16 v[172:175], v[20:23], a[252:255], v[172:175]
  s_waitcnt lgkmcnt(5)
  v_exp_f32 v166, v166
  v_mfma_f32_16x16x32_bf16 v[72:75], a[248:251], v[24:27], v[72:75]
  ds_read_b64 v[20:21], v15 offset:448
  ds_read_b64 v[22:23], v15 offset:608
  v_mfma_f32_16x16x32_bf16 v[76:79], a[252:255], v[24:27], v[76:79]
  s_waitcnt lgkmcnt(6)
  v_exp_f32 v167, v167
  v_mfma_f32_16x16x32_bf16 v[88:91], a[248:251], v[28:31], v[88:91]
  ds_read_b128 v[24:27], v1 offset:17408
  v_fma_f32 v160, v160, v54, v54
  v_mfma_f32_16x16x32_bf16 v[92:95], a[252:255], v[28:31], v[92:95]
  s_waitcnt vmcnt(7) lgkmcnt(5)
  v_rcp_f32 v160, v160
  v_mfma_f32_16x16x32_bf16 v[168:171], v[128:131], v[200:203], v[168:171]
  ds_read_b128 v[28:31], v1 offset:37888
  v_fma_f32 v161, v161, v54, v54
  v_mfma_f32_16x16x32_bf16 v[172:175], v[128:131], v[204:207], v[172:175]
  s_waitcnt lgkmcnt(5)
  v_rcp_f32 v161, v161
  v_mfma_f32_16x16x32_bf16 v[72:75], v[200:203], v[132:135], v[72:75]
  ds_read_b64 v[128:129], v15 offset:768
  ds_read_b64 v[130:131], v15 offset:928
  v_mfma_f32_16x16x32_bf16 v[76:79], v[204:207], v[132:135], v[76:79]
  s_waitcnt lgkmcnt(6)
  v_fma_f32 v162, v162, v54, v54
  v_fma_f32 v163, v163, v54, v54
  v_mfma_f32_16x16x32_bf16 v[88:91], v[200:203], v[16:19], v[88:91]
  ds_read_b128 v[132:135], v1 offset:18432
  v_fma_f32 v164, v164, v54, v54
  v_mfma_f32_16x16x32_bf16 v[92:95], v[204:207], v[16:19], v[92:95]
  s_waitcnt vmcnt(5) lgkmcnt(5)
  v_rcp_f32 v162, v162
  v_mfma_f32_16x16x32_bf16 v[168:171], v[20:23], v[216:219], v[168:171]
  ds_read_b128 v[16:19], v1 offset:38912
  v_fma_f32 v165, v165, v54, v54
  v_mfma_f32_16x16x32_bf16 v[172:175], v[20:23], v[220:223], v[172:175]
  s_waitcnt lgkmcnt(5)
  v_rcp_f32 v163, v163
  v_mfma_f32_16x16x32_bf16 v[72:75], v[216:219], v[24:27], v[72:75]
  ds_read_b64 v[20:21], v15 offset:1088
  ds_read_b64 v[22:23], v15 offset:1248
  v_mfma_f32_16x16x32_bf16 v[76:79], v[220:223], v[24:27], v[76:79]
  s_waitcnt lgkmcnt(6)
  v_rcp_f32 v164, v164
  v_mfma_f32_16x16x32_bf16 v[88:91], v[216:219], v[28:31], v[88:91]
  ds_read_b128 v[24:27], v1 offset:19456
  v_fma_f32 v166, v166, v54, v54
  v_mfma_f32_16x16x32_bf16 v[92:95], v[220:223], v[28:31], v[92:95]
  s_waitcnt vmcnt(3) lgkmcnt(5)
  v_rcp_f32 v165, v165
  v_mfma_f32_16x16x32_bf16 v[168:171], v[128:131], v[232:235], v[168:171]
  ds_read_b128 v[28:31], v1 offset:39936
  v_fma_f32 v167, v167, v54, v54
  v_mfma_f32_16x16x32_bf16 v[172:175], v[128:131], v[236:239], v[172:175]
  s_waitcnt lgkmcnt(5)
  v_rcp_f32 v166, v166
  v_mfma_f32_16x16x32_bf16 v[72:75], v[232:235], v[132:135], v[72:75]
  v_rcp_f32 v167, v167
  v_mfma_f32_16x16x32_bf16 v[76:79], v[236:239], v[132:135], v[76:79]
  s_waitcnt lgkmcnt(4)
  v_mul_f32 v160, v160, v80
  v_mul_f32 v161, v161, v81
  v_mfma_f32_16x16x32_bf16 v[88:91], v[232:235], v[16:19], v[88:91]
  v_mul_f32 v162, v162, v82
  v_mul_f32 v163, v163, v83
  v_mfma_f32_16x16x32_bf16 v[92:95], v[236:239], v[16:19], v[92:95]
  s_waitcnt vmcnt(1) lgkmcnt(2)
  v_mul_f32 v164, v164, v84
  v_mul_f32 v165, v165, v85
  v_mfma_f32_16x16x32_bf16 v[168:171], v[20:23], v[248:251], v[168:171]
  v_mul_f32 v166, v166, v86
  v_mul_f32 v167, v167, v87
  v_mfma_f32_16x16x32_bf16 v[172:175], v[20:23], v[252:255], v[172:175]
  s_waitcnt lgkmcnt(1)
  v_cvt_pk_bf16_f32 v80, v160, v161
  v_cvt_pk_bf16_f32 v81, v162, v163
  v_mfma_f32_16x16x32_bf16 v[72:75], v[248:251], v[24:27], v[72:75]
  v_cvt_pk_bf16_f32 v82, v164, v165
  v_cvt_pk_bf16_f32 v83, v166, v167
  v_mfma_f32_16x16x32_bf16 v[76:79], v[252:255], v[24:27], v[76:79]
  s_waitcnt lgkmcnt(0)
  buffer_store_dwordx4 v[80:83], v11, s[12:15], s98 offen offset:1024 sc1
  v_mfma_f32_16x16x32_bf16 v[88:91], v[248:251], v[28:31], v[88:91]
  v_mfma_f32_16x16x32_bf16 v[92:95], v[252:255], v[28:31], v[92:95]
  s_barrier
  ds_read_b128 v[16:19], v1 offset:40960
  ds_read_b128 v[20:23], v4 offset:8192
  ds_read_b128 v[24:27], v1 offset:41984
  ds_read_b128 v[28:31], v4 offset:9216
  ds_read_b128 v[128:131], v1 offset:43008
  s_waitcnt lgkmcnt(4)
  v_mfma_f32_16x16x32_bf16 v[96:99], a[0:3], v[16:19], 0
  ds_read_b128 v[132:135], v4 offset:10240
  v_cvt_pk_bf16_f32 v145, v170, v144
  v_cvt_pk_bf16_f32 v144, v168, v169
  v_lshlrev_b32 v176, 16, v144
  v_mfma_f32_16x16x32_bf16 v[100:103], a[4:7], v[16:19], 0
  s_waitcnt lgkmcnt(4)
  v_and_b32 v177, 0xffff0000, v144
  v_lshlrev_b32 v178, 16, v145
  v_sub_f32 v176, v168, v176
  v_sub_f32 v177, v169, v177
  v_mfma_f32_16x16x32_bf16 v[112:115], a[0:3], v[20:23], 0
  ds_read_b128 v[16:19], v1 offset:44032
  v_sub_f32 v178, v170, v178
  v_cvt_pk_bf16_f32 v146, v176, v177
  v_cvt_pk_bf16_f32 v147, v178, 0
  v_mfma_f32_16x16x32_bf16 v[116:119], a[4:7], v[20:23], 0
  s_waitcnt lgkmcnt(4)
  v_cvt_pk_bf16_f32 v149, v174, v148
  v_cvt_pk_bf16_f32 v148, v172, v173
  v_lshlrev_b32 v176, 16, v148
  v_and_b32 v177, 0xffff0000, v148
  v_mfma_f32_16x16x32_bf16 v[96:99], a[16:19], v[24:27], v[96:99]
  ds_read_b128 v[20:23], v4 offset:11264
  v_lshlrev_b32 v178, 16, v149
  v_sub_f32 v176, v172, v176
  v_sub_f32 v177, v173, v177
  v_mfma_f32_16x16x32_bf16 v[100:103], a[20:23], v[24:27], v[100:103]
  s_waitcnt lgkmcnt(4)
  s_add_u32 s27, s24, 0
  buffer_load_dwordx4 a[0:3], v1, s[12:15], s27 offen offset:0 sc1
  v_sub_f32 v178, v174, v178
  v_cvt_pk_bf16_f32 v150, v176, v177
  v_mfma_f32_16x16x32_bf16 v[112:115], a[16:19], v[28:31], v[112:115]
  ds_read_b128 v[24:27], v1 offset:45056
  v_cvt_pk_bf16_f32 v151, v178, 0
  v_mfma_f32_16x16x32_bf16 v[116:119], a[20:23], v[28:31], v[116:119]
  s_waitcnt lgkmcnt(4)
  v_mfma_f32_16x16x32_bf16 v[96:99], a[32:35], v[128:131], v[96:99]
  ds_read_b128 v[28:31], v4 offset:12288
  v_mfma_f32_16x16x32_bf16 v[72:75], v[144:147], v[32:35], v[72:75]
  v_mfma_f32_16x16x32_bf16 v[76:79], v[148:151], v[32:35], v[76:79]
  v_mfma_f32_16x16x32_bf16 v[88:91], v[144:147], v[36:39], v[88:91]
  v_mfma_f32_16x16x32_bf16 v[92:95], v[148:151], v[36:39], v[92:95]
  v_mfma_f32_16x16x32_bf16 v[100:103], a[36:39], v[128:131], v[100:103]
  s_waitcnt lgkmcnt(4)
  buffer_load_dwordx4 a[4:7], v1, s[12:15], s27 offen offset:1024 sc1
  v_mfma_f32_16x16x32_bf16 v[112:115], a[32:35], v[132:135], v[112:115]
  ds_read_b128 v[128:131], v1 offset:46080
  v_mfma_f32_16x16x32_bf16 v[116:119], a[36:39], v[132:135], v[116:119]
  s_waitcnt lgkmcnt(4)
  v_mul_f32 v152, v72, v72
  v_mul_f32 v153, v73, v73
  v_mul_f32 v154, v74, v74
  v_mul_f32 v155, v75, v75
  v_mfma_f32_16x16x32_bf16 v[96:99], a[48:51], v[16:19], v[96:99]
  ds_read_b128 v[132:135], v4 offset:13312
  v_mul_f32 v156, v76, v76
  v_mul_f32 v157, v77, v77
  v_mul_f32 v158, v78, v78
  v_mfma_f32_16x16x32_bf16 v[100:103], a[52:55], v[16:19], v[100:103]
  s_waitcnt lgkmcnt(4)
  v_mul_f32 v159, v79, v79
  v_fma_f32 v152, v152, v49, v48
  v_fma_f32 v153, v153, v49, v48
  v_fma_f32 v154, v154, v49, v48
  v_mfma_f32_16x16x32_bf16 v[112:115], a[48:51], v[20:23], v[112:115]
  ds_read_b128 v[16:19], v1 offset:47104
  v_fma_f32 v155, v155, v49, v48
  v_fma_f32 v156, v156, v49, v48
  v_fma_f32 v157, v157, v49, v48
  v_mfma_f32_16x16x32_bf16 v[116:119], a[52:55], v[20:23], v[116:119]
  s_waitcnt lgkmcnt(4)
  s_add_u32 s27, s24, 4096
  buffer_load_dwordx4 a[16:19], v1, s[12:15], s27 offen offset:0 sc1
  v_fma_f32 v158, v158, v49, v48
  v_fma_f32 v159, v159, v49, v48
  v_mfma_f32_16x16x32_bf16 v[96:99], a[64:67], v[24:27], v[96:99]
  ds_read_b128 v[20:23], v4 offset:14336
  v_mul_f32 v152, v152, v72
  v_exp_f32 v152, v152
  v_mfma_f32_16x16x32_bf16 v[100:103], a[68:71], v[24:27], v[100:103]
  s_waitcnt lgkmcnt(4)
  v_mul_f32 v153, v153, v73
  v_mul_f32 v154, v154, v74
  v_exp_f32 v153, v153
  v_mfma_f32_16x16x32_bf16 v[112:115], a[64:67], v[28:31], v[112:115]
  ds_read_b128 v[24:27], v1 offset:48128
  v_mul_f32 v155, v155, v75
  v_exp_f32 v154, v154
  v_mfma_f32_16x16x32_bf16 v[116:119], a[68:71], v[28:31], v[116:119]
  s_waitcnt lgkmcnt(4)
  buffer_load_dwordx4 a[20:23], v1, s[12:15], s27 offen offset:1024 sc1
  v_exp_f32 v155, v155
  v_mfma_f32_16x16x32_bf16 v[96:99], a[80:83], v[128:131], v[96:99]
  ds_read_b128 v[28:31], v4 offset:15360
  v_mul_f32 v156, v156, v76
  v_exp_f32 v156, v156
  v_mfma_f32_16x16x32_bf16 v[100:103], a[84:87], v[128:131], v[100:103]
  s_waitcnt lgkmcnt(4)
  v_mul_f32 v157, v157, v77
  v_mul_f32 v158, v158, v78
  v_exp_f32 v157, v157
  v_mfma_f32_16x16x32_bf16 v[112:115], a[80:83], v[132:135], v[112:115]
  ds_read_b128 v[128:131], v1 offset:49152
  v_mul_f32 v159, v159, v79
  v_exp_f32 v158, v158
  v_mfma_f32_16x16x32_bf16 v[116:119], a[84:87], v[132:135], v[116:119]
  s_waitcnt lgkmcnt(4)
  v_exp_f32 v159, v159
  v_fma_f32 v152, v152, v50, v50
  v_fma_f32 v153, v153, v50, v50
  v_mfma_f32_16x16x32_bf16 v[96:99], a[96:99], v[16:19], v[96:99]
  ds_read_b128 v[132:135], v4 offset:16384
  v_fma_f32 v154, v154, v50, v50
  v_rcp_f32 v152, v152
  v_mfma_f32_16x16x32_bf16 v[100:103], a[100:103], v[16:19], v[100:103]
  s_waitcnt lgkmcnt(4)
  s_add_u32 s27, s24, 8192
  buffer_load_dwordx4 a[32:35], v1, s[12:15], s27 offen offset:0 sc1
  v_rcp_f32 v153, v153
  v_mfma_f32_16x16x32_bf16 v[112:115], a[96:99], v[20:23], v[112:115]
  ds_read_b128 v[16:19], v1 offset:50176
  v_fma_f32 v155, v155, v50, v50
  v_rcp_f32 v154, v154
  v_mfma_f32_16x16x32_bf16 v[116:119], a[100:103], v[20:23], v[116:119]
  s_waitcnt lgkmcnt(4)
  v_rcp_f32 v155, v155
  v_fma_f32 v156, v156, v50, v50
  v_fma_f32 v157, v157, v50, v50
  v_mfma_f32_16x16x32_bf16 v[96:99], a[112:115], v[24:27], v[96:99]
  ds_read_b128 v[20:23], v4 offset:17408
  v_fma_f32 v158, v158, v50, v50
  v_rcp_f32 v156, v156
  v_mfma_f32_16x16x32_bf16 v[100:103], a[116:119], v[24:27], v[100:103]
  s_waitcnt lgkmcnt(4)
  buffer_load_dwordx4 a[36:39], v1, s[12:15], s27 offen offset:1024 sc1
  v_rcp_f32 v157, v157
  v_mfma_f32_16x16x32_bf16 v[112:115], a[112:115], v[28:31], v[112:115]
  ds_read_b128 v[24:27], v1 offset:51200
  v_fma_f32 v159, v159, v50, v50
  v_rcp_f32 v158, v158
  v_mfma_f32_16x16x32_bf16 v[116:119], a[116:119], v[28:31], v[116:119]
  s_waitcnt lgkmcnt(4)
  v_rcp_f32 v159, v159
  v_mul_f32 v152, v152, v72
  v_mul_f32 v153, v153, v73
  v_mfma_f32_16x16x32_bf16 v[96:99], a[128:131], v[128:131], v[96:99]
  ds_read_b128 v[28:31], v4 offset:18432
  v_mul_f32 v154, v154, v74
  v_mul_f32 v155, v155, v75
  v_mul_f32 v156, v156, v76
  v_mfma_f32_16x16x32_bf16 v[100:103], a[132:135], v[128:131], v[100:103]
  s_waitcnt lgkmcnt(4)
  v_mul_f32 v157, v157, v77
  v_mul_f32 v158, v158, v78
  v_mul_f32 v159, v159, v79
  v_cvt_pk_bf16_f32 v72, v152, v153
  v_mfma_f32_16x16x32_bf16 v[112:115], a[128:131], v[132:135], v[112:115]
  ds_read_b128 v[128:131], v1 offset:52224
  v_cvt_pk_bf16_f32 v73, v154, v155
  v_cvt_pk_bf16_f32 v74, v156, v157
  v_cvt_pk_bf16_f32 v75, v158, v159
  v_mfma_f32_16x16x32_bf16 v[116:119], a[132:135], v[132:135], v[116:119]
  s_waitcnt lgkmcnt(4)
  s_add_u32 s27, s24, 12288
  buffer_load_dwordx4 a[48:51], v1, s[12:15], s27 offen offset:0 sc1
  buffer_store_dwordx4 v[72:75], v11, s[12:15], s99 offen offset:0 sc1
  v_mfma_f32_16x16x32_bf16 v[96:99], a[144:147], v[16:19], v[96:99]
  ds_read_b128 v[132:135], v4 offset:19456
  v_mul_f32 v160, v88, v88
  v_mul_f32 v161, v89, v89
  v_mul_f32 v162, v90, v90
  v_mfma_f32_16x16x32_bf16 v[100:103], a[148:151], v[16:19], v[100:103]
  s_waitcnt lgkmcnt(4)
  v_mul_f32 v163, v91, v91
  v_mul_f32 v164, v92, v92
  v_mul_f32 v165, v93, v93
  v_mul_f32 v166, v94, v94
  v_mfma_f32_16x16x32_bf16 v[112:115], a[144:147], v[20:23], v[112:115]
  ds_read_b128 v[16:19], v1 offset:53248
  v_mul_f32 v167, v95, v95
  v_fma_f32 v160, v160, v53, v52
  v_fma_f32 v161, v161, v53, v52
  v_mfma_f32_16x16x32_bf16 v[116:119], a[148:151], v[20:23], v[116:119]
  s_waitcnt lgkmcnt(4)
  buffer_load_dwordx4 a[52:55], v1, s[12:15], s27 offen offset:1024 sc1
  v_fma_f32 v162, v162, v53, v52
  v_fma_f32 v163, v163, v53, v52
  v_mfma_f32_16x16x32_bf16 v[96:99], a[160:163], v[24:27], v[96:99]
  ds_read_b128 v[20:23], v4 offset:20480
  v_fma_f32 v164, v164, v53, v52
  v_fma_f32 v165, v165, v53, v52
  v_fma_f32 v166, v166, v53, v52
  v_mfma_f32_16x16x32_bf16 v[100:103], a[164:167], v[24:27], v[100:103]
  s_waitcnt lgkmcnt(4)
  v_fma_f32 v167, v167, v53, v52
  v_mul_f32 v160, v160, v88
  v_exp_f32 v160, v160
  v_mfma_f32_16x16x32_bf16 v[112:115], a[160:163], v[28:31], v[112:115]
  ds_read_b128 v[24:27], v1 offset:54272
  v_mul_f32 v161, v161, v89
  v_exp_f32 v161, v161
  v_mfma_f32_16x16x32_bf16 v[116:119], a[164:167], v[28:31], v[116:119]
  s_waitcnt lgkmcnt(4)
  v_mul_f32 v162, v162, v90
  v_mul_f32 v163, v163, v91
  v_exp_f32 v162, v162
  v_mfma_f32_16x16x32_bf16 v[96:99], a[176:179], v[128:131], v[96:99]
  ds_read_b128 v[28:31], v4 offset:21504
  v_mul_f32 v164, v164, v92
  v_exp_f32 v163, v163
  v_mfma_f32_16x16x32_bf16 v[100:103], a[180:183], v[128:131], v[100:103]
  s_waitcnt lgkmcnt(4)
  s_add_u32 s27, s24, 16384
  buffer_load_dwordx4 a[64:67], v1, s[12:15], s27 offen offset:0 sc1
  v_exp_f32 v164, v164
  v_mfma_f32_16x16x32_bf16 v[112:115], a[176:179], v[132:135], v[112:115]
  ds_read_b128 v[128:131], v1 offset:55296
  v_mul_f32 v165, v165, v93
  v_exp_f32 v165, v165
  v_mfma_f32_16x16x32_bf16 v[116:119], a[180:183], v[132:135], v[116:119]
  s_waitcnt lgkmcnt(4)
  v_mul_f32 v166, v166, v94
  v_mul_f32 v167, v167, v95
  v_exp_f32 v166, v166
  v_mfma_f32_16x16x32_bf16 v[96:99], a[192:195], v[16:19], v[96:99]
  ds_read_b128 v[132:135], v4 offset:22528
  v_exp_f32 v167, v167
  v_fma_f32 v160, v160, v54, v54
  v_mfma_f32_16x16x32_bf16 v[100:103], a[196:199], v[16:19], v[100:103]
  s_waitcnt lgkmcnt(4)
  buffer_load_dwordx4 a[68:71], v1, s[12:15], s27 offen offset:1024 sc1
  v_rcp_f32 v160, v160
  v_mfma_f32_16x16x32_bf16 v[112:115], a[192:195], v[20:23], v[112:115]
  ds_read_b128 v[16:19], v1 offset:56320
  v_fma_f32 v161, v161, v54, v54
  v_rcp_f32 v161, v161
  v_mfma_f32_16x16x32_bf16 v[116:119], a[196:199], v[20:23], v[116:119]
  s_waitcnt lgkmcnt(4)
  v_fma_f32 v162, v162, v54, v54
  v_fma_f32 v163, v163, v54, v54
  v_rcp_f32 v162, v162
  v_mfma_f32_16x16x32_bf16 v[96:99], a[208:211], v[24:27], v[96:99]
  ds_read_b128 v[20:23], v4 offset:23552
  v_fma_f32 v164, v164, v54, v54
  v_rcp_f32 v163, v163
  v_mfma_f32_16x16x32_bf16 v[100:103], a[212:215], v[24:27], v[100:103]
  s_waitcnt lgkmcnt(4)
  v_rcp_f32 v164, v164
  v_fma_f32 v165, v165, v54, v54
  v_fma_f32 v166, v166, v54, v54
  v_mfma_f32_16x16x32_bf16 v[112:115], a[208:211], v[28:31], v[112:115]
  ds_read_b128 v[24:27], v1 offset:57344
  v_fma_f32 v167, v167, v54, v54
  v_rcp_f32 v165, v165
  v_mfma_f32_16x16x32_bf16 v[116:119], a[212:215], v[28:31], v[116:119]
  s_waitcnt lgkmcnt(4)
  s_add_u32 s27, s24, 20480
  buffer_load_dwordx4 a[80:83], v1, s[12:15], s27 offen offset:0 sc1
  v_rcp_f32 v166, v166
  v_mfma_f32_16x16x32_bf16 v[96:99], a[224:227], v[128:131], v[96:99]
  ds_read_b128 v[28:31], v4 offset:24576
  v_rcp_f32 v167, v167
  v_mul_f32 v160, v160, v88
  v_mfma_f32_16x16x32_bf16 v[100:103], a[228:231], v[128:131], v[100:103]
  s_waitcnt lgkmcnt(4)
  v_mul_f32 v161, v161, v89
  v_mul_f32 v162, v162, v90
  v_mul_f32 v163, v163, v91
  v_mul_f32 v164, v164, v92
  v_mfma_f32_16x16x32_bf16 v[112:115], a[224:227], v[132:135], v[112:115]
  ds_read_b128 v[128:131], v1 offset:58368
  v_mul_f32 v165, v165, v93
  v_mul_f32 v166, v166, v94
  v_mul_f32 v167, v167, v95
  v_mfma_f32_16x16x32_bf16 v[116:119], a[228:231], v[132:135], v[116:119]
  s_waitcnt lgkmcnt(4)
  buffer_load_dwordx4 a[84:87], v1, s[12:15], s27 offen offset:1024 sc1
  v_cvt_pk_bf16_f32 v88, v160, v161
  v_cvt_pk_bf16_f32 v89, v162, v163
  v_mfma_f32_16x16x32_bf16 v[96:99], a[240:243], v[16:19], v[96:99]
  ds_read_b128 v[132:135], v4 offset:25600
  v_cvt_pk_bf16_f32 v90, v164, v165
  v_cvt_pk_bf16_f32 v91, v166, v167
  v_mfma_f32_16x16x32_bf16 v[100:103], a[244:247], v[16:19], v[100:103]
  s_waitcnt lgkmcnt(4)
  buffer_store_dwordx4 v[88:91], v11, s[12:15], s99 offen offset:1024 sc1
  v_mfma_f32_16x16x32_bf16 v[112:115], a[240:243], v[20:23], v[112:115]
  ds_read_b128 v[16:19], v1 offset:59392
  v_mfma_f32_16x16x32_bf16 v[116:119], a[244:247], v[20:23], v[116:119]
  s_waitcnt lgkmcnt(4)
  s_add_u32 s27, s24, 24576
  buffer_load_dwordx4 a[96:99], v1, s[12:15], s27 offen offset:0 sc1
  v_mfma_f32_16x16x32_bf16 v[96:99], v[192:195], v[24:27], v[96:99]
  ds_read_b128 v[20:23], v4 offset:26624
  v_mfma_f32_16x16x32_bf16 v[100:103], v[196:199], v[24:27], v[100:103]
  s_waitcnt lgkmcnt(4)
  v_mfma_f32_16x16x32_bf16 v[112:115], v[192:195], v[28:31], v[112:115]
  ds_read_b128 v[24:27], v1 offset:60416
  v_mfma_f32_16x16x32_bf16 v[116:119], v[196:199], v[28:31], v[116:119]
  s_waitcnt lgkmcnt(4)
  buffer_load_dwordx4 a[100:103], v1, s[12:15], s27 offen offset:1024 sc1
  v_mfma_f32_16x16x32_bf16 v[96:99], v[208:211], v[128:131], v[96:99]
  ds_read_b128 v[28:31], v4 offset:27648
  v_mfma_f32_16x16x32_bf16 v[100:103], v[212:215], v[128:131], v[100:103]
  s_waitcnt lgkmcnt(4)
  v_mfma_f32_16x16x32_bf16 v[112:115], v[208:211], v[132:135], v[112:115]
  ds_read_b128 v[128:131], v1 offset:40960
  v_mfma_f32_16x16x32_bf16 v[116:119], v[212:215], v[132:135], v[116:119]
  s_waitcnt lgkmcnt(4)
  s_add_u32 s27, s24, 28672
  buffer_load_dwordx4 a[112:115], v1, s[12:15], s27 offen offset:0 sc1
  v_mfma_f32_16x16x32_bf16 v[96:99], v[224:227], v[16:19], v[96:99]
  ds_read_b128 v[132:135], v4 offset:8192
  v_mfma_f32_16x16x32_bf16 v[100:103], v[228:231], v[16:19], v[100:103]
  s_waitcnt lgkmcnt(4)
  buffer_load_dwordx4 a[116:119], v1, s[12:15], s27 offen offset:1024 sc1
  v_mfma_f32_16x16x32_bf16 v[112:115], v[224:227], v[20:23], v[112:115]
  ds_read_b128 v[16:19], v1 offset:41984
  v_mfma_f32_16x16x32_bf16 v[116:119], v[228:231], v[20:23], v[116:119]
  s_waitcnt lgkmcnt(4)
  v_mfma_f32_16x16x32_bf16 v[96:99], v[240:243], v[24:27], v[96:99]
  ds_read_b128 v[20:23], v4 offset:9216
  v_mfma_f32_16x16x32_bf16 v[100:103], v[244:247], v[24:27], v[100:103]
  s_waitcnt lgkmcnt(4)
  s_add_u32 s27, s24, 32768
  buffer_load_dwordx4 a[128:131], v1, s[12:15], s27 offen offset:0 sc1
  v_mfma_f32_16x16x32_bf16 v[112:115], v[240:243], v[28:31], v[112:115]
  ds_read_b128 v[24:27], v1 offset:43008
  v_mfma_f32_16x16x32_bf16 v[116:119], v[244:247], v[28:31], v[116:119]
  s_waitcnt lgkmcnt(4)
  v_mfma_f32_16x16x32_bf16 v[104:107], a[8:11], v[128:131], 0
  ds_read_b128 v[28:31], v4 offset:10240
  v_mfma_f32_16x16x32_bf16 v[108:111], a[12:15], v[128:131], 0
  s_waitcnt lgkmcnt(4)
  buffer_load_dwordx4 a[132:135], v1, s[12:15], s27 offen offset:1024 sc1
  v_mfma_f32_16x16x32_bf16 v[120:123], a[8:11], v[132:135], 0
  ds_read_b128 v[128:131], v1 offset:44032
  v_mfma_f32_16x16x32_bf16 v[124:127], a[12:15], v[132:135], 0
  s_waitcnt lgkmcnt(4)
  v_mfma_f32_16x16x32_bf16 v[104:107], a[24:27], v[16:19], v[104:107]
  ds_read_b128 v[132:135], v4 offset:11264
  v_mfma_f32_16x16x32_bf16 v[108:111], a[28:31], v[16:19], v[108:111]
  s_waitcnt lgkmcnt(4)
  s_add_u32 s27, s24, 0
  buffer_load_dwordx4 a[8:11], v1, s[12:15], s27 offen offset:2048 sc1
  v_mfma_f32_16x16x32_bf16 v[120:123], a[24:27], v[20:23], v[120:123]
  ds_read_b128 v[16:19], v1 offset:45056
  v_mfma_f32_16x16x32_bf16 v[124:127], a[28:31], v[20:23], v[124:127]
  s_waitcnt lgkmcnt(4)
  buffer_load_dwordx4 a[12:15], v1, s[12:15], s27 offen offset:3072 sc1
  v_mfma_f32_16x16x32_bf16 v[104:107], a[40:43], v[24:27], v[104:107]
  ds_read_b128 v[20:23], v4 offset:12288
  v_mfma_f32_16x16x32_bf16 v[108:111], a[44:47], v[24:27], v[108:111]
  s_waitcnt lgkmcnt(4)
  v_mfma_f32_16x16x32_bf16 v[120:123], a[40:43], v[28:31], v[120:123]
  ds_read_b128 v[24:27], v1 offset:46080
  v_mfma_f32_16x16x32_bf16 v[124:127], a[44:47], v[28:31], v[124:127]
  s_waitcnt lgkmcnt(4)
  s_add_u32 s27, s24, 4096
  buffer_load_dwordx4 a[24:27], v1, s[12:15], s27 offen offset:2048 sc1
  s_barrier
  v_mfma_f32_16x16x32_bf16 v[104:107], a[56:59], v[128:131], v[104:107]
  ds_read_b128 v[28:31], v4 offset:13312
  ds_read_b128 v[40:43], v4 offset:2048
  v_mfma_f32_16x16x32_bf16 v[108:111], a[60:63], v[128:131], v[108:111]
  s_waitcnt lgkmcnt(5)
  ds_read_b128 v[56:59], v4 offset:6144
  ds_read_b128 v[44:47], v4 offset:3072
  v_mfma_f32_16x16x32_bf16 v[120:123], a[56:59], v[132:135], v[120:123]
  ds_read_b128 v[128:131], v1 offset:47104
  ds_read_b128 v[60:63], v4 offset:7168
  v_mfma_f32_16x16x32_bf16 v[124:127], a[60:63], v[132:135], v[124:127]
  s_waitcnt lgkmcnt(8)
  buffer_load_dwordx4 a[28:31], v1, s[12:15], s27 offen offset:3072 sc1
  v_mfma_f32_16x16x32_bf16 v[104:107], a[72:75], v[16:19], v[104:107]
  ds_read_b128 v[132:135], v4 offset:14336
  v_mfma_f32_16x16x32_bf16 v[108:111], a[76:79], v[16:19], v[108:111]
  s_waitcnt lgkmcnt(8)
  s_add_u32 s27, s24, 8192
  buffer_load_dwordx4 a[40:43], v1, s[12:15], s27 offen offset:2048 sc1
  v_mfma_f32_16x16x32_bf16 v[120:123], a[72:75], v[20:23], v[120:123]
  ds_read_b128 v[16:19], v1 offset:48128
  s_waitcnt lgkmcnt(6)
  v_mfma_f32_16x16x32_bf16 v[96:99], v[136:139], v[40:43], v[96:99]
  v_mfma_f32_16x16x32_bf16 v[100:103], v[140:143], v[40:43], v[100:103]
  s_waitcnt lgkmcnt(4)
  v_mfma_f32_16x16x32_bf16 v[112:115], v[136:139], v[44:47], v[112:115]
  v_mfma_f32_16x16x32_bf16 v[116:119], v[140:143], v[44:47], v[116:119]
  v_mfma_f32_16x16x32_bf16 v[124:127], a[76:79], v[20:23], v[124:127]
  v_mfma_f32_16x16x32_bf16 v[104:107], a[88:91], v[24:27], v[104:107]
  ds_read_b128 v[20:23], v4 offset:15360
  v_mfma_f32_16x16x32_bf16 v[108:111], a[92:95], v[24:27], v[108:111]
  buffer_load_dwordx4 a[44:47], v1, s[12:15], s27 offen offset:3072 sc1
  v_mul_f32 v152, v96, v96
  v_mul_f32 v153, v97, v97
  v_mfma_f32_16x16x32_bf16 v[120:123], a[88:91], v[28:31], v[120:123]
  ds_read_b128 v[24:27], v1 offset:49152
  v_mul_f32 v154, v98, v98
  v_mul_f32 v155, v99, v99
  v_mul_f32 v156, v100, v100
  v_mfma_f32_16x16x32_bf16 v[124:127], a[92:95], v[28:31], v[124:127]
  s_waitcnt lgkmcnt(5)
  v_mul_f32 v157, v101, v101
  v_mul_f32 v158, v102, v102
  v_mul_f32 v159, v103, v103
  v_fma_f32 v152, v152, v57, v56
  v_mfma_f32_16x16x32_bf16 v[104:107], a[104:107], v[128:131], v[104:107]
  ds_read_b128 v[28:31], v4 offset:16384
  v_fma_f32 v153, v153, v57, v56
  v_fma_f32 v154, v154, v57, v56
  v_fma_f32 v155, v155, v57, v56
  v_mfma_f32_16x16x32_bf16 v[108:111], a[108:111], v[128:131], v[108:111]
  s_waitcnt lgkmcnt(4)
  s_add_u32 s27, s24, 12288
  buffer_load_dwordx4 a[56:59], v1, s[12:15], s27 offen offset:2048 sc1
  v_fma_f32 v156, v156, v57, v56
  v_fma_f32 v157, v157, v57, v56
  s_waitcnt vmcnt(13)
  s_barrier
  s_cmp_lg_u32 s3, 0
  s_cbranch_scc1 SK33
  s_add_u32 s6, s52, 16384
  buffer_store_dword v14, v10, s[12:15], s6 offen sc1
SK33:
  v_mfma_f32_16x16x32_bf16 v[120:123], a[104:107], v[132:135], v[120:123]
  ds_read_b128 v[128:131], v1 offset:50176
  v_fma_f32 v158, v158, v57, v56
  v_fma_f32 v159, v159, v57, v56
  v_mul_f32 v152, v152, v96
  v_mfma_f32_16x16x32_bf16 v[124:127], a[108:111], v[132:135], v[124:127]
  s_waitcnt lgkmcnt(4)
  v_exp_f32 v152, v152
  v_mul_f32 v153, v153, v97
  v_mul_f32 v154, v154, v98
  v_mfma_f32_16x16x32_bf16 v[104:107], a[120:123], v[16:19], v[104:107]
  ds_read_b128 v[132:135], v4 offset:17408
  v_mul_f32 v155, v155, v99
  v_exp_f32 v153, v153
  v_mfma_f32_16x16x32_bf16 v[108:111], a[124:127], v[16:19], v[108:111]
  s_waitcnt lgkmcnt(4)
  buffer_load_dwordx4 a[60:63], v1, s[12:15], s27 offen offset:3072 sc1
  v_exp_f32 v154, v154
  v_mfma_f32_16x16x32_bf16 v[120:123], a[120:123], v[20:23], v[120:123]
  ds_read_b128 v[16:19], v1 offset:51200
  v_mul_f32 v156, v156, v100
  v_exp_f32 v155, v155
  v_mfma_f32_16x16x32_bf16 v[124:127], a[124:127], v[20:23], v[124:127]
  s_waitcnt lgkmcnt(4)
  v_exp_f32 v156, v156
  v_mul_f32 v157, v157, v101
  v_mul_f32 v158, v158, v102
  v_mfma_f32_16x16x32_bf16 v[104:107], a[136:139], v[24:27], v[104:107]
  ds_read_b128 v[20:23], v4 offset:18432
  v_mul_f32 v159, v159, v103
  v_exp_f32 v157, v157
  v_mfma_f32_16x16x32_bf16 v[108:111], a[140:143], v[24:27], v[108:111]
  s_waitcnt lgkmcnt(4)
  s_add_u32 s27, s24, 16384
  buffer_load_dwordx4 a[72:75], v1, s[12:15], s27 offen offset:2048 sc1
  v_exp_f32 v158, v158
  v_mfma_f32_16x16x32_bf16 v[120:123], a[136:139], v[28:31], v[120:123]
  ds_read_b128 v[24:27], v1 offset:52224
  v_exp_f32 v159, v159
  v_fma_f32 v152, v152, v58, v58
  v_mfma_f32_16x16x32_bf16 v[124:127], a[140:143], v[28:31], v[124:127]
  s_waitcnt lgkmcnt(4)
  v_rcp_f32 v152, v152
  v_fma_f32 v153, v153, v58, v58
  v_fma_f32 v154, v154, v58, v58
  v_mfma_f32_16x16x32_bf16 v[104:107], a[152:155], v[128:131], v[104:107]
  ds_read_b128 v[28:31], v4 offset:19456
  v_fma_f32 v155, v155, v58, v58
  v_rcp_f32 v153, v153
  v_mfma_f32_16x16x32_bf16 v[108:111], a[156:159], v[128:131], v[108:111]
  s_waitcnt lgkmcnt(4)
  buffer_load_dwordx4 a[76:79], v1, s[12:15], s27 offen offset:3072 sc1
  v_rcp_f32 v154, v154
  v_mfma_f32_16x16x32_bf16 v[120:123], a[152:155], v[132:135], v[120:123]
  ds_read_b128 v[128:131], v1 offset:53248
  v_fma_f32 v156, v156, v58, v58
  v_rcp_f32 v155, v155
  v_mfma_f32_16x16x32_bf16 v[124:127], a[156:159], v[132:135], v[124:127]
  s_waitcnt lgkmcnt(4)
  v_rcp_f32 v156, v156
  v_fma_f32 v157, v157, v58, v58
  v_fma_f32 v158, v158, v58, v58
  v_mfma_f32_16x16x32_bf16 v[104:107], a[168:171], v[16:19], v[104:107]
  ds_read_b128 v[132:135], v4 offset:20480
  v_fma_f32 v159, v159, v58, v58
  v_rcp_f32 v157, v157
  v_mfma_f32_16x16x32_bf16 v[108:111], a[172:175], v[16:19], v[108:111]
  s_waitcnt lgkmcnt(4)
  s_add_u32 s27, s24, 20480
  buffer_load_dwordx4 a[88:91], v1, s[12:15], s27 offen offset:2048 sc1
  v_rcp_f32 v158, v158
  v_mfma_f32_16x16x32_bf16 v[120:123], a[168:171], v[20:23], v[120:123]
  ds_read_b128 v[16:19], v1 offset:54272
  v_rcp_f32 v159, v159
  v_mul_f32 v152, v152, v96
  v_mfma_f32_16x16x32_bf16 v[124:127], a[172:175], v[20:23], v[124:127]
  s_waitcnt lgkmcnt(4)
  v_mul_f32 v153, v153, v97
  v_mul_f32 v154, v154, v98
  v_mul_f32 v155, v155, v99
  v_mul_f32 v156, v156, v100
  v_mfma_f32_16x16x32_bf16 v[104:107], a[184:187], v[24:27], v[104:107]
  ds_read_b128 v[20:23], v4 offset:21504
  v_mul_f32 v157, v157, v101
  v_mul_f32 v158, v158, v102
  v_mul_f32 v159, v159, v103
  v_mfma_f32_16x16x32_bf16 v[108:111], a[188:191], v[24:27], v[108:111]
  s_waitcnt lgkmcnt(4)
  buffer_load_dwordx4 a[92:95], v1, s[12:15], s27 offen offset:3072 sc1
  v_cvt_pk_bf16_f32 v96, v152, v153
  v_cvt_pk_bf16_f32 v97, v154, v155
  v_mfma_f32_16x16x32_bf16 v[120:123], a[184:187], v[28:31], v[120:123]
  ds_read_b128 v[24:27], v1 offset:55296
  v_cvt_pk_bf16_f32 v98, v156, v157
  v_cvt_pk_bf16_f32 v99, v158, v159
  v_mul_f32 v160, v112, v112
  v_mfma_f32_16x16x32_bf16 v[124:127], a[188:191], v[28:31], v[124:127]
  s_waitcnt lgkmcnt(4)
  buffer_store_dwordx4 v[96:99], v11, s[12:15], s98 offen offset:2048 sc1
  v_mul_f32 v161, v113, v113
  v_mul_f32 v162, v114, v114
  v_mfma_f32_16x16x32_bf16 v[104:107], a[200:203], v[128:131], v[104:107]
  ds_read_b128 v[28:31], v4 offset:22528
  v_mul_f32 v163, v115, v115
  v_mul_f32 v164, v116, v116
  v_mul_f32 v165, v117, v117
  v_mfma_f32_16x16x32_bf16 v[108:111], a[204:207], v[128:131], v[108:111]
  s_waitcnt lgkmcnt(4)
  s_add_u32 s27, s24, 24576
  buffer_load_dwordx4 a[104:107], v1, s[12:15], s27 offen offset:2048 sc1
  v_mul_f32 v166, v118, v118
  v_mul_f32 v167, v119, v119
  v_mfma_f32_16x16x32_bf16 v[120:123], a[200:203], v[132:135], v[120:123]
  ds_read_b128 v[128:131], v1 offset:56320
  v_fma_f32 v160, v160, v61, v60
  v_fma_f32 v161, v161, v61, v60
  v_fma_f32 v162, v162, v61, v60
  v_mfma_f32_16x16x32_bf16 v[124:127], a[204:207], v[132:135], v[124:127]
  s_waitcnt lgkmcnt(4)
  v_fma_f32 v163, v163, v61, v60
  v_fma_f32 v164, v164, v61, v60
  v_fma_f32 v165, v165, v61, v60
  v_fma_f32 v166, v166, v61, v60
  v_mfma_f32_16x16x32_bf16 v[104:107], a[216:219], v[16:19], v[104:107]
  ds_read_b128 v[132:135], v4 offset:23552
  v_fma_f32 v167, v167, v61, v60
  v_mul_f32 v160, v160, v112
  v_mul_f32 v161, v161, v113
  v_mfma_f32_16x16x32_bf16 v[108:111], a[220:223], v[16:19], v[108:111]
  s_waitcnt lgkmcnt(4)
  buffer_load_dwordx4 a[108:111], v1, s[12:15], s27 offen offset:3072 sc1
  v_exp_f32 v160, v160
  v_mfma_f32_16x16x32_bf16 v[120:123], a[216:219], v[20:23], v[120:123]
  ds_read_b128 v[16:19], v1 offset:57344
  v_mul_f32 v162, v162, v114
  v_exp_f32 v161, v161
  v_mfma_f32_16x16x32_bf16 v[124:127], a[220:223], v[20:23], v[124:127]
  s_waitcnt lgkmcnt(4)
  v_exp_f32 v162, v162
  v_mul_f32 v163, v163, v115
  v_mul_f32 v164, v164, v116
  v_mfma_f32_16x16x32_bf16 v[104:107], a[232:235], v[24:27], v[104:107]
  ds_read_b128 v[20:23], v4 offset:24576
  v_mul_f32 v165, v165, v117
  v_exp_f32 v163, v163
  v_mfma_f32_16x16x32_bf16 v[108:111], a[236:239], v[24:27], v[108:111]
  s_waitcnt lgkmcnt(4)
  s_add_u32 s27, s24, 28672
  buffer_load_dwordx4 a[120:123], v1, s[12:15], s27 offen offset:2048 sc1
  v_exp_f32 v164, v164
  v_mfma_f32_16x16x32_bf16 v[120:123], a[232:235], v[28:31], v[120:123]
  ds_read_b128 v[24:27], v1 offset:58368
  v_mul_f32 v166, v166, v118
  v_exp_f32 v165, v165
  v_mfma_f32_16x16x32_bf16 v[124:127], a[236:239], v[28:31], v[124:127]
  s_waitcnt lgkmcnt(4)
  v_exp_f32 v166, v166
  v_mul_f32 v167, v167, v119
  v_fma_f32 v160, v160, v62, v62
  v_mfma_f32_16x16x32_bf16 v[104:107], a[248:251], v[128:131], v[104:107]
  ds_read_b128 v[28:31], v4 offset:25600
  v_exp_f32 v167, v167
  v_fma_f32 v161, v161, v62, v62
  v_mfma_f32_16x16x32_bf16 v[108:111], a[252:255], v[128:131], v[108:111]
  s_waitcnt lgkmcnt(4)
  buffer_load_dwordx4 a[124:127], v1, s[12:15], s27 offen offset:3072 sc1
  v_rcp_f32 v160, v160
  v_mfma_f32_16x16x32_bf16 v[120:123], a[248:251], v[132:135], v[120:123]
  ds_read_b128 v[128:131], v1 offset:59392
  v_fma_f32 v162, v162, v62, v62
  v_rcp_f32 v161, v161
  v_mfma_f32_16x16x32_bf16 v[124:127], a[252:255], v[132:135], v[124:127]
  s_waitcnt lgkmcnt(4)
  v_rcp_f32 v162, v162
  v_fma_f32 v163, v163, v62, v62
  v_fma_f32 v164, v164, v62, v62
  v_mfma_f32_16x16x32_bf16 v[104:107], v[200:203], v[16:19], v[104:107]
  ds_read_b128 v[132:135], v4 offset:26624
  v_fma_f32 v165, v165, v62, v62
  v_rcp_f32 v163, v163
  v_mfma_f32_16x16x32_bf16 v[108:111], v[204:207], v[16:19], v[108:111]
  s_waitcnt lgkmcnt(4)
  s_add_u32 s27, s24, 32768
  buffer_load_dwordx4 a[136:139], v1, s[12:15], s27 offen offset:2048 sc1
  v_rcp_f32 v164, v164
  v_mfma_f32_16x16x32_bf16 v[120:123], v[200:203], v[20:23], v[120:123]
  ds_read_b128 v[16:19], v1 offset:60416
  v_fma_f32 v166, v166, v62, v62
  v_rcp_f32 v165, v165
  v_mfma_f32_16x16x32_bf16 v[124:127], v[204:207], v[20:23], v[124:127]
  s_waitcnt lgkmcnt(4)
  v_rcp_f32 v166, v166
  v_fma_f32 v167, v167, v62, v62
  v_mul_f32 v160, v160, v112
  v_mfma_f32_16x16x32_bf16 v[104:107], v[216:219], v[24:27], v[104:107]
  ds_read_b128 v[20:23], v4 offset:27648
  v_rcp_f32 v167, v167
  v_mul_f32 v161, v161, v113
  v_mfma_f32_16x16x32_bf16 v[108:111], v[220:223], v[24:27], v[108:111]
  s_waitcnt lgkmcnt(4)
  buffer_load_dwordx4 a[140:143], v1, s[12:15], s27 offen offset:3072 sc1
  v_mul_f32 v162, v162, v114
  v_mul_f32 v163, v163, v115
  v_mfma_f32_16x16x32_bf16 v[120:123], v[216:219], v[28:31], v[120:123]
  v_mul_f32 v164, v164, v116
  v_mul_f32 v165, v165, v117
  v_mul_f32 v166, v166, v118
  v_mul_f32 v167, v167, v119
  v_mfma_f32_16x16x32_bf16 v[124:127], v[220:223], v[28:31], v[124:127]
  s_waitcnt lgkmcnt(3)
  v_cvt_pk_bf16_f32 v112, v160, v161
  v_cvt_pk_bf16_f32 v113, v162, v163
  v_cvt_pk_bf16_f32 v114, v164, v165
  v_cvt_pk_bf16_f32 v115, v166, v167
  v_mfma_f32_16x16x32_bf16 v[104:107], v[232:235], v[128:131], v[104:107]
  buffer_store_dwordx4 v[112:115], v11, s[12:15], s98 offen offset:3072 sc1
  v_mfma_f32_16x16x32_bf16 v[108:111], v[236:239], v[128:131], v[108:111]
  s_waitcnt lgkmcnt(2)
  s_add_u32 s27, s24, 36864
  buffer_load_dwordx4 a[144:147], v1, s[12:15], s27 offen offset:0 sc1
  v_mfma_f32_16x16x32_bf16 v[120:123], v[232:235], v[132:135], v[120:123]
  v_mfma_f32_16x16x32_bf16 v[124:127], v[236:239], v[132:135], v[124:127]
  s_waitcnt lgkmcnt(1)
  v_mfma_f32_16x16x32_bf16 v[104:107], v[248:251], v[16:19], v[104:107]
  v_mfma_f32_16x16x32_bf16 v[108:111], v[252:255], v[16:19], v[108:111]
  s_waitcnt lgkmcnt(0)
  buffer_load_dwordx4 a[148:151], v1, s[12:15], s27 offen offset:1024 sc1
  v_mfma_f32_16x16x32_bf16 v[120:123], v[248:251], v[20:23], v[120:123]
  v_mfma_f32_16x16x32_bf16 v[124:127], v[252:255], v[20:23], v[124:127]
  v_mfma_f32_16x16x32_bf16 v[104:107], v[144:147], v[40:43], v[104:107]
  v_mfma_f32_16x16x32_bf16 v[108:111], v[148:151], v[40:43], v[108:111]
  v_mfma_f32_16x16x32_bf16 v[120:123], v[144:147], v[44:47], v[120:123]
  v_mfma_f32_16x16x32_bf16 v[124:127], v[148:151], v[44:47], v[124:127]
  s_cmp_lg_u32 s3, 0
  s_cbranch_scc1 PI4
  s_load_dwordx8 s[28:35], s[54:55], 16384 glc
PI4:
  s_lshl_b32 s6, s3, 11
  v_add_u32 v176, s6, v1
  ds_read_b128 a[168:171], v176 offset:0
  ds_read_b128 a[172:175], v176 offset:1024
  ds_read_b128 a[184:187], v176 offset:6144
  ds_read_b128 a[188:191], v176 offset:7168
  v_pk_mul_f32 v[152:153], v[104:105], v[104:105]
  v_pk_mul_f32 v[154:155], v[106:107], v[106:107]
  v_pk_mul_f32 v[156:157], v[108:109], v[108:109]
  v_pk_mul_f32 v[158:159], v[110:111], v[110:111]
  buffer_load_dwordx4 a[152:155], v1, s[12:15], s27 offen offset:2048 sc1
  v_pk_fma_f32 v[152:153], v[152:153], v[56:57], v[56:57] op_sel:[0,1,0] op_sel_hi:[1,1,0]
  v_pk_fma_f32 v[154:155], v[154:155], v[56:57], v[56:57] op_sel:[0,1,0] op_sel_hi:[1,1,0]
  v_pk_fma_f32 v[156:157], v[156:157], v[56:57], v[56:57] op_sel:[0,1,0] op_sel_hi:[1,1,0]
  v_pk_fma_f32 v[158:159], v[158:159], v[56:57], v[56:57] op_sel:[0,1,0] op_sel_hi:[1,1,0]
  v_pk_mul_f32 v[152:153], v[152:153], v[104:105]
  v_pk_mul_f32 v[154:155], v[154:155], v[106:107]
  v_pk_mul_f32 v[156:157], v[156:157], v[108:109]
  v_pk_mul_f32 v[158:159], v[158:159], v[110:111]
  v_exp_f32 v152, v152
  buffer_load_dwordx4 a[156:159], v1, s[12:15], s27 offen offset:3072 sc1
  v_exp_f32 v153, v153
  v_exp_f32 v154, v154
  v_exp_f32 v155, v155
  v_exp_f32 v156, v156
  s_add_u32 s27, s24, 40960
  buffer_load_dwordx4 a[160:163], v1, s[12:15], s27 offen offset:0 sc1
  v_exp_f32 v157, v157
  v_exp_f32 v158, v158
  v_exp_f32 v159, v159
  v_pk_fma_f32 v[152:153], v[152:153], v[58:59], v[58:59] op_sel_hi:[1,0,0]
  v_pk_fma_f32 v[154:155], v[154:155], v[58:59], v[58:59] op_sel_hi:[1,0,0]
  v_pk_fma_f32 v[156:157], v[156:157], v[58:59], v[58:59] op_sel_hi:[1,0,0]
  buffer_load_dwordx4 a[164:167], v1, s[12:15], s27 offen offset:1024 sc1
  v_pk_fma_f32 v[158:159], v[158:159], v[58:59], v[58:59] op_sel_hi:[1,0,0]
  v_rcp_f32 v152, v152
  v_rcp_f32 v153, v153
  v_rcp_f32 v154, v154
  v_rcp_f32 v155, v155
  s_add_u32 s27, s24, 45056
  buffer_load_dwordx4 a[176:179], v1, s[12:15], s27 offen offset:0 sc1
  v_rcp_f32 v156, v156
  v_rcp_f32 v157, v157
  v_rcp_f32 v158, v158
  v_rcp_f32 v159, v159
  v_pk_mul_f32 v[152:153], v[152:153], v[104:105]
  buffer_load_dwordx4 a[180:183], v1, s[12:15], s27 offen offset:1024 sc1
  v_pk_mul_f32 v[154:155], v[154:155], v[106:107]
  v_pk_mul_f32 v[156:157], v[156:157], v[108:109]
  v_pk_mul_f32 v[158:159], v[158:159], v[110:111]
  v_cvt_pk_bf16_f32 v104, v152, v153
  v_cvt_pk_bf16_f32 v105, v154, v155
  v_cvt_pk_bf16_f32 v106, v156, v157
  v_cvt_pk_bf16_f32 v107, v158, v159
  buffer_store_dwordx4 v[104:107], v11, s[12:15], s99 offen offset:2048 sc1
  s_waitcnt lgkmcnt(0)
  s_mov_b32 s61, 0
  s_cmp_lg_u32 s3, 0
  s_cbranch_scc1 ACQ4_DONE
ACQ4:
  s_xor_b32 s28, s28, s94
  s_xor_b32 s29, s29, s94
  s_xor_b32 s30, s30, s94
  s_xor_b32 s31, s31, s94
  s_xor_b32 s32, s32, s94
  s_xor_b32 s33, s33, s94
  s_xor_b32 s34, s34, s94
  s_xor_b32 s35, s35, s94
  s_or_b64 s[28:29], s[28:29], s[30:31]
  s_or_b64 s[28:29], s[28:29], s[32:33]
  s_or_b64 s[28:29], s[28:29], s[34:35]
  s_cbranch_scc0 ACQ4_DONE
  s_load_dwordx8 s[28:35], s[54:55], 16384 glc
  s_waitcnt lgkmcnt(0)
  s_add_u32 s61, s61, 1
  s_cmp_lt_u32 s61, 262144
  s_cbranch_scc1 ACQ4
ACQ4_DONE:
  s_waitcnt lgkmcnt(0)
  s_branch HELP_END
HELP:
  s_nop 7
  s_waitcnt vmcnt(6)
  s_barrier
  s_lshl_b32 s63, s4, 14
  s_add_u32 s63, s63, 21299200
  s_add_u32 s7, s63, 0
  buffer_load_dwordx4 v[16:19], v1, s[12:15], s7 offen offset:0 sc1
  buffer_load_dwordx4 v[20:23], v1, s[12:15], s7 offen offset:1024 sc1
  buffer_load_dwordx4 v[24:27], v1, s[12:15], s7 offen offset:2048 sc1
  buffer_load_dwordx4 v[28:31], v1, s[12:15], s7 offen offset:3072 sc1
  s_add_u32 s7, s63, 4096
  buffer_load_dwordx4 v[32:35], v1, s[12:15], s7 offen offset:0 sc1
  buffer_load_dwordx4 v[36:39], v1, s[12:15], s7 offen offset:1024 sc1
  buffer_load_dwordx4 v[40:43], v1, s[12:15], s7 offen offset:2048 sc1
  buffer_load_dwordx4 v[44:47], v1, s[12:15], s7 offen offset:3072 sc1
  ds_read_b128 v[48:51], v0 offset:0
  ds_read_b128 v[52:55], v0 offset:64
  ds_read_b128 v[56:59], v0 offset:160
  ds_read_b128 v[60:63], v0 offset:224
  ds_read_b128 v[64:67], v0 offset:320
  ds_read_b128 v[68:71], v0 offset:384
  ds_read_b128 v[72:75], v0 offset:480
  ds_read_b128 v[76:79], v0 offset:544
  ds_read_b128 v[80:83], v0 offset:640
  ds_read_b128 v[84:87], v0 offset:704
  ds_read_b128 v[88:91], v0 offset:800
  ds_read_b128 v[92:95], v0 offset:864
  ds_read_b128 v[96:99], v0 offset:960
  ds_read_b128 v[100:103], v0 offset:1024
  ds_read_b128 v[104:107], v0 offset:1120
  ds_read_b128 v[108:111], v0 offset:1184
  ds_read_b64 v[112:113], v15 offset:128
  ds_read_b64 v[114:115], v15 offset:288
  ds_read_b64 v[116:117], v15 offset:448
  ds_read_b64 v[118:119], v15 offset:608
  ds_read_b64 v[120:121], v15 offset:768
  ds_read_b64 v[122:123], v15 offset:928
  ds_read_b64 v[124:125], v15 offset:1088
  ds_read_b64 v[126:127], v15 offset:1248
  s_mov_b32 s23, 0
  s_waitcnt lgkmcnt(15)
  v_mfma_f32_16x16x32_bf16 v[168:171], v[48:51], v[48:51], 0
  s_mov_b32 m0, 131072
  s_add_u32 s6, s95, 10240
  buffer_load_dwordx4 v1, s[12:15], s6 offen offset:0 sc1 lds
  v_mfma_f32_16x16x32_bf16 v[172:175], v[52:55], v[52:55], 0
  buffer_load_dwordx4 v1, s[12:15], s6 offen offset:1024 sc1 lds
  v_mfma_f32_16x16x32_bf16 v[168:171], v[56:59], v[56:59], v[168:171]
  buffer_load_dwordx4 v1, s[12:15], s6 offen offset:2048 sc1 lds
  v_mfma_f32_16x16x32_bf16 v[172:175], v[60:63], v[60:63], v[172:175]
  buffer_load_dwordx4 v1, s[12:15], s6 offen offset:3072 sc1 lds
  s_mov_b32 m0, 135168
  s_add_u32 s6, s95, 14336
  v_mfma_f32_16x16x32_bf16 v[168:171], v[64:67], v[64:67], v[168:171]
  buffer_load_dwordx4 v1, s[12:15], s6 offen offset:0 sc1 lds
  s_mov_b32 m0, 136192
  s_add_u32 s6, s95, 81920
  v_mfma_f32_16x16x32_bf16 v[172:175], v[68:71], v[68:71], v[172:175]
  buffer_load_dwordx4 v1, s[12:15], s6 offen offset:0 sc1 lds
  v_mfma_f32_16x16x32_bf16 v[168:171], v[72:75], v[72:75], v[168:171]
  v_mfma_f32_16x16x32_bf16 v[172:175], v[76:79], v[76:79], v[172:175]
  v_mfma_f32_16x16x32_bf16 v[168:171], v[80:83], v[80:83], v[168:171]
  s_waitcnt lgkmcnt(14)
  v_mfma_f32_16x16x32_bf16 v[172:175], v[84:87], v[84:87], v[172:175]
  s_waitcnt lgkmcnt(13)
  v_mfma_f32_16x16x32_bf16 v[168:171], v[88:91], v[88:91], v[168:171]
  s_waitcnt lgkmcnt(12)
  v_mfma_f32_16x16x32_bf16 v[172:175], v[92:95], v[92:95], v[172:175]
  s_waitcnt lgkmcnt(11)
  v_mfma_f32_16x16x32_bf16 v[168:171], v[96:99], v[96:99], v[168:171]
  s_waitcnt lgkmcnt(10)
  v_mfma_f32_16x16x32_bf16 v[172:175], v[100:103], v[100:103], v[172:175]
  s_waitcnt lgkmcnt(9)
  v_mfma_f32_16x16x32_bf16 v[168:171], v[104:107], v[104:107], v[168:171]
  s_waitcnt lgkmcnt(8)
  v_mfma_f32_16x16x32_bf16 v[172:175], v[108:111], v[108:111], v[172:175]
  s_waitcnt lgkmcnt(6)
  v_mfma_f32_16x16x32_bf16 v[168:171], v[112:115], v[112:115], v[168:171]
  s_waitcnt lgkmcnt(4)
  v_mfma_f32_16x16x32_bf16 v[172:175], v[116:119], v[116:119], v[172:175]
  s_waitcnt lgkmcnt(2)
  v_mfma_f32_16x16x32_bf16 v[168:171], v[120:123], v[120:123], v[168:171]
  s_waitcnt lgkmcnt(0)
  v_mfma_f32_16x16x32_bf16 v[172:175], v[124:127], v[124:127], v[172:175]
  buffer_load_dwordx4 v1, s[12:15], s6 offen offset:1024 sc1 lds
  s_nop 6
  v_add_f32 v168, v168, v172
  v_mul_f32 v168, s21, v168
  v_add_f32 v169, v169, v173
  v_mul_f32 v169, s21, v169
  v_add_f32 v170, v170, v174
  v_mul_f32 v170, s21, v170
  v_readlane_b32 s56, v168, 0
  v_readlane_b32 s57, v169, 0
  v_readlane_b32 s58, v170, 0
  v_readlane_b32 s59, v169, 1
  v_readlane_b32 s62, v170, 1
  s_waitcnt vmcnt(10)
  v_pk_add_f32 v[16:17], v[16:17], v[32:33]
  s_barrier
  v_pk_add_f32 v[18:19], v[18:19], v[34:35]
  s_waitcnt vmcnt(9)
  v_pk_add_f32 v[20:21], v[20:21], v[36:37]
  v_pk_add_f32 v[22:23], v[22:23], v[38:39]
  s_waitcnt vmcnt(8)
  v_pk_add_f32 v[24:25], v[24:25], v[40:41]
  v_pk_add_f32 v[26:27], v[26:27], v[42:43]
  s_waitcnt vmcnt(7)
  v_pk_add_f32 v[28:29], v[28:29], v[44:45]
  v_pk_add_f32 v[30:31], v[30:31], v[46:47]
  v_pk_add_f32 v[16:17], v[16:17], v[24:25]
  v_pk_add_f32 v[18:19], v[18:19], v[26:27]
  v_pk_add_f32 v[20:21], v[20:21], v[28:29]
  v_pk_add_f32 v[22:23], v[22:23], v[30:31]
  v_pk_add_f32 v[16:17], v[16:17], v[20:21]
  v_pk_add_f32 v[96:97], v[18:19], v[22:23]
  v_mul_f32 v16, s21, v16
  v_mul_f32 v17, s21, v17
  v_mov_b32 v18, v16
  s_nop 1
  v_permlane16_swap_b32 v16, v18
  v_mov_b32 v19, v16
  v_mov_b32 v20, v18
  s_nop 0
  v_permlane32_swap_b32 v16, v19
  v_permlane32_swap_b32 v18, v20
  v_mov_b32 v29, v17
  v_mov_b32 v24, v16
  v_mov_b32 v25, v19
  v_permlane32_swap_b32 v17, v29
  v_mov_b32 v26, v18
  v_mov_b32 v27, v20
  v_mov_b32 v28, v17
  v_fma_f32 v25, -v24, v24, v25
  v_max_f32 v25, 0, v25
  v_add_f32 v25, s22, v25
  v_rsq_f32 v16, v25
  v_fma_f32 v26, -v24, s58, v26
  v_fma_f32 v29, -v24, s57, v29
  v_mul_f32 v17, s56, v24
  v_fma_f32 v17, v27, -2.0, v17
  v_fma_f32 v28, v24, v17, v28
  v_mul_f32 v25, v25, v16
  v_fma_f32 v26, v16, v26, s62
  v_mul_f32 v28, v28, v16
  v_fma_f32 v28, v29, 2.0, v28
  v_fma_f32 v28, v28, v16, s59
  v_fma_f32 v28, -v26, v26, v28
  v_max_f32 v28, 0, v28
  v_add_f32 v28, s22, v28
  v_rsq_f32 v17, v28
  v_sub_f32 v24, 0, v24
  v_mul_f32_e64 v26, -v26, v25
  v_mul_f32 v28, v28, v17
  v_mul_f32 v27, v28, v25
  v_mul_f32 v16, v16, v17
  v_mul_f32 v20, 0xc0135761, v16
  v_mul_f32 v21, v16, v16
  v_mul_f32 v21, v21, v20
  v_mul_f32 v21, 0x3d372713, v21
  v_mov_b32 v22, v27
  v_mov_b32 v23, 0
  v_cvt_pk_bf16_f32 v32, v24, v25
  v_cvt_pk_bf16_f32 v33, v26, v27
  v_lshlrev_b32 v36, 16, v32
  v_and_b32 v37, 0xffff0000, v32
  v_lshlrev_b32 v38, 16, v33
  v_and_b32 v39, 0xffff0000, v33
  v_sub_f32 v36, v24, v36
  v_sub_f32 v37, v25, v37
  v_sub_f32 v38, v26, v38
  v_sub_f32 v39, v27, v39
  v_cvt_pk_bf16_f32 v34, v36, v37
  v_cvt_pk_bf16_f32 v35, v38, v39
  v_cmp_eq_u32 vcc, 1, v3
  s_nop 1
  v_cndmask_b32 v40, 0, v34, vcc
  v_cndmask_b32 v41, 0, v35, vcc
  v_cmp_eq_u32 vcc, 0, v3
  s_nop 1
  v_cndmask_b32 v40, v40, v32, vcc
  v_cndmask_b32 v41, v41, v33, vcc
  v_cndmask_b32 v42, 0, v32, vcc
  v_cndmask_b32 v43, 0, v33, vcc
  ds_write_b128 v4, v[40:43] offset:0
  ds_write_b128 v4, v[20:23] offset:4096
  v_mul_f32 v96, s21, v96
  v_mul_f32 v97, s21, v97
  v_mov_b32 v98, v96
  s_nop 1
  v_permlane16_swap_b32 v96, v98
  v_mov_b32 v99, v96
  v_mov_b32 v100, v98
  s_nop 0
  v_permlane32_swap_b32 v96, v99
  v_permlane32_swap_b32 v98, v100
  v_mov_b32 v109, v97
  v_mov_b32 v104, v96
  v_mov_b32 v105, v99
  v_permlane32_swap_b32 v97, v109
  v_mov_b32 v106, v98
  v_mov_b32 v107, v100
  v_mov_b32 v108, v97
  v_fma_f32 v105, -v104, v104, v105
  v_max_f32 v105, 0, v105
  v_add_f32 v105, s22, v105
  v_rsq_f32 v96, v105
  v_fma_f32 v106, -v104, s58, v106
  v_fma_f32 v109, -v104, s57, v109
  v_mul_f32 v97, s56, v104
  v_fma_f32 v97, v107, -2.0, v97
  v_fma_f32 v108, v104, v97, v108
  s_load_dwordx8 s[28:35], s[54:55], 12288 glc
  v_mul_f32 v105, v105, v96
  v_fma_f32 v106, v96, v106, s62
  v_mul_f32 v108, v108, v96
  v_fma_f32 v108, v109, 2.0, v108
  v_fma_f32 v108, v108, v96, s59
  v_fma_f32 v108, -v106, v106, v108
  v_max_f32 v108, 0, v108
  v_add_f32 v108, s22, v108
  v_rsq_f32 v97, v108
  v_sub_f32 v104, 0, v104
  v_mul_f32_e64 v106, -v106, v105
  v_mul_f32 v108, v108, v97
  v_mul_f32 v107, v108, v105
  v_mul_f32 v96, v96, v97
  v_mul_f32 v100, 0xc0135761, v96
  v_mul_f32 v101, v96, v96
  v_mul_f32 v101, v101, v100
  v_mul_f32 v101, 0x3d372713, v101
  v_mov_b32 v102, v107
  v_mov_b32 v103, 0
  v_cvt_pk_bf16_f32 v112, v104, v105
  v_cvt_pk_bf16_f32 v113, v106, v107
  v_lshlrev_b32 v116, 16, v112
  v_and_b32 v117, 0xffff0000, v112
  v_lshlrev_b32 v118, 16, v113
  v_and_b32 v119, 0xffff0000, v113
  v_sub_f32 v116, v104, v116
  v_sub_f32 v117, v105, v117
  v_sub_f32 v118, v106, v118
  v_sub_f32 v119, v107, v119
  v_cvt_pk_bf16_f32 v114, v116, v117
  v_cvt_pk_bf16_f32 v115, v118, v119
  v_cmp_eq_u32 vcc, 1, v3
  s_nop 1
  v_cndmask_b32 v120, 0, v114, vcc
  v_cndmask_b32 v121, 0, v115, vcc
  v_cmp_eq_u32 vcc, 0, v3
  s_nop 1
  v_cndmask_b32 v120, v120, v112, vcc
  v_cndmask_b32 v121, v121, v113, vcc
  v_cndmask_b32 v122, 0, v112, vcc
  v_cndmask_b32 v123, 0, v113, vcc
  ds_write_b128 v4, v[120:123] offset:1024
  ds_write_b128 v4, v[100:103] offset:5120
  s_waitcnt lgkmcnt(0)
  s_barrier
  s_waitcnt lgkmcnt(0)
  s_mov_b32 s61, 0
ACQ3:
  s_xor_b32 s28, s28, s94
  s_xor_b32 s29, s29, s94
  s_xor_b32 s30, s30, s94
  s_xor_b32 s31, s31, s94
  s_xor_b32 s32, s32, s94
  s_xor_b32 s33, s33, s94
  s_xor_b32 s34, s34, s94
  s_xor_b32 s35, s35, s94
  s_or_b64 s[28:29], s[28:29], s[30:31]
  s_or_b64 s[28:29], s[28:29], s[32:33]
  s_or_b64 s[28:29], s[28:29], s[34:35]
  s_cbranch_scc0 ACQ3_DONE
  s_load_dwordx8 s[28:35], s[54:55], 12288 glc
  s_waitcnt lgkmcnt(0)
  s_add_u32 s61, s61, 1
  s_cmp_lt_u32 s61, 262144
  s_cbranch_scc1 ACQ3
ACQ3_DONE:
  s_add_u32 m0, s23, 40960
  s_add_u32 s101, s23, s25
  s_add_u32 s101, s101, 40960
  buffer_load_dwordx4 v1, s[12:15], s101 offen offset:0 sc1 lds
  buffer_load_dwordx4 v1, s[12:15], s101 offen offset:1024 sc1 lds
  buffer_load_dwordx4 v1, s[12:15], s101 offen offset:2048 sc1 lds
  buffer_load_dwordx4 v1, s[12:15], s101 offen offset:3072 sc1 lds
  s_add_u32 m0, s23, 45056
  s_add_u32 s101, s23, s25
  s_add_u32 s101, s101, 45056
  buffer_load_dwordx4 v1, s[12:15], s101 offen offset:0 sc1 lds
  buffer_load_dwordx4 v1, s[12:15], s101 offen offset:1024 sc1 lds
  buffer_load_dwordx4 v1, s[12:15], s101 offen offset:2048 sc1 lds
  buffer_load_dwordx4 v1, s[12:15], s101 offen offset:3072 sc1 lds
  s_add_u32 m0, s23, 49152
  s_add_u32 s101, s23, s25
  s_add_u32 s101, s101, 49152
  buffer_load_dwordx4 v1, s[12:15], s101 offen offset:0 sc1 lds
  buffer_load_dwordx4 v1, s[12:15], s101 offen offset:1024 sc1 lds
  s_add_u32 m0, s23, 110592
  s_add_u32 s101, s23, s25
  s_add_u32 s101, s101, 61440
  buffer_load_dwordx4 v1, s[12:15], s101 offen offset:0 sc1 lds
  buffer_load_dwordx4 v1, s[12:15], s101 offen offset:1024 sc1 lds
  buffer_load_dwordx4 v1, s[12:15], s101 offen offset:2048 sc1 lds
  buffer_load_dwordx4 v1, s[12:15], s101 offen offset:3072 sc1 lds
  s_add_u32 m0, s23, 114688
  s_add_u32 s101, s23, s25
  s_add_u32 s101, s101, 65536
  buffer_load_dwordx4 v1, s[12:15], s101 offen offset:0 sc1 lds
  buffer_load_dwordx4 v1, s[12:15], s101 offen offset:1024 sc1 lds
  buffer_load_dwordx4 v1, s[12:15], s101 offen offset:2048 sc1 lds
  buffer_load_dwordx4 v1, s[12:15], s101 offen offset:3072 sc1 lds
  s_add_u32 m0, s23, 118784
  s_add_u32 s101, s23, s25
  s_add_u32 s101, s101, 69632
  buffer_load_dwordx4 v1, s[12:15], s101 offen offset:0 sc1 lds
  buffer_load_dwordx4 v1, s[12:15], s101 offen offset:1024 sc1 lds
  s_add_u32 m0, s23, 51200
  s_add_u32 s101, s23, s25
  s_add_u32 s101, s101, 51200
  buffer_load_dwordx4 v1, s[12:15], s101 offen offset:0 sc1 lds
  buffer_load_dwordx4 v1, s[12:15], s101 offen offset:1024 sc1 lds
  buffer_load_dwordx4 v1, s[12:15], s101 offen offset:2048 sc1 lds
  buffer_load_dwordx4 v1, s[12:15], s101 offen offset:3072 sc1 lds
  s_add_u32 m0, s23, 55296
  s_add_u32 s101, s23, s25
  s_add_u32 s101, s101, 55296
  ds_read_b128 v[16:19], v1 offset:0
  ds_read_b128 v[20:23], v1 offset:1024
  ds_read_b128 v[24:27], v1 offset:2048
  ds_read_b128 v[28:31], v1 offset:3072
  ds_read_b128 v[128:131], v1 offset:4096
  ds_read_b128 v[32:35], v4 offset:0
  ds_read_b128 v[48:51], v4 offset:4096
  s_waitcnt lgkmcnt(6)
  v_mfma_f32_16x16x32_bf16 v[64:67], a[0:3], v[16:19], 0
  ds_read_b128 v[132:135], v1 offset:5120
  v_mfma_f32_16x16x32_bf16 v[68:71], a[4:7], v[16:19], 0
  s_waitcnt lgkmcnt(6)
  buffer_load_dwordx4 v1, s[12:15], s101 offen offset:0 sc1 lds
  v_mfma_f32_16x16x32_bf16 v[64:67], a[16:19], v[20:23], v[64:67]
  ds_read_b128 v[16:19], v1 offset:6144
  v_mfma_f32_16x16x32_bf16 v[68:71], a[20:23], v[20:23], v[68:71]
  s_waitcnt lgkmcnt(6)
  buffer_load_dwordx4 v1, s[12:15], s101 offen offset:1024 sc1 lds
  v_mfma_f32_16x16x32_bf16 v[64:67], a[32:35], v[24:27], v[64:67]
  ds_read_b128 v[20:23], v1 offset:7168
  v_mfma_f32_16x16x32_bf16 v[68:71], a[36:39], v[24:27], v[68:71]
  s_waitcnt lgkmcnt(6)
  buffer_load_dwordx4 v1, s[12:15], s101 offen offset:2048 sc1 lds
  v_mfma_f32_16x16x32_bf16 v[64:67], a[48:51], v[28:31], v[64:67]
  ds_read_b128 v[24:27], v1 offset:8192
  v_mfma_f32_16x16x32_bf16 v[68:71], a[52:55], v[28:31], v[68:71]
  s_waitcnt lgkmcnt(6)
  buffer_load_dwordx4 v1, s[12:15], s101 offen offset:3072 sc1 lds
  v_mfma_f32_16x16x32_bf16 v[64:67], a[64:67], v[128:131], v[64:67]
  s_add_u32 m0, s23, 59392
  ds_read_b128 v[28:31], v1 offset:9216
  s_add_u32 s101, s23, s25
  v_mfma_f32_16x16x32_bf16 v[68:71], a[68:71], v[128:131], v[68:71]
  s_waitcnt lgkmcnt(4)
  s_add_u32 s101, s101, 59392
  buffer_load_dwordx4 v1, s[12:15], s101 offen offset:0 sc1 lds
  s_load_dwordx8 s[28:35], s[54:55], 28704 glc
  v_mfma_f32_16x16x32_bf16 v[64:67], a[80:83], v[132:135], v[64:67]
  ds_read_b128 v[128:131], v1 offset:10240
  v_mfma_f32_16x16x32_bf16 v[68:71], a[84:87], v[132:135], v[68:71]
  s_waitcnt lgkmcnt(4)
  buffer_load_dwordx4 v1, s[12:15], s101 offen offset:1024 sc1 lds
  v_mfma_f32_16x16x32_bf16 v[64:67], a[96:99], v[16:19], v[64:67]
  s_add_u32 m0, s23, 120832
  ds_read_b128 v[132:135], v1 offset:11264
  s_add_u32 s101, s23, s25
  v_mfma_f32_16x16x32_bf16 v[68:71], a[100:103], v[16:19], v[68:71]
  s_waitcnt lgkmcnt(4)
  s_add_u32 s101, s101, 71680
  buffer_load_dwordx4 v1, s[12:15], s101 offen offset:0 sc1 lds
  v_mfma_f32_16x16x32_bf16 v[64:67], a[112:115], v[20:23], v[64:67]
  ds_read_b128 v[16:19], v1 offset:12288
  v_mfma_f32_16x16x32_bf16 v[68:71], a[116:119], v[20:23], v[68:71]
  s_waitcnt lgkmcnt(4)
  buffer_load_dwordx4 v1, s[12:15], s101 offen offset:1024 sc1 lds
  v_mfma_f32_16x16x32_bf16 v[64:67], a[128:131], v[24:27], v[64:67]
  ds_read_b128 v[20:23], v1 offset:13312
  v_mfma_f32_16x16x32_bf16 v[68:71], a[132:135], v[24:27], v[68:71]
  s_waitcnt lgkmcnt(4)
  buffer_load_dwordx4 v1, s[12:15], s101 offen offset:2048 sc1 lds
  v_mfma_f32_16x16x32_bf16 v[64:67], a[144:147], v[28:31], v[64:67]
  ds_read_b128 v[24:27], v1 offset:14336
  v_mfma_f32_16x16x32_bf16 v[68:71], a[148:151], v[28:31], v[68:71]
  s_waitcnt lgkmcnt(4)
  buffer_load_dwordx4 v1, s[12:15], s101 offen offset:3072 sc1 lds
  v_mfma_f32_16x16x32_bf16 v[64:67], a[160:163], v[128:131], v[64:67]
  s_add_u32 m0, s23, 124928
  ds_read_b128 v[28:31], v1 offset:15360
  s_add_u32 s101, s23, s25
  v_mfma_f32_16x16x32_bf16 v[68:71], a[164:167], v[128:131], v[68:71]
  s_waitcnt lgkmcnt(4)
  s_add_u32 s101, s101, 75776
  buffer_load_dwordx4 v1, s[12:15], s101 offen offset:0 sc1 lds
  v_mfma_f32_16x16x32_bf16 v[64:67], a[176:179], v[132:135], v[64:67]
  ds_read_b128 v[128:131], v1 offset:16384
  v_mfma_f32_16x16x32_bf16 v[68:71], a[180:183], v[132:135], v[68:71]
  s_waitcnt lgkmcnt(4)
  buffer_load_dwordx4 v1, s[12:15], s101 offen offset:1024 sc1 lds
  v_mfma_f32_16x16x32_bf16 v[64:67], a[192:195], v[16:19], v[64:67]
  ds_read_b128 v[132:135], v1 offset:17408
  v_mfma_f32_16x16x32_bf16 v[68:71], a[196:199], v[16:19], v[68:71]
  s_waitcnt lgkmcnt(4)
  buffer_load_dwordx4 v1, s[12:15], s101 offen offset:2048 sc1 lds
  v_mfma_f32_16x16x32_bf16 v[64:67], a[208:211], v[20:23], v[64:67]
  ds_read_b128 v[16:19], v1 offset:18432
  v_mfma_f32_16x16x32_bf16 v[68:71], a[212:215], v[20:23], v[68:71]
  s_waitcnt lgkmcnt(4)
  buffer_load_dwordx4 v1, s[12:15], s101 offen offset:3072 sc1 lds
  v_mfma_f32_16x16x32_bf16 v[64:67], a[224:227], v[24:27], v[64:67]
  s_add_u32 m0, s23, 129024
  ds_read_b128 v[20:23], v1 offset:19456
  s_add_u32 s101, s23, s25
  v_mfma_f32_16x16x32_bf16 v[68:71], a[228:231], v[24:27], v[68:71]
  s_waitcnt lgkmcnt(4)
  s_add_u32 s101, s101, 79872
  buffer_load_dwordx4 v1, s[12:15], s101 offen offset:0 sc1 lds
  v_mfma_f32_16x16x32_bf16 v[64:67], a[240:243], v[28:31], v[64:67]
  v_mfma_f32_16x16x32_bf16 v[68:71], a[244:247], v[28:31], v[68:71]
  s_waitcnt lgkmcnt(3)
  buffer_load_dwordx4 v1, s[12:15], s101 offen offset:1024 sc1 lds
  v_mfma_f32_16x16x32_bf16 v[64:67], v[192:195], v[128:131], v[64:67]
  s_mov_b32 m0, 136192
  v_mfma_f32_16x16x32_bf16 v[68:71], v[196:199], v[128:131], v[68:71]
  s_waitcnt lgkmcnt(2)
  buffer_load_dwordx4 v1, s[12:15], s6 offen offset:2048 sc1 lds
  v_mfma_f32_16x16x32_bf16 v[64:67], v[208:211], v[132:135], v[64:67]
  v_mfma_f32_16x16x32_bf16 v[68:71], v[212:215], v[132:135], v[68:71]
  s_waitcnt lgkmcnt(1)
  buffer_load_dwordx4 v1, s[12:15], s6 offen offset:3072 sc1 lds
  v_mfma_f32_16x16x32_bf16 v[64:67], v[224:227], v[16:19], v[64:67]
  s_mov_b32 m0, 140288
  s_add_u32 s6, s95, 86016
  v_mfma_f32_16x16x32_bf16 v[68:71], v[228:231], v[16:19], v[68:71]
  s_waitcnt lgkmcnt(0)
  buffer_load_dwordx4 v1, s[12:15], s6 offen offset:0 sc1 lds
  v_mfma_f32_16x16x32_bf16 v[64:67], v[240:243], v[20:23], v[64:67]
  s_mov_b32 m0, 141312
  s_add_u32 s6, s95, 153600
  v_mfma_f32_16x16x32_bf16 v[68:71], v[244:247], v[20:23], v[68:71]
  buffer_load_dwordx4 v1, s[12:15], s6 offen offset:0 sc1 lds
  v_mfma_f32_16x16x32_bf16 v[64:67], v[136:139], v[32:35], v[64:67]
  v_mfma_f32_16x16x32_bf16 v[68:71], v[140:143], v[32:35], v[68:71]
  s_waitcnt lgkmcnt(0)
  s_mov_b32 s61, 0
ACQ8:
  s_xor_b32 s28, s28, s94
  s_xor_b32 s29, s29, s94
  s_xor_b32 s30, s30, s94
  s_xor_b32 s31, s31, s94
  s_xor_b32 s32, s32, s94
  s_xor_b32 s33, s33, s94
  s_xor_b32 s34, s34, s94
  s_xor_b32 s35, s35, s94
  s_or_b64 s[28:29], s[28:29], s[30:31]
  s_or_b64 s[28:29], s[28:29], s[32:33]
  s_or_b64 s[28:29], s[28:29], s[34:35]
  s_cbranch_scc0 ACQ8_DONE
  s_load_dwordx8 s[28:35], s[54:55], 28704 glc
  s_waitcnt lgkmcnt(0)
  s_add_u32 s61, s61, 1
  s_cmp_lt_u32 s61, 262144
  s_cbranch_scc1 ACQ8
ACQ8_DONE:
  v_pk_mul_f32 v[152:153], v[64:65], v[64:65]
  v_pk_mul_f32 v[154:155], v[66:67], v[66:67]
  v_pk_mul_f32 v[156:157], v[68:69], v[68:69]
  v_pk_mul_f32 v[158:159], v[70:71], v[70:71]
  v_pk_fma_f32 v[152:153], v[152:153], v[48:49], v[48:49] op_sel:[0,1,0] op_sel_hi:[1,1,0]
  v_pk_fma_f32 v[154:155], v[154:155], v[48:49], v[48:49] op_sel:[0,1,0] op_sel_hi:[1,1,0]
  v_pk_fma_f32 v[156:157], v[156:157], v[48:49], v[48:49] op_sel:[0,1,0] op_sel_hi:[1,1,0]
  v_pk_fma_f32 v[158:159], v[158:159], v[48:49], v[48:49] op_sel:[0,1,0] op_sel_hi:[1,1,0]
  v_pk_mul_f32 v[152:153], v[152:153], v[64:65]
  v_pk_mul_f32 v[154:155], v[154:155], v[66:67]
  v_pk_mul_f32 v[156:157], v[156:157], v[68:69]
  v_pk_mul_f32 v[158:159], v[158:159], v[70:71]
  buffer_load_dwordx4 v1, s[12:15], s6 offen offset:1024 sc1 lds
  v_exp_f32 v152, v152
  v_exp_f32 v153, v153
  v_exp_f32 v154, v154
  v_exp_f32 v155, v155
  v_exp_f32 v156, v156
  v_exp_f32 v157, v157
  buffer_load_dwordx4 v1, s[12:15], s6 offen offset:2048 sc1 lds
  v_exp_f32 v158, v158
  v_exp_f32 v159, v159
  v_pk_fma_f32 v[152:153], v[152:153], v[50:51], v[50:51] op_sel_hi:[1,0,0]
  v_pk_fma_f32 v[154:155], v[154:155], v[50:51], v[50:51] op_sel_hi:[1,0,0]
  v_pk_fma_f32 v[156:157], v[156:157], v[50:51], v[50:51] op_sel_hi:[1,0,0]
  v_pk_fma_f32 v[158:159], v[158:159], v[50:51], v[50:51] op_sel_hi:[1,0,0]
  v_rcp_f32 v152, v152
  buffer_load_dwordx4 v1, s[12:15], s6 offen offset:3072 sc1 lds
  s_mov_b32 m0, 145408
  s_add_u32 s6, s95, 157696
  v_rcp_f32 v153, v153
  v_rcp_f32 v154, v154
  v_rcp_f32 v155, v155
  v_rcp_f32 v156, v156
  v_rcp_f32 v157, v157
  v_rcp_f32 v158, v158
  buffer_load_dwordx4 v1, s[12:15], s6 offen offset:0 sc1 lds
  s_mov_b32 m0, 146432
  s_add_u32 s6, s95, 220160
  v_rcp_f32 v159, v159
  v_pk_mul_f32 v[152:153], v[152:153], v[64:65]
  v_pk_mul_f32 v[154:155], v[154:155], v[66:67]
  v_pk_mul_f32 v[156:157], v[156:157], v[68:69]
  v_pk_mul_f32 v[158:159], v[158:159], v[70:71]
  v_cvt_pk_bf16_f32 v64, v152, v153
  v_cvt_pk_bf16_f32 v65, v154, v155
  v_cvt_pk_bf16_f32 v66, v156, v157
  v_cvt_pk_bf16_f32 v67, v158, v159
  buffer_store_dwordx4 v[64:67], v11, s[12:15], s98 offen offset:0 sc1
  buffer_load_dwordx4 v1, s[12:15], s6 offen offset:0 sc1 lds
  buffer_load_dwordx4 v1, s[12:15], s6 offen offset:1024 sc1 lds
  buffer_load_dwordx4 v1, s[12:15], s6 offen offset:2048 sc1 lds
  buffer_load_dwordx4 v1, s[12:15], s6 offen offset:3072 sc1 lds
  s_mov_b32 m0, 150528
  s_add_u32 s6, s95, 224256
  buffer_load_dwordx4 v1, s[12:15], s6 offen offset:0 sc1 lds
  s_add_u32 s7, s63, 8192
  buffer_load_dwordx4 v[96:99], v1, s[12:15], s7 offen offset:0 sc1
  buffer_load_dwordx4 v[100:103], v1, s[12:15], s7 offen offset:1024 sc1
  buffer_load_dwordx4 v[104:107], v1, s[12:15], s7 offen offset:2048 sc1
  buffer_load_dwordx4 v[108:111], v1, s[12:15], s7 offen offset:3072 sc1
  s_add_u32 s7, s63, 12288
  buffer_load_dwordx4 v[112:115], v1, s[12:15], s7 offen offset:0 sc1
  buffer_load_dwordx4 v[116:119], v1, s[12:15], s7 offen offset:1024 sc1
  buffer_load_dwordx4 v[120:123], v1, s[12:15], s7 offen offset:2048 sc1
  buffer_load_dwordx4 v[124:127], v1, s[12:15], s7 offen offset:3072 sc1
  s_add_u32 s27, s24, 20480
  buffer_load_dwordx4 a[92:95], v1, s[12:15], s27 offen offset:3072 sc1
  s_add_u32 s27, s24, 24576
  buffer_load_dwordx4 a[104:107], v1, s[12:15], s27 offen offset:2048 sc1
  s_waitcnt vmcnt(24)
  s_barrier
  ds_read_b128 v[16:19], v1 offset:20480
  ds_read_b128 v[20:23], v1 offset:21504
  ds_read_b128 v[24:27], v1 offset:22528
  ds_read_b128 v[28:31], v1 offset:23552
  ds_read_b128 v[128:131], v1 offset:24576
  ds_read_b128 v[36:39], v4 offset:1024
  ds_read_b128 v[52:55], v4 offset:5120
  s_waitcnt lgkmcnt(6)
  v_mfma_f32_16x16x32_bf16 v[80:83], a[0:3], v[16:19], 0
  ds_read_b128 v[132:135], v1 offset:25600
  v_mfma_f32_16x16x32_bf16 v[84:87], a[4:7], v[16:19], 0
  s_waitcnt lgkmcnt(6)
  buffer_load_dwordx4 a[108:111], v1, s[12:15], s27 offen offset:3072 sc1
  v_mfma_f32_16x16x32_bf16 v[80:83], a[16:19], v[20:23], v[80:83]
  s_add_u32 s27, s24, 28672
  ds_read_b128 v[16:19], v1 offset:26624
  v_mfma_f32_16x16x32_bf16 v[84:87], a[20:23], v[20:23], v[84:87]
  s_waitcnt lgkmcnt(6)
  buffer_load_dwordx4 a[120:123], v1, s[12:15], s27 offen offset:2048 sc1
  v_mfma_f32_16x16x32_bf16 v[80:83], a[32:35], v[24:27], v[80:83]
  ds_read_b128 v[20:23], v1 offset:27648
  v_mfma_f32_16x16x32_bf16 v[84:87], a[36:39], v[24:27], v[84:87]
  s_waitcnt lgkmcnt(6)
  buffer_load_dwordx4 a[124:127], v1, s[12:15], s27 offen offset:3072 sc1
  v_mfma_f32_16x16x32_bf16 v[80:83], a[48:51], v[28:31], v[80:83]
  s_add_u32 s27, s24, 32768
  ds_read_b128 v[24:27], v1 offset:28672
  v_mfma_f32_16x16x32_bf16 v[84:87], a[52:55], v[28:31], v[84:87]
  s_waitcnt lgkmcnt(6)
  buffer_load_dwordx4 a[136:139], v1, s[12:15], s27 offen offset:2048 sc1
  v_mfma_f32_16x16x32_bf16 v[80:83], a[64:67], v[128:131], v[80:83]
  ds_read_b128 v[28:31], v1 offset:29696
  v_mfma_f32_16x16x32_bf16 v[84:87], a[68:71], v[128:131], v[84:87]
  s_waitcnt lgkmcnt(4)
  buffer_load_dwordx4 a[140:143], v1, s[12:15], s27 offen offset:3072 sc1
  v_mfma_f32_16x16x32_bf16 v[80:83], a[80:83], v[132:135], v[80:83]
  s_add_u32 s27, s24, 36864
  ds_read_b128 v[128:131], v1 offset:30720
  v_mfma_f32_16x16x32_bf16 v[84:87], a[84:87], v[132:135], v[84:87]
  s_waitcnt lgkmcnt(4)
  buffer_load_dwordx4 a[152:155], v1, s[12:15], s27 offen offset:2048 sc1
  v_mfma_f32_16x16x32_bf16 v[80:83], a[96:99], v[16:19], v[80:83]
  ds_read_b128 v[132:135], v1 offset:31744
  v_mfma_f32_16x16x32_bf16 v[84:87], a[100:103], v[16:19], v[84:87]
  s_waitcnt lgkmcnt(4)
  buffer_load_dwordx4 a[156:159], v1, s[12:15], s27 offen offset:3072 sc1
  v_mfma_f32_16x16x32_bf16 v[80:83], a[112:115], v[20:23], v[80:83]
  s_add_u32 s27, s24, 40960
  ds_read_b128 v[16:19], v1 offset:32768
  v_mfma_f32_16x16x32_bf16 v[84:87], a[116:119], v[20:23], v[84:87]
  s_waitcnt lgkmcnt(4)
  buffer_load_dwordx4 a[168:171], v1, s[12:15], s27 offen offset:2048 sc1
  v_mfma_f32_16x16x32_bf16 v[80:83], a[128:131], v[24:27], v[80:83]
  ds_read_b128 v[20:23], v1 offset:33792
  v_mfma_f32_16x16x32_bf16 v[84:87], a[132:135], v[24:27], v[84:87]
  s_waitcnt lgkmcnt(4)
  buffer_load_dwordx4 a[172:175], v1, s[12:15], s27 offen offset:3072 sc1
  v_mfma_f32_16x16x32_bf16 v[80:83], a[144:147], v[28:31], v[80:83]
  s_add_u32 s27, s24, 45056
  ds_read_b128 v[24:27], v1 offset:34816
  v_mfma_f32_16x16x32_bf16 v[84:87], a[148:151], v[28:31], v[84:87]
  s_waitcnt lgkmcnt(4)
  buffer_load_dwordx4 a[184:187], v1, s[12:15], s27 offen offset:2048 sc1
  v_mfma_f32_16x16x32_bf16 v[80:83], a[160:163], v[128:131], v[80:83]
  ds_read_b128 v[28:31], v1 offset:35840
  v_mfma_f32_16x16x32_bf16 v[84:87], a[164:167], v[128:131], v[84:87]
  s_waitcnt lgkmcnt(4)
  buffer_load_dwordx4 a[188:191], v1, s[12:15], s27 offen offset:3072 sc1
  v_mfma_f32_16x16x32_bf16 v[80:83], a[176:179], v[132:135], v[80:83]
  s_mov_b32 m0, 0
  ds_read_b128 v[128:131], v1 offset:36864
  s_add_u32 s6, s95, 58368
  v_mfma_f32_16x16x32_bf16 v[84:87], a[180:183], v[132:135], v[84:87]
  s_waitcnt lgkmcnt(4)
  buffer_load_dwordx4 v1, s[12:15], s6 offen offset:0 sc1 lds
  v_mfma_f32_16x16x32_bf16 v[80:83], a[192:195], v[16:19], v[80:83]
  ds_read_b128 v[132:135], v1 offset:37888
  v_mfma_f32_16x16x32_bf16 v[84:87], a[196:199], v[16:19], v[84:87]
  s_waitcnt lgkmcnt(4)
  buffer_load_dwordx4 v1, s[12:15], s6 offen offset:1024 sc1 lds
  v_mfma_f32_16x16x32_bf16 v[80:83], a[208:211], v[20:23], v[80:83]
  s_mov_b32 m0, 2048
  ds_read_b128 v[16:19], v1 offset:38912
  s_add_u32 s6, s95, 130048
  v_mfma_f32_16x16x32_bf16 v[84:87], a[212:215], v[20:23], v[84:87]
  s_waitcnt lgkmcnt(4)
  buffer_load_dwordx4 v1, s[12:15], s6 offen offset:0 sc1 lds
  v_mfma_f32_16x16x32_bf16 v[80:83], a[224:227], v[24:27], v[80:83]
  ds_read_b128 v[20:23], v1 offset:39936
  v_mfma_f32_16x16x32_bf16 v[84:87], a[228:231], v[24:27], v[84:87]
  s_waitcnt lgkmcnt(4)
  buffer_load_dwordx4 v1, s[12:15], s6 offen offset:1024 sc1 lds
  v_mfma_f32_16x16x32_bf16 v[80:83], a[240:243], v[28:31], v[80:83]
  s_mov_b32 m0, 4096
  s_add_u32 s6, s95, 201728
  v_mfma_f32_16x16x32_bf16 v[84:87], a[244:247], v[28:31], v[84:87]
  s_waitcnt lgkmcnt(3)
  buffer_load_dwordx4 v1, s[12:15], s6 offen offset:0 sc1 lds
  v_mfma_f32_16x16x32_bf16 v[80:83], v[192:195], v[128:131], v[80:83]
  v_mfma_f32_16x16x32_bf16 v[84:87], v[196:199], v[128:131], v[84:87]
  s_waitcnt lgkmcnt(2)
  buffer_load_dwordx4 v1, s[12:15], s6 offen offset:1024 sc1 lds
  v_mfma_f32_16x16x32_bf16 v[80:83], v[208:211], v[132:135], v[80:83]
  s_mov_b32 m0, 6144
  s_add_u32 s6, s95, 62464
  v_mfma_f32_16x16x32_bf16 v[84:87], v[212:215], v[132:135], v[84:87]
  s_waitcnt lgkmcnt(1)
  buffer_load_dwordx4 v1, s[12:15], s6 offen offset:0 sc1 lds
  v_mfma_f32_16x16x32_bf16 v[80:83], v[224:227], v[16:19], v[80:83]
  v_mfma_f32_16x16x32_bf16 v[84:87], v[228:231], v[16:19], v[84:87]
  s_waitcnt lgkmcnt(0)
  buffer_load_dwordx4 v1, s[12:15], s6 offen offset:1024 sc1 lds
  v_mfma_f32_16x16x32_bf16 v[80:83], v[240:243], v[20:23], v[80:83]
  s_mov_b32 m0, 8192
  s_add_u32 s6, s95, 134144
  v_mfma_f32_16x16x32_bf16 v[84:87], v[244:247], v[20:23], v[84:87]
  buffer_load_dwordx4 v1, s[12:15], s6 offen offset:0 sc1 lds
  v_mfma_f32_16x16x32_bf16 v[80:83], v[136:139], v[36:39], v[80:83]
  v_mfma_f32_16x16x32_bf16 v[84:87], v[140:143], v[36:39], v[84:87]
  s_nop 6
  v_pk_mul_f32 v[160:161], v[80:81], v[80:81]
  v_pk_mul_f32 v[162:163], v[82:83], v[82:83]
  v_pk_mul_f32 v[164:165], v[84:85], v[84:85]
  v_pk_mul_f32 v[166:167], v[86:87], v[86:87]
  v_pk_fma_f32 v[160:161], v[160:161], v[52:53], v[52:53] op_sel:[0,1,0] op_sel_hi:[1,1,0]
  v_pk_fma_f32 v[162:163], v[162:163], v[52:53], v[52:53] op_sel:[0,1,0] op_sel_hi:[1,1,0]
  v_pk_fma_f32 v[164:165], v[164:165], v[52:53], v[52:53] op_sel:[0,1,0] op_sel_hi:[1,1,0]
  v_pk_fma_f32 v[166:167], v[166:167], v[52:53], v[52:53] op_sel:[0,1,0] op_sel_hi:[1,1,0]
  v_pk_mul_f32 v[160:161], v[160:161], v[80:81]
  v_pk_mul_f32 v[162:163], v[162:163], v[82:83]
  v_pk_mul_f32 v[164:165], v[164:165], v[84:85]
  v_pk_mul_f32 v[166:167], v[166:167], v[86:87]
  v_exp_f32 v160, v160
  v_exp_f32 v161, v161
  v_exp_f32 v162, v162
  v_exp_f32 v163, v163
  v_exp_f32 v164, v164
  v_exp_f32 v165, v165
  buffer_load_dwordx4 v1, s[12:15], s6 offen offset:1024 sc1 lds
  s_mov_b32 m0, 10240
  s_add_u32 s6, s95, 205824
  v_exp_f32 v166, v166
  v_exp_f32 v167, v167
  v_pk_fma_f32 v[160:161], v[160:161], v[54:55], v[54:55] op_sel_hi:[1,0,0]
  v_pk_fma_f32 v[162:163], v[162:163], v[54:55], v[54:55] op_sel_hi:[1,0,0]
  v_pk_fma_f32 v[164:165], v[164:165], v[54:55], v[54:55] op_sel_hi:[1,0,0]
  v_pk_fma_f32 v[166:167], v[166:167], v[54:55], v[54:55] op_sel_hi:[1,0,0]
  v_rcp_f32 v160, v160
  v_rcp_f32 v161, v161
  v_rcp_f32 v162, v162
  v_rcp_f32 v163, v163
  v_rcp_f32 v164, v164
  v_rcp_f32 v165, v165
  v_rcp_f32 v166, v166
  buffer_load_dwordx4 v1, s[12:15], s6 offen offset:0 sc1 lds
  v_rcp_f32 v167, v167
  v_pk_mul_f32 v[160:161], v[160:161], v[80:81]
  v_pk_mul_f32 v[162:163], v[162:163], v[82:83]
  v_pk_mul_f32 v[164:165], v[164:165], v[84:85]
  v_pk_mul_f32 v[166:167], v[166:167], v[86:87]
  v_cvt_pk_bf16_f32 v80, v160, v161
  v_cvt_pk_bf16_f32 v81, v162, v163
  v_cvt_pk_bf16_f32 v82, v164, v165
  v_cvt_pk_bf16_f32 v83, v166, v167
  buffer_store_dwordx4 v[80:83], v11, s[12:15], s98 offen offset:1024 sc1
  s_waitcnt vmcnt(28)
  v_pk_add_f32 v[96:97], v[96:97], v[112:113]
  v_pk_add_f32 v[98:99], v[98:99], v[114:115]
  s_waitcnt vmcnt(27)
  v_pk_add_f32 v[100:101], v[100:101], v[116:117]
  v_pk_add_f32 v[102:103], v[102:103], v[118:119]
  s_waitcnt vmcnt(26)
  v_pk_add_f32 v[104:105], v[104:105], v[120:121]
  v_pk_add_f32 v[106:107], v[106:107], v[122:123]
  s_waitcnt vmcnt(25)
  v_pk_add_f32 v[108:109], v[108:109], v[124:125]
  v_pk_add_f32 v[110:111], v[110:111], v[126:127]
  v_pk_add_f32 v[96:97], v[96:97], v[104:105]
  v_pk_add_f32 v[98:99], v[98:99], v[106:107]
  v_pk_add_f32 v[100:101], v[100:101], v[108:109]
  v_pk_add_f32 v[102:103], v[102:103], v[110:111]
  v_pk_add_f32 v[96:97], v[96:97], v[100:101]
  v_pk_add_f32 v[152:153], v[98:99], v[102:103]
  v_mul_f32 v96, s21, v96
  v_mul_f32 v97, s21, v97
  v_mov_b32 v98, v96
  s_nop 1
  v_permlane16_swap_b32 v96, v98
  v_mov_b32 v99, v96
  v_mov_b32 v100, v98
  s_nop 0
  v_permlane32_swap_b32 v96, v99
  buffer_load_dwordx4 v1, s[12:15], s6 offen offset:1024 sc1 lds
  v_permlane32_swap_b32 v98, v100
  v_mov_b32 v109, v97
  v_mov_b32 v104, v96
  v_mov_b32 v105, v99
  v_permlane32_swap_b32 v97, v109
  v_mov_b32 v106, v98
  v_mov_b32 v107, v100
  v_mov_b32 v108, v97
  v_fma_f32 v105, -v104, v104, v105
  v_max_f32 v105, 0, v105
  v_add_f32 v105, s22, v105
  v_rsq_f32 v96, v105
  v_fma_f32 v106, -v104, s58, v106
  v_fma_f32 v109, -v104, s57, v109
  v_mul_f32 v97, s56, v104
  v_fma_f32 v97, v107, -2.0, v97
  v_fma_f32 v108, v104, v97, v108
  v_mul_f32 v105, v105, v96
  v_fma_f32 v106, v96, v106, s62
  v_mul_f32 v108, v108, v96
  v_fma_f32 v108, v109, 2.0, v108
  v_fma_f32 v108, v108, v96, s59
  v_fma_f32 v108, -v106, v106, v108
  v_max_f32 v108, 0, v108
  v_add_f32 v108, s22, v108
  v_rsq_f32 v97, v108
  v_sub_f32 v104, 0, v104
  v_mul_f32_e64 v106, -v106, v105
  v_mul_f32 v108, v108, v97
  v_mul_f32 v107, v108, v105
  v_mul_f32 v96, v96, v97
  v_mul_f32 v100, 0xc0135761, v96
  v_mul_f32 v101, v96, v96
  v_mul_f32 v101, v101, v100
  v_mul_f32 v101, 0x3d372713, v101
  v_mov_b32 v102, v107
  v_mov_b32 v103, 0
  v_cvt_pk_bf16_f32 v112, v104, v105
  v_cvt_pk_bf16_f32 v113, v106, v107
  v_lshlrev_b32 v116, 16, v112
  v_and_b32 v117, 0xffff0000, v112
  v_lshlrev_b32 v118, 16, v113
  v_and_b32 v119, 0xffff0000, v113
  v_sub_f32 v116, v104, v116
  v_sub_f32 v117, v105, v117
  v_sub_f32 v118, v106, v118
  v_sub_f32 v119, v107, v119
  v_cvt_pk_bf16_f32 v114, v116, v117
  v_cvt_pk_bf16_f32 v115, v118, v119
  v_cmp_eq_u32 vcc, 1, v3
  s_nop 1
  v_cndmask_b32 v120, 0, v114, vcc
  v_cndmask_b32 v121, 0, v115, vcc
  v_cmp_eq_u32 vcc, 0, v3
  s_nop 1
  v_cndmask_b32 v120, v120, v112, vcc
  v_cndmask_b32 v121, v121, v113, vcc
  v_cndmask_b32 v122, 0, v112, vcc
  v_cndmask_b32 v123, 0, v113, vcc
  ds_write_b128 v4, v[120:123] offset:2048
  ds_write_b128 v4, v[100:103] offset:6144
  v_mul_f32 v152, s21, v152
  v_mul_f32 v153, s21, v153
  v_mov_b32 v154, v152
  s_nop 1
  v_permlane16_swap_b32 v152, v154
  v_mov_b32 v155, v152
  v_mov_b32 v156, v154
  s_nop 0
  v_permlane32_swap_b32 v152, v155
  v_permlane32_swap_b32 v154, v156
  v_mov_b32 v165, v153
  v_mov_b32 v160, v152
  v_mov_b32 v161, v155
  v_permlane32_swap_b32 v153, v165
  v_mov_b32 v162, v154
  v_mov_b32 v163, v156
  v_mov_b32 v164, v153
  v_fma_f32 v161, -v160, v160, v161
  v_max_f32 v161, 0, v161
  v_add_f32 v161, s22, v161
  v_rsq_f32 v152, v161
  v_fma_f32 v162, -v160, s58, v162
  v_fma_f32 v165, -v160, s57, v165
  v_mul_f32 v153, s56, v160
  v_fma_f32 v153, v163, -2.0, v153
  v_fma_f32 v164, v160, v153, v164
  v_mul_f32 v161, v161, v152
  v_fma_f32 v162, v152, v162, s62
  v_mul_f32 v164, v164, v152
  v_fma_f32 v164, v165, 2.0, v164
  v_fma_f32 v164, v164, v152, s59
  v_fma_f32 v164, -v162, v162, v164
  v_max_f32 v164, 0, v164
  v_add_f32 v164, s22, v164
  v_rsq_f32 v153, v164
  v_sub_f32 v160, 0, v160
  v_mul_f32_e64 v162, -v162, v161
  v_mul_f32 v164, v164, v153
  v_mul_f32 v163, v164, v161
  v_mul_f32 v152, v152, v153
  v_mul_f32 v156, 0xc0135761, v152
  v_mul_f32 v157, v152, v152
  v_mul_f32 v157, v157, v156
  v_mul_f32 v157, 0x3d372713, v157
  v_mov_b32 v158, v163
  v_mov_b32 v159, 0
  v_cvt_pk_bf16_f32 v168, v160, v161
  v_cvt_pk_bf16_f32 v169, v162, v163
  v_lshlrev_b32 v172, 16, v168
  v_and_b32 v173, 0xffff0000, v168
  v_lshlrev_b32 v174, 16, v169
  v_and_b32 v175, 0xffff0000, v169
  v_sub_f32 v172, v160, v172
  v_sub_f32 v173, v161, v173
  v_sub_f32 v174, v162, v174
  v_sub_f32 v175, v163, v175
  v_cvt_pk_bf16_f32 v170, v172, v173
  v_cvt_pk_bf16_f32 v171, v174, v175
  v_cmp_eq_u32 vcc, 1, v3
  s_nop 1
  v_cndmask_b32 v176, 0, v170, vcc
  v_cndmask_b32 v177, 0, v171, vcc
  v_cmp_eq_u32 vcc, 0, v3
  s_nop 1
  v_cndmask_b32 v176, v176, v168, vcc
  v_cndmask_b32 v177, v177, v169, vcc
  v_cndmask_b32 v178, 0, v168, vcc
  v_cndmask_b32 v179, 0, v169, vcc
  ds_write_b128 v4, v[176:179] offset:3072
  ds_write_b128 v4, v[156:159] offset:7168
  s_waitcnt lgkmcnt(0)
  s_barrier
  ds_read_b128 v[16:19], v1 offset:40960
  ds_read_b128 v[20:23], v4 offset:8192
  ds_read_b128 v[24:27], v1 offset:41984
  ds_read_b128 v[28:31], v4 offset:9216
  ds_read_b128 v[128:131], v1 offset:43008
  ds_read_b128 v[40:43], v4 offset:2048
  ds_read_b128 v[56:59], v4 offset:6144
  ds_read_b128 v[44:47], v4 offset:3072
  ds_read_b128 v[60:63], v4 offset:7168
  s_waitcnt lgkmcnt(8)
  v_mfma_f32_16x16x32_bf16 v[96:99], a[0:3], v[16:19], 0
  ds_read_b128 v[132:135], v4 offset:10240
  v_mfma_f32_16x16x32_bf16 v[100:103], a[4:7], v[16:19], 0
  s_waitcnt lgkmcnt(8)
  v_mfma_f32_16x16x32_bf16 v[120:123], a[0:3], v[20:23], 0
  ds_read_b128 v[16:19], v1 offset:44032
  v_mfma_f32_16x16x32_bf16 v[124:127], a[4:7], v[20:23], 0
  s_waitcnt lgkmcnt(8)
  v_mfma_f32_16x16x32_bf16 v[96:99], a[16:19], v[24:27], v[96:99]
  ds_read_b128 v[20:23], v4 offset:11264
  v_mfma_f32_16x16x32_bf16 v[100:103], a[20:23], v[24:27], v[100:103]
  s_waitcnt lgkmcnt(8)
  s_add_u32 s27, s24, 0
  buffer_load_dwordx4 a[0:3], v1, s[12:15], s27 offen offset:0 sc1
  v_mfma_f32_16x16x32_bf16 v[120:123], a[16:19], v[28:31], v[120:123]
  ds_read_b128 v[24:27], v1 offset:45056
  v_mfma_f32_16x16x32_bf16 v[124:127], a[20:23], v[28:31], v[124:127]
  s_waitcnt lgkmcnt(8)
  buffer_load_dwordx4 a[4:7], v1, s[12:15], s27 offen offset:1024 sc1
  v_mfma_f32_16x16x32_bf16 v[96:99], a[32:35], v[128:131], v[96:99]
  ds_read_b128 v[28:31], v4 offset:12288
  v_mfma_f32_16x16x32_bf16 v[100:103], a[36:39], v[128:131], v[100:103]
  s_waitcnt lgkmcnt(4)
  s_add_u32 s27, s24, 4096
  buffer_load_dwordx4 a[16:19], v1, s[12:15], s27 offen offset:0 sc1
  v_mfma_f32_16x16x32_bf16 v[120:123], a[32:35], v[132:135], v[120:123]
  ds_read_b128 v[128:131], v1 offset:46080
  v_mfma_f32_16x16x32_bf16 v[124:127], a[36:39], v[132:135], v[124:127]
  s_waitcnt lgkmcnt(4)
  buffer_load_dwordx4 a[20:23], v1, s[12:15], s27 offen offset:1024 sc1
  v_mfma_f32_16x16x32_bf16 v[96:99], a[48:51], v[16:19], v[96:99]
  ds_read_b128 v[132:135], v4 offset:13312
  v_mfma_f32_16x16x32_bf16 v[100:103], a[52:55], v[16:19], v[100:103]
  s_waitcnt lgkmcnt(4)
  s_add_u32 s27, s24, 8192
  buffer_load_dwordx4 a[32:35], v1, s[12:15], s27 offen offset:0 sc1
  v_mfma_f32_16x16x32_bf16 v[120:123], a[48:51], v[20:23], v[120:123]
  ds_read_b128 v[16:19], v1 offset:47104
  v_mfma_f32_16x16x32_bf16 v[124:127], a[52:55], v[20:23], v[124:127]
  s_waitcnt lgkmcnt(4)
  buffer_load_dwordx4 a[36:39], v1, s[12:15], s27 offen offset:1024 sc1
  s_waitcnt vmcnt(6)
  s_barrier
  v_mfma_f32_16x16x32_bf16 v[96:99], a[64:67], v[24:27], v[96:99]
  ds_read_b128 v[20:23], v4 offset:14336
  v_mfma_f32_16x16x32_bf16 v[100:103], a[68:71], v[24:27], v[100:103]
  s_waitcnt lgkmcnt(4)
  s_add_u32 s27, s24, 12288
  buffer_load_dwordx4 a[48:51], v1, s[12:15], s27 offen offset:0 sc1
  v_mfma_f32_16x16x32_bf16 v[120:123], a[64:67], v[28:31], v[120:123]
  ds_read_b128 v[24:27], v1 offset:48128
  v_mfma_f32_16x16x32_bf16 v[124:127], a[68:71], v[28:31], v[124:127]
  s_waitcnt lgkmcnt(4)
  buffer_load_dwordx4 a[52:55], v1, s[12:15], s27 offen offset:1024 sc1
  v_mfma_f32_16x16x32_bf16 v[96:99], a[80:83], v[128:131], v[96:99]
  ds_read_b128 v[28:31], v4 offset:15360
  v_mfma_f32_16x16x32_bf16 v[100:103], a[84:87], v[128:131], v[100:103]
  s_waitcnt lgkmcnt(4)
  s_add_u32 s27, s24, 16384
  buffer_load_dwordx4 a[64:67], v1, s[12:15], s27 offen offset:0 sc1
  v_mfma_f32_16x16x32_bf16 v[120:123], a[80:83], v[132:135], v[120:123]
  ds_read_b128 v[128:131], v1 offset:49152
  v_mfma_f32_16x16x32_bf16 v[124:127], a[84:87], v[132:135], v[124:127]
  s_waitcnt lgkmcnt(4)
  buffer_load_dwordx4 a[68:71], v1, s[12:15], s27 offen offset:1024 sc1
  v_mfma_f32_16x16x32_bf16 v[96:99], a[96:99], v[16:19], v[96:99]
  ds_read_b128 v[132:135], v4 offset:16384
  v_mfma_f32_16x16x32_bf16 v[100:103], a[100:103], v[16:19], v[100:103]
  s_waitcnt lgkmcnt(4)
  s_add_u32 s27, s24, 20480
  buffer_load_dwordx4 a[80:83], v1, s[12:15], s27 offen offset:0 sc1
  v_mfma_f32_16x16x32_bf16 v[120:123], a[96:99], v[20:23], v[120:123]
  ds_read_b128 v[16:19], v1 offset:50176
  v_mfma_f32_16x16x32_bf16 v[124:127], a[100:103], v[20:23], v[124:127]
  s_waitcnt lgkmcnt(4)
  buffer_load_dwordx4 a[84:87], v1, s[12:15], s27 offen offset:1024 sc1
  v_mfma_f32_16x16x32_bf16 v[96:99], a[112:115], v[24:27], v[96:99]
  ds_read_b128 v[20:23], v4 offset:17408
  v_mfma_f32_16x16x32_bf16 v[100:103], a[116:119], v[24:27], v[100:103]
  s_waitcnt lgkmcnt(4)
  s_add_u32 s27, s24, 24576
  buffer_load_dwordx4 a[96:99], v1, s[12:15], s27 offen offset:0 sc1
  v_mfma_f32_16x16x32_bf16 v[120:123], a[112:115], v[28:31], v[120:123]
  ds_read_b128 v[24:27], v1 offset:51200
  v_mfma_f32_16x16x32_bf16 v[124:127], a[116:119], v[28:31], v[124:127]
  s_waitcnt lgkmcnt(4)
  buffer_load_dwordx4 a[100:103], v1, s[12:15], s27 offen offset:1024 sc1
  v_mfma_f32_16x16x32_bf16 v[96:99], a[128:131], v[128:131], v[96:99]
  ds_read_b128 v[28:31], v4 offset:18432
  v_mfma_f32_16x16x32_bf16 v[100:103], a[132:135], v[128:131], v[100:103]
  s_waitcnt lgkmcnt(4)
  s_add_u32 s27, s24, 28672
  buffer_load_dwordx4 a[112:115], v1, s[12:15], s27 offen offset:0 sc1
  v_mfma_f32_16x16x32_bf16 v[120:123], a[128:131], v[132:135], v[120:123]
  ds_read_b128 v[128:131], v1 offset:52224
  v_mfma_f32_16x16x32_bf16 v[124:127], a[132:135], v[132:135], v[124:127]
  s_waitcnt lgkmcnt(4)
  buffer_load_dwordx4 a[116:119], v1, s[12:15], s27 offen offset:1024 sc1
  v_mfma_f32_16x16x32_bf16 v[96:99], a[144:147], v[16:19], v[96:99]
  ds_read_b128 v[132:135], v4 offset:19456
  v_mfma_f32_16x16x32_bf16 v[100:103], a[148:151], v[16:19], v[100:103]
  s_waitcnt lgkmcnt(4)
  s_add_u32 s27, s24, 32768
  buffer_load_dwordx4 a[128:131], v1, s[12:15], s27 offen offset:0 sc1
  v_mfma_f32_16x16x32_bf16 v[120:123], a[144:147], v[20:23], v[120:123]
  ds_read_b128 v[16:19], v1 offset:53248
  v_mfma_f32_16x16x32_bf16 v[124:127], a[148:151], v[20:23], v[124:127]
  s_waitcnt lgkmcnt(4)
  buffer_load_dwordx4 a[132:135], v1, s[12:15], s27 offen offset:1024 sc1
  v_mfma_f32_16x16x32_bf16 v[96:99], a[160:163], v[24:27], v[96:99]
  ds_read_b128 v[20:23], v4 offset:20480
  v_mfma_f32_16x16x32_bf16 v[100:103], a[164:167], v[24:27], v[100:103]
  s_waitcnt lgkmcnt(4)
  s_add_u32 s27, s24, 36864
  buffer_load_dwordx4 a[144:147], v1, s[12:15], s27 offen offset:0 sc1
  v_mfma_f32_16x16x32_bf16 v[120:123], a[160:163], v[28:31], v[120:123]
  ds_read_b128 v[24:27], v1 offset:54272
  v_mfma_f32_16x16x32_bf16 v[124:127], a[164:167], v[28:31], v[124:127]
  s_waitcnt lgkmcnt(4)
  buffer_load_dwordx4 a[148:151], v1, s[12:15], s27 offen offset:1024 sc1
  v_mfma_f32_16x16x32_bf16 v[96:99], a[176:179], v[128:131], v[96:99]
  ds_read_b128 v[28:31], v4 offset:21504
  v_mfma_f32_16x16x32_bf16 v[100:103], a[180:183], v[128:131], v[100:103]
  s_waitcnt lgkmcnt(4)
  s_add_u32 s27, s24, 40960
  buffer_load_dwordx4 a[160:163], v1, s[12:15], s27 offen offset:0 sc1
  v_mfma_f32_16x16x32_bf16 v[120:123], a[176:179], v[132:135], v[120:123]
  ds_read_b128 v[128:131], v1 offset:55296
  v_mfma_f32_16x16x32_bf16 v[124:127], a[180:183], v[132:135], v[124:127]
  s_waitcnt lgkmcnt(4)
  buffer_load_dwordx4 a[164:167], v1, s[12:15], s27 offen offset:1024 sc1
  v_mfma_f32_16x16x32_bf16 v[96:99], a[192:195], v[16:19], v[96:99]
  ds_read_b128 v[132:135], v4 offset:22528
  v_mfma_f32_16x16x32_bf16 v[100:103], a[196:199], v[16:19], v[100:103]
  s_waitcnt lgkmcnt(4)
  s_add_u32 s27, s24, 45056
  buffer_load_dwordx4 a[176:179], v1, s[12:15], s27 offen offset:0 sc1
  v_mfma_f32_16x16x32_bf16 v[120:123], a[192:195], v[20:23], v[120:123]
  ds_read_b128 v[16:19], v1 offset:56320
  v_mfma_f32_16x16x32_bf16 v[124:127], a[196:199], v[20:23], v[124:127]
  s_waitcnt lgkmcnt(4)
  buffer_load_dwordx4 a[180:183], v1, s[12:15], s27 offen offset:1024 sc1
  v_mfma_f32_16x16x32_bf16 v[96:99], a[208:211], v[24:27], v[96:99]
  ds_read_b128 v[20:23], v4 offset:23552
  v_mfma_f32_16x16x32_bf16 v[100:103], a[212:215], v[24:27], v[100:103]
  s_waitcnt lgkmcnt(4)
  v_mfma_f32_16x16x32_bf16 v[120:123], a[208:211], v[28:31], v[120:123]
  ds_read_b128 v[24:27], v1 offset:57344
  v_mfma_f32_16x16x32_bf16 v[124:127], a[212:215], v[28:31], v[124:127]
  s_waitcnt lgkmcnt(4)
  v_mfma_f32_16x16x32_bf16 v[96:99], a[224:227], v[128:131], v[96:99]
  ds_read_b128 v[28:31], v4 offset:24576
  v_mfma_f32_16x16x32_bf16 v[100:103], a[228:231], v[128:131], v[100:103]
  s_waitcnt lgkmcnt(4)
  v_mfma_f32_16x16x32_bf16 v[120:123], a[224:227], v[132:135], v[120:123]
  ds_read_b128 v[128:131], v1 offset:58368
  v_mfma_f32_16x16x32_bf16 v[124:127], a[228:231], v[132:135], v[124:127]
  s_waitcnt lgkmcnt(4)
  v_mfma_f32_16x16x32_bf16 v[96:99], a[240:243], v[16:19], v[96:99]
  ds_read_b128 v[132:135], v4 offset:25600
  v_mfma_f32_16x16x32_bf16 v[100:103], a[244:247], v[16:19], v[100:103]
  s_waitcnt lgkmcnt(4)
  v_mfma_f32_16x16x32_bf16 v[120:123], a[240:243], v[20:23], v[120:123]
  ds_read_b128 v[16:19], v1 offset:59392
  v_mfma_f32_16x16x32_bf16 v[124:127], a[244:247], v[20:23], v[124:127]
  s_waitcnt lgkmcnt(4)
  v_mfma_f32_16x16x32_bf16 v[96:99], v[192:195], v[24:27], v[96:99]
  ds_read_b128 v[20:23], v4 offset:26624
  v_mfma_f32_16x16x32_bf16 v[100:103], v[196:199], v[24:27], v[100:103]
  s_waitcnt lgkmcnt(4)
  v_mfma_f32_16x16x32_bf16 v[120:123], v[192:195], v[28:31], v[120:123]
  ds_read_b128 v[24:27], v1 offset:60416
  v_mfma_f32_16x16x32_bf16 v[124:127], v[196:199], v[28:31], v[124:127]
  s_waitcnt lgkmcnt(4)
  v_mfma_f32_16x16x32_bf16 v[96:99], v[208:211], v[128:131], v[96:99]
  ds_read_b128 v[28:31], v4 offset:27648
  v_mfma_f32_16x16x32_bf16 v[100:103], v[212:215], v[128:131], v[100:103]
  s_waitcnt lgkmcnt(4)
  v_mfma_f32_16x16x32_bf16 v[120:123], v[208:211], v[132:135], v[120:123]
  v_mfma_f32_16x16x32_bf16 v[124:127], v[212:215], v[132:135], v[124:127]
  s_waitcnt lgkmcnt(3)
  v_mfma_f32_16x16x32_bf16 v[96:99], v[224:227], v[16:19], v[96:99]
  v_mfma_f32_16x16x32_bf16 v[100:103], v[228:231], v[16:19], v[100:103]
  s_waitcnt lgkmcnt(2)
  v_mfma_f32_16x16x32_bf16 v[120:123], v[224:227], v[20:23], v[120:123]
  v_mfma_f32_16x16x32_bf16 v[124:127], v[228:231], v[20:23], v[124:127]
  s_waitcnt lgkmcnt(1)
  v_mfma_f32_16x16x32_bf16 v[96:99], v[240:243], v[24:27], v[96:99]
  v_mfma_f32_16x16x32_bf16 v[100:103], v[244:247], v[24:27], v[100:103]
  s_waitcnt lgkmcnt(0)
  v_mfma_f32_16x16x32_bf16 v[120:123], v[240:243], v[28:31], v[120:123]
  v_mfma_f32_16x16x32_bf16 v[124:127], v[244:247], v[28:31], v[124:127]
  v_mfma_f32_16x16x32_bf16 v[96:99], v[136:139], v[40:43], v[96:99]
  v_mfma_f32_16x16x32_bf16 v[100:103], v[140:143], v[40:43], v[100:103]
  v_mfma_f32_16x16x32_bf16 v[120:123], v[136:139], v[44:47], v[120:123]
  v_mfma_f32_16x16x32_bf16 v[124:127], v[140:143], v[44:47], v[124:127]
  s_nop 4
  v_pk_mul_f32 v[152:153], v[96:97], v[96:97]
  v_pk_mul_f32 v[154:155], v[98:99], v[98:99]
  v_pk_mul_f32 v[156:157], v[100:101], v[100:101]
  v_pk_mul_f32 v[158:159], v[102:103], v[102:103]
  v_pk_fma_f32 v[152:153], v[152:153], v[56:57], v[56:57] op_sel:[0,1,0] op_sel_hi:[1,1,0]
  v_pk_fma_f32 v[154:155], v[154:155], v[56:57], v[56:57] op_sel:[0,1,0] op_sel_hi:[1,1,0]
  v_pk_fma_f32 v[156:157], v[156:157], v[56:57], v[56:57] op_sel:[0,1,0] op_sel_hi:[1,1,0]
  v_pk_fma_f32 v[158:159], v[158:159], v[56:57], v[56:57] op_sel:[0,1,0] op_sel_hi:[1,1,0]
  v_pk_mul_f32 v[152:153], v[152:153], v[96:97]
  v_pk_mul_f32 v[154:155], v[154:155], v[98:99]
  v_pk_mul_f32 v[156:157], v[156:157], v[100:101]
  v_pk_mul_f32 v[158:159], v[158:159], v[102:103]
  v_exp_f32 v152, v152
  v_exp_f32 v153, v153
  v_exp_f32 v154, v154
  v_exp_f32 v155, v155
  v_exp_f32 v156, v156
  v_exp_f32 v157, v157
  v_exp_f32 v158, v158
  v_exp_f32 v159, v159
  v_pk_fma_f32 v[152:153], v[152:153], v[58:59], v[58:59] op_sel_hi:[1,0,0]
  v_pk_fma_f32 v[154:155], v[154:155], v[58:59], v[58:59] op_sel_hi:[1,0,0]
  v_pk_fma_f32 v[156:157], v[156:157], v[58:59], v[58:59] op_sel_hi:[1,0,0]
  v_pk_fma_f32 v[158:159], v[158:159], v[58:59], v[58:59] op_sel_hi:[1,0,0]
  v_rcp_f32 v152, v152
  v_rcp_f32 v153, v153
  v_rcp_f32 v154, v154
  v_rcp_f32 v155, v155
  v_rcp_f32 v156, v156
  v_rcp_f32 v157, v157
  v_rcp_f32 v158, v158
  v_rcp_f32 v159, v159
  v_pk_mul_f32 v[152:153], v[152:153], v[96:97]
  v_pk_mul_f32 v[154:155], v[154:155], v[98:99]
  v_pk_mul_f32 v[156:157], v[156:157], v[100:101]
  v_pk_mul_f32 v[158:159], v[158:159], v[102:103]
  v_cvt_pk_bf16_f32 v96, v152, v153
  v_cvt_pk_bf16_f32 v97, v154, v155
  v_cvt_pk_bf16_f32 v98, v156, v157
  v_cvt_pk_bf16_f32 v99, v158, v159
  buffer_store_dwordx4 v[96:99], v11, s[12:15], s98 offen offset:2048 sc1
  s_mov_b32 s99, s98
  s_waitcnt lgkmcnt(0)
HELP_END:
  s_nop 7
  s_barrier
  s_lshl_b32 s25, s26, 12
  s_add_u32 s25, s25, s53
  s_mov_b32 s23, s25
  s_mov_b32 s63, s25
  buffer_load_dwordx4 v[192:195], v1, s[12:15], s25 offen offset:0 sc1
  buffer_load_dwordx4 v[196:199], v1, s[12:15], s25 offen offset:1024 sc1
  s_add_u32 s25, s25, 4096
  buffer_load_dwordx4 v[200:203], v1, s[12:15], s25 offen offset:0 sc1
  s_add_u32 s6, s49, 61440
  v_add_u32 v12, s6, v1
  s_lshr_b32 s6, s49, 1
  s_add_u32 s6, s6, 131072
  v_add_u32 v13, s6, v1
  ds_read_b128 a[220:223], v12 offset:0
  ds_read_b128 a[224:227], v12 offset:1024
  ds_read_b128 a[228:231], v12 offset:2048
  ds_read_b128 a[232:235], v12 offset:3072
  ds_read_b128 a[236:239], v12 offset:4096
  ds_read_b128 a[240:243], v12 offset:5120
  ds_read_b128 a[244:247], v12 offset:6144
  ds_read_b128 a[248:251], v12 offset:7168
  ds_read_b128 a[252:255], v12 offset:8192
  ds_read_b128 v[136:139], v12 offset:9216
  ds_read_b128 v[140:143], v13 offset:0
  ds_read_b128 v[144:147], v13 offset:1024
  ds_read_b128 v[148:151], v13 offset:2048
  ds_read_b128 v[152:155], v13 offset:3072
  ds_read_b128 v[156:159], v13 offset:4096
  s_lshr_b32 s6, s3, 1
  s_lshl_b32 s101, s6, 6
  v_add_u32 v8, s101, v8
  v_add_u32 v13, 157760, v8
  v_add_u32 v4, 157760, v9
  ds_read_b128 v[166:169], v13 offset:512
  ds_read_b64 v[170:171], v4 offset:640
  ds_read_b128 v[160:163], v13 offset:3744
  ds_read_b64 v[164:165], v4 offset:3872
  s_lshl_b32 s7, s6, 11
  s_and_b32 s6, s3, 1
  s_mul_i32 s6, s6, 20480
  v_add_u32 v13, s6, v1
  v_add_u32 v0, s7, v13
  s_mul_i32 s6, s3, 5120
  v_add_u32 v12, s6, v1
  v_add_u32 v4, 40960, v12
  v_pk_mul_f32 v[72:73], v[120:121], v[120:121]
  v_pk_mul_f32 v[74:75], v[122:123], v[122:123]
  v_pk_mul_f32 v[76:77], v[124:125], v[124:125]
  v_pk_mul_f32 v[78:79], v[126:127], v[126:127]
  v_pk_fma_f32 v[72:73], v[72:73], v[60:61], v[60:61] op_sel:[0,1,0] op_sel_hi:[1,1,0]
  v_pk_fma_f32 v[74:75], v[74:75], v[60:61], v[60:61] op_sel:[0,1,0] op_sel_hi:[1,1,0]
  v_pk_fma_f32 v[76:77], v[76:77], v[60:61], v[60:61] op_sel:[0,1,0] op_sel_hi:[1,1,0]
  v_pk_fma_f32 v[78:79], v[78:79], v[60:61], v[60:61] op_sel:[0,1,0] op_sel_hi:[1,1,0]
  v_pk_mul_f32 v[72:73], v[72:73], v[120:121]
  v_pk_mul_f32 v[74:75], v[74:75], v[122:123]
  v_pk_mul_f32 v[76:77], v[76:77], v[124:125]
  v_pk_mul_f32 v[78:79], v[78:79], v[126:127]
  buffer_load_dwordx4 v[204:207], v1, s[12:15], s25 offen offset:1024 sc1
  s_add_u32 s25, s25, 4096
  v_exp_f32 v72, v72
  v_exp_f32 v73, v73
  v_exp_f32 v74, v74
  v_exp_f32 v75, v75
  v_exp_f32 v76, v76
  v_exp_f32 v77, v77
  buffer_load_dwordx4 v[208:211], v1, s[12:15], s25 offen offset:0 sc1
  v_exp_f32 v78, v78
  v_exp_f32 v79, v79
  v_pk_fma_f32 v[72:73], v[72:73], v[62:63], v[62:63] op_sel_hi:[1,0,0]
  v_pk_fma_f32 v[74:75], v[74:75], v[62:63], v[62:63] op_sel_hi:[1,0,0]
  v_pk_fma_f32 v[76:77], v[76:77], v[62:63], v[62:63] op_sel_hi:[1,0,0]
  v_pk_fma_f32 v[78:79], v[78:79], v[62:63], v[62:63] op_sel_hi:[1,0,0]
  v_rcp_f32 v72, v72
  buffer_load_dwordx4 v[212:215], v1, s[12:15], s25 offen offset:1024 sc1
  s_add_u32 s25, s25, 4096
  v_rcp_f32 v73, v73
  v_rcp_f32 v74, v74
  v_rcp_f32 v75, v75
  v_rcp_f32 v76, v76
  v_rcp_f32 v77, v77
  v_rcp_f32 v78, v78
  buffer_load_dwordx4 v[216:219], v1, s[12:15], s25 offen offset:0 sc1
  v_rcp_f32 v79, v79
  v_pk_mul_f32 v[72:73], v[72:73], v[120:121]
  v_pk_mul_f32 v[74:75], v[74:75], v[122:123]
  v_pk_mul_f32 v[76:77], v[76:77], v[124:125]
  v_pk_mul_f32 v[78:79], v[78:79], v[126:127]
  v_cvt_pk_bf16_f32 v120, v72, v73
  v_cvt_pk_bf16_f32 v121, v74, v75
  v_cvt_pk_bf16_f32 v122, v76, v77
  v_cvt_pk_bf16_f32 v123, v78, v79
  buffer_store_dwordx4 v[120:123], v11, s[12:15], s99 offen offset:3072 sc1
  buffer_load_dwordx4 v[220:223], v1, s[12:15], s25 offen offset:1024 sc1
  s_add_u32 s25, s25, 4096
  s_waitcnt vmcnt(9)
  s_barrier
  s_cmp_lg_u32 s3, 0
  s_cbranch_scc1 SK34
  s_add_u32 s6, s52, 20480
  buffer_store_dword v14, v10, s[12:15], s6 offen sc1
SK34:
  s_waitcnt vmcnt(8) lgkmcnt(15)
  v_mfma_f32_16x16x32_bf16 v[16:19], a[220:223], v[192:195], 0
  buffer_load_dwordx4 v[224:227], v1, s[12:15], s25 offen offset:0 sc1
  v_mfma_f32_16x16x32_bf16 v[20:23], a[224:227], v[192:195], 0
  v_mfma_f32_16x16x32_bf16 v[24:27], a[228:231], v[192:195], 0
  buffer_load_dwordx4 v[228:231], v1, s[12:15], s25 offen offset:1024 sc1
  v_mfma_f32_16x16x32_bf16 v[28:31], a[232:235], v[192:195], 0
  s_add_u32 s25, s25, 4096
  buffer_load_dwordx4 v[232:235], v1, s[12:15], s25 offen offset:0 sc1
  s_waitcnt lgkmcnt(14)
  v_mfma_f32_16x16x32_bf16 v[32:35], a[236:239], v[192:195], 0
  s_waitcnt vmcnt(10)
  v_mfma_f32_16x16x32_bf16 v[36:39], a[220:223], v[196:199], 0
  buffer_load_dwordx4 v[236:239], v1, s[12:15], s25 offen offset:1024 sc1
  v_mfma_f32_16x16x32_bf16 v[40:43], a[224:227], v[196:199], 0
  s_add_u32 s25, s25, 4096
  v_mfma_f32_16x16x32_bf16 v[44:47], a[228:231], v[196:199], 0
  buffer_load_dwordx4 v[240:243], v1, s[12:15], s25 offen offset:0 sc1
  v_mfma_f32_16x16x32_bf16 v[48:51], a[232:235], v[196:199], 0
  v_mfma_f32_16x16x32_bf16 v[52:55], a[236:239], v[196:199], 0
  s_waitcnt vmcnt(11) lgkmcnt(13)
  v_mfma_f32_16x16x32_bf16 v[16:19], a[240:243], v[200:203], v[16:19]
  s_waitcnt lgkmcnt(12)
  v_mfma_f32_16x16x32_bf16 v[20:23], a[244:247], v[200:203], v[20:23]
  buffer_load_dwordx4 v[244:247], v1, s[12:15], s25 offen offset:1024 sc1
  s_waitcnt lgkmcnt(11)
  v_mfma_f32_16x16x32_bf16 v[24:27], a[248:251], v[200:203], v[24:27]
  s_add_u32 s25, s25, 4096
  s_waitcnt lgkmcnt(10)
  v_mfma_f32_16x16x32_bf16 v[28:31], a[252:255], v[200:203], v[28:31]
  s_waitcnt lgkmcnt(9)
  v_mfma_f32_16x16x32_bf16 v[32:35], v[136:139], v[200:203], v[32:35]
  s_waitcnt vmcnt(11)
  v_mfma_f32_16x16x32_bf16 v[36:39], a[240:243], v[204:207], v[36:39]
  buffer_load_dwordx4 v[248:251], v1, s[12:15], s25 offen offset:0 sc1
  v_mfma_f32_16x16x32_bf16 v[40:43], a[244:247], v[204:207], v[40:43]
  v_mfma_f32_16x16x32_bf16 v[44:47], a[248:251], v[204:207], v[44:47]
  v_mfma_f32_16x16x32_bf16 v[48:51], a[252:255], v[204:207], v[48:51]
  v_mfma_f32_16x16x32_bf16 v[52:55], v[136:139], v[204:207], v[52:55]
  buffer_load_dwordx4 v[252:255], v1, s[12:15], s25 offen offset:1024 sc1
  s_waitcnt vmcnt(12) lgkmcnt(8)
  v_mfma_f32_16x16x32_bf16 v[16:19], v[140:143], v[208:211], v[16:19]
  s_add_u32 s25, s25, 4096
  s_waitcnt lgkmcnt(7)
  v_mfma_f32_16x16x32_bf16 v[20:23], v[144:147], v[208:211], v[20:23]
  s_waitcnt lgkmcnt(6)
  v_mfma_f32_16x16x32_bf16 v[24:27], v[148:151], v[208:211], v[24:27]
  s_waitcnt lgkmcnt(5)
  v_mfma_f32_16x16x32_bf16 v[28:31], v[152:155], v[208:211], v[28:31]
  buffer_load_dwordx4 v[96:99], v1, s[12:15], s25 offen offset:0 sc1
  s_waitcnt lgkmcnt(4)
  v_mfma_f32_16x16x32_bf16 v[32:35], v[156:159], v[208:211], v[32:35]
  s_waitcnt vmcnt(12)
  v_mfma_f32_16x16x32_bf16 v[36:39], v[140:143], v[212:215], v[36:39]
  v_mfma_f32_16x16x32_bf16 v[40:43], v[144:147], v[212:215], v[40:43]
  v_mfma_f32_16x16x32_bf16 v[44:47], v[148:151], v[212:215], v[44:47]
  buffer_load_dwordx4 v[100:103], v1, s[12:15], s25 offen offset:1024 sc1
  v_mfma_f32_16x16x32_bf16 v[48:51], v[152:155], v[212:215], v[48:51]
  s_add_u32 s25, s25, 4096
  v_mfma_f32_16x16x32_bf16 v[52:55], v[156:159], v[212:215], v[52:55]
  s_waitcnt vmcnt(11)
  s_barrier
  s_cmp_lg_u32 s3, 0
  s_cbranch_scc1 SK35
  s_add_u32 s6, s52, 24576
  buffer_store_dword v14, v10, s[12:15], s6 offen sc1
SK35:
  v_mfma_f32_16x16x32_bf16 v[16:19], a[0:3], v[216:219], v[16:19]
  v_mfma_f32_16x16x32_bf16 v[20:23], a[4:7], v[216:219], v[20:23]
  buffer_load_dwordx4 v[104:107], v1, s[12:15], s25 offen offset:0 sc1
  v_mfma_f32_16x16x32_bf16 v[24:27], a[8:11], v[216:219], v[24:27]
  v_mfma_f32_16x16x32_bf16 v[28:31], a[12:15], v[216:219], v[28:31]
  v_mfma_f32_16x16x32_bf16 v[32:35], a[16:19], v[216:219], v[32:35]
  s_waitcnt vmcnt(11)
  v_mfma_f32_16x16x32_bf16 v[36:39], a[0:3], v[220:223], v[36:39]
  buffer_load_dwordx4 v[108:111], v1, s[12:15], s25 offen offset:1024 sc1
  v_mfma_f32_16x16x32_bf16 v[40:43], a[4:7], v[220:223], v[40:43]
  s_add_u32 s25, s25, 4096
  v_mfma_f32_16x16x32_bf16 v[44:47], a[8:11], v[220:223], v[44:47]
  v_mfma_f32_16x16x32_bf16 v[48:51], a[12:15], v[220:223], v[48:51]
  v_mfma_f32_16x16x32_bf16 v[52:55], a[16:19], v[220:223], v[52:55]
  buffer_load_dwordx4 v[128:131], v1, s[12:15], s25 offen offset:0 sc1
  s_waitcnt vmcnt(12)
  v_mfma_f32_16x16x32_bf16 v[16:19], a[20:23], v[224:227], v[16:19]
  v_mfma_f32_16x16x32_bf16 v[20:23], a[24:27], v[224:227], v[20:23]
  v_mfma_f32_16x16x32_bf16 v[24:27], a[28:31], v[224:227], v[24:27]
  v_mfma_f32_16x16x32_bf16 v[28:31], a[32:35], v[224:227], v[28:31]
  buffer_load_dwordx4 v[132:135], v1, s[12:15], s25 offen offset:1024 sc1
  v_mfma_f32_16x16x32_bf16 v[32:35], a[36:39], v[224:227], v[32:35]
  s_add_u32 s25, s25, 4096
  s_waitcnt vmcnt(12)
  v_mfma_f32_16x16x32_bf16 v[36:39], a[20:23], v[228:231], v[36:39]
  v_mfma_f32_16x16x32_bf16 v[40:43], a[24:27], v[228:231], v[40:43]
  v_mfma_f32_16x16x32_bf16 v[44:47], a[28:31], v[228:231], v[44:47]
  buffer_load_dwordx4 v[112:115], v1, s[12:15], s25 offen offset:0 sc1
  v_mfma_f32_16x16x32_bf16 v[48:51], a[32:35], v[228:231], v[48:51]
  v_mfma_f32_16x16x32_bf16 v[52:55], a[36:39], v[228:231], v[52:55]
  s_waitcnt vmcnt(12)
  v_mfma_f32_16x16x32_bf16 v[16:19], a[40:43], v[232:235], v[16:19]
  v_mfma_f32_16x16x32_bf16 v[20:23], a[44:47], v[232:235], v[20:23]
  buffer_load_dwordx4 v[116:119], v1, s[12:15], s25 offen offset:1024 sc1
  v_mfma_f32_16x16x32_bf16 v[24:27], a[48:51], v[232:235], v[24:27]
  s_add_u32 s25, s25, 8192
  v_mfma_f32_16x16x32_bf16 v[28:31], a[52:55], v[232:235], v[28:31]
  v_mfma_f32_16x16x32_bf16 v[32:35], a[56:59], v[232:235], v[32:35]
  s_waitcnt vmcnt(12)
  v_mfma_f32_16x16x32_bf16 v[36:39], a[40:43], v[236:239], v[36:39]
  s_add_u32 s27, s24, 49152
  buffer_load_dwordx4 a[192:195], v1, s[12:15], s27 offen offset:0 sc1
  v_mfma_f32_16x16x32_bf16 v[40:43], a[44:47], v[236:239], v[40:43]
  v_mfma_f32_16x16x32_bf16 v[44:47], a[48:51], v[236:239], v[44:47]
  v_mfma_f32_16x16x32_bf16 v[48:51], a[52:55], v[236:239], v[48:51]
  v_mfma_f32_16x16x32_bf16 v[52:55], a[56:59], v[236:239], v[52:55]
  buffer_load_dwordx4 a[196:199], v1, s[12:15], s27 offen offset:1024 sc1
  s_waitcnt vmcnt(13)
  v_mfma_f32_16x16x32_bf16 v[16:19], a[60:63], v[240:243], v[16:19]
  v_mfma_f32_16x16x32_bf16 v[20:23], a[64:67], v[240:243], v[20:23]
  v_mfma_f32_16x16x32_bf16 v[24:27], a[68:71], v[240:243], v[24:27]
  v_mfma_f32_16x16x32_bf16 v[28:31], a[72:75], v[240:243], v[28:31]
  s_cmp_ge_u32 s3, 2
  s_cbranch_scc1 SK36
  buffer_load_dwordx4 a[200:203], v1, s[12:15], s27 offen offset:2048 sc1
SK36:
  v_mfma_f32_16x16x32_bf16 v[32:35], a[76:79], v[240:243], v[32:35]
  s_waitcnt vmcnt(12)
  v_mfma_f32_16x16x32_bf16 v[36:39], a[60:63], v[244:247], v[36:39]
  v_mfma_f32_16x16x32_bf16 v[40:43], a[64:67], v[244:247], v[40:43]
  v_mfma_f32_16x16x32_bf16 v[44:47], a[68:71], v[244:247], v[44:47]
  s_cmp_ge_u32 s3, 2
  s_cbranch_scc1 SK37
  buffer_load_dwordx4 a[204:207], v1, s[12:15], s27 offen offset:3072 sc1
SK37:
  v_mfma_f32_16x16x32_bf16 v[48:51], a[72:75], v[244:247], v[48:51]
  v_mfma_f32_16x16x32_bf16 v[52:55], a[76:79], v[244:247], v[52:55]
  s_cmp_lg_u32 s3, 0
  s_cbranch_scc1 PI5
  s_load_dwordx8 s[28:35], s[54:55], 20480 glc
PI5:
  s_waitcnt vmcnt(11)
  v_mfma_f32_16x16x32_bf16 v[16:19], a[80:83], v[248:251], v[16:19]
  v_mfma_f32_16x16x32_bf16 v[20:23], a[84:87], v[248:251], v[20:23]
  s_add_u32 s27, s24, 53248
  s_cmp_ge_u32 s3, 2
  s_cbranch_scc1 SK38
  buffer_load_dwordx4 a[208:211], v1, s[12:15], s27 offen offset:0 sc1
SK38:
  v_mfma_f32_16x16x32_bf16 v[24:27], a[88:91], v[248:251], v[24:27]
  v_mfma_f32_16x16x32_bf16 v[28:31], a[92:95], v[248:251], v[28:31]
  v_mfma_f32_16x16x32_bf16 v[32:35], a[96:99], v[248:251], v[32:35]
  s_waitcnt vmcnt(10)
  v_mfma_f32_16x16x32_bf16 v[36:39], a[80:83], v[252:255], v[36:39]
  s_cmp_ge_u32 s3, 2
  s_cbranch_scc1 SK39
  buffer_load_dwordx4 a[212:215], v1, s[12:15], s27 offen offset:1024 sc1
SK39:
  v_mfma_f32_16x16x32_bf16 v[40:43], a[84:87], v[252:255], v[40:43]
  v_mfma_f32_16x16x32_bf16 v[44:47], a[88:91], v[252:255], v[44:47]
  v_mfma_f32_16x16x32_bf16 v[48:51], a[92:95], v[252:255], v[48:51]
  v_mfma_f32_16x16x32_bf16 v[52:55], a[96:99], v[252:255], v[52:55]
  s_cmp_ge_u32 s3, 2
  s_cbranch_scc1 SK40
  buffer_load_dwordx4 a[216:219], v1, s[12:15], s27 offen offset:2048 sc1
SK40:
  s_waitcnt vmcnt(9)
  v_mfma_f32_16x16x32_bf16 v[16:19], a[100:103], v[96:99], v[16:19]
  s_cmp_ge_u32 s3, 2
  s_cbranch_scc1 SK41
  buffer_load_dwordx4 v[120:123], v1, s[12:15], s25 offen offset:0 sc1
SK41:
  v_mfma_f32_16x16x32_bf16 v[20:23], a[104:107], v[96:99], v[20:23]
  v_mfma_f32_16x16x32_bf16 v[24:27], a[108:111], v[96:99], v[24:27]
  v_mfma_f32_16x16x32_bf16 v[28:31], a[112:115], v[96:99], v[28:31]
  s_cmp_ge_u32 s3, 2
  s_cbranch_scc1 SK42
  buffer_load_dwordx4 v[124:127], v1, s[12:15], s25 offen offset:1024 sc1
SK42:
  v_mfma_f32_16x16x32_bf16 v[32:35], a[116:119], v[96:99], v[32:35]
  s_add_u32 s25, s25, -4096
  s_waitcnt lgkmcnt(0)
  s_mov_b32 s61, 0
  s_cmp_lg_u32 s3, 0
  s_cbranch_scc1 ACQ5_DONE
ACQ5:
  s_xor_b32 s28, s28, s94
  s_xor_b32 s29, s29, s94
  s_xor_b32 s30, s30, s94
  s_xor_b32 s31, s31, s94
  s_xor_b32 s32, s32, s94
  s_xor_b32 s33, s33, s94
  s_xor_b32 s34, s34, s94
  s_xor_b32 s35, s35, s94
  s_or_b64 s[28:29], s[28:29], s[30:31]
  s_or_b64 s[28:29], s[28:29], s[32:33]
  s_or_b64 s[28:29], s[28:29], s[34:35]
  s_cbranch_scc0 ACQ5_DONE
  s_load_dwordx8 s[28:35], s[54:55], 20480 glc
  s_waitcnt lgkmcnt(0)
  s_add_u32 s61, s61, 1
  s_cmp_lt_u32 s61, 262144
  s_cbranch_scc1 ACQ5
ACQ5_DONE:
  s_barrier
  s_waitcnt vmcnt(8)
  v_mfma_f32_16x16x32_bf16 v[36:39], a[100:103], v[100:103], v[36:39]
  buffer_load_dwordx4 v[192:195], v1, s[12:15], s25 offen offset:0 sc1
  v_mfma_f32_16x16x32_bf16 v[40:43], a[104:107], v[100:103], v[40:43]
  v_mfma_f32_16x16x32_bf16 v[44:47], a[108:111], v[100:103], v[44:47]
  buffer_load_dwordx4 v[196:199], v1, s[12:15], s25 offen offset:1024 sc1
  v_mfma_f32_16x16x32_bf16 v[48:51], a[112:115], v[100:103], v[48:51]
  v_mfma_f32_16x16x32_bf16 v[52:55], a[116:119], v[100:103], v[52:55]
  s_waitcnt vmcnt(9)
  v_mfma_f32_16x16x32_bf16 v[16:19], a[120:123], v[104:107], v[16:19]
  buffer_load_dwordx4 v[200:203], v1, s[12:15], s23 offen offset:2048 sc1
  v_mfma_f32_16x16x32_bf16 v[20:23], a[124:127], v[104:107], v[20:23]
  s_add_u32 s23, s23, 4096
  buffer_load_dwordx4 v[204:207], v1, s[12:15], s23 offen offset:2048 sc1
  v_mfma_f32_16x16x32_bf16 v[24:27], a[128:131], v[104:107], v[24:27]
  s_add_u32 s23, s23, 4096
  v_mfma_f32_16x16x32_bf16 v[28:31], a[132:135], v[104:107], v[28:31]
  v_mfma_f32_16x16x32_bf16 v[32:35], a[136:139], v[104:107], v[32:35]
  s_waitcnt vmcnt(10)
  v_mfma_f32_16x16x32_bf16 v[36:39], a[120:123], v[108:111], v[36:39]
  buffer_load_dwordx4 v[208:211], v1, s[12:15], s23 offen offset:2048 sc1
  v_mfma_f32_16x16x32_bf16 v[40:43], a[124:127], v[108:111], v[40:43]
  s_add_u32 s23, s23, 4096
  v_mfma_f32_16x16x32_bf16 v[44:47], a[128:131], v[108:111], v[44:47]
  v_mfma_f32_16x16x32_bf16 v[48:51], a[132:135], v[108:111], v[48:51]
  v_mfma_f32_16x16x32_bf16 v[52:55], a[136:139], v[108:111], v[52:55]
  buffer_load_dwordx4 v[212:215], v1, s[12:15], s23 offen offset:2048 sc1
  s_waitcnt vmcnt(11)
  v_mfma_f32_16x16x32_bf16 v[16:19], a[140:143], v[128:131], v[16:19]
  s_add_u32 s23, s23, 4096
  v_mfma_f32_16x16x32_bf16 v[20:23], a[144:147], v[128:131], v[20:23]
  v_mfma_f32_16x16x32_bf16 v[24:27], a[148:151], v[128:131], v[24:27]
  v_mfma_f32_16x16x32_bf16 v[28:31], a[152:155], v[128:131], v[28:31]
  buffer_load_dwordx4 v[216:219], v1, s[12:15], s23 offen offset:2048 sc1
  v_mfma_f32_16x16x32_bf16 v[32:35], a[156:159], v[128:131], v[32:35]
  s_add_u32 s23, s23, 4096
  s_waitcnt vmcnt(11)
  v_mfma_f32_16x16x32_bf16 v[36:39], a[140:143], v[132:135], v[36:39]
  v_mfma_f32_16x16x32_bf16 v[40:43], a[144:147], v[132:135], v[40:43]
  v_mfma_f32_16x16x32_bf16 v[44:47], a[148:151], v[132:135], v[44:47]
  buffer_load_dwordx4 v[220:223], v1, s[12:15], s23 offen offset:2048 sc1
  v_mfma_f32_16x16x32_bf16 v[48:51], a[152:155], v[132:135], v[48:51]
  s_add_u32 s23, s23, 4096
  v_mfma_f32_16x16x32_bf16 v[52:55], a[156:159], v[132:135], v[52:55]
  s_cmp_lg_u32 s3, 0
  s_cbranch_scc1 PI6
  s_load_dwordx8 s[28:35], s[54:55], 24576 glc
PI6:
  s_waitcnt vmcnt(11)
  v_mfma_f32_16x16x32_bf16 v[16:19], a[160:163], v[112:115], v[16:19]
  v_mfma_f32_16x16x32_bf16 v[20:23], a[164:167], v[112:115], v[20:23]
  buffer_load_dwordx4 v[224:227], v1, s[12:15], s23 offen offset:2048 sc1
  v_mfma_f32_16x16x32_bf16 v[24:27], a[168:171], v[112:115], v[24:27]
  s_add_u32 s23, s23, 4096
  v_mfma_f32_16x16x32_bf16 v[28:31], a[172:175], v[112:115], v[28:31]
  v_mfma_f32_16x16x32_bf16 v[32:35], a[176:179], v[112:115], v[32:35]
  s_waitcnt vmcnt(11)
  v_mfma_f32_16x16x32_bf16 v[36:39], a[160:163], v[116:119], v[36:39]
  buffer_load_dwordx4 v[228:231], v1, s[12:15], s23 offen offset:2048 sc1
  v_mfma_f32_16x16x32_bf16 v[40:43], a[164:167], v[116:119], v[40:43]
  s_add_u32 s23, s23, 4096
  v_mfma_f32_16x16x32_bf16 v[44:47], a[168:171], v[116:119], v[44:47]
  v_mfma_f32_16x16x32_bf16 v[48:51], a[172:175], v[116:119], v[48:51]
  v_mfma_f32_16x16x32_bf16 v[52:55], a[176:179], v[116:119], v[52:55]
  buffer_load_dwordx4 v[232:235], v1, s[12:15], s23 offen offset:2048 sc1
  s_waitcnt vmcnt(10)
  v_mfma_f32_16x16x32_bf16 v[16:19], a[180:183], v[192:195], v[16:19]
  s_add_u32 s23, s23, 4096
  v_mfma_f32_16x16x32_bf16 v[20:23], a[184:187], v[192:195], v[20:23]
  v_mfma_f32_16x16x32_bf16 v[24:27], a[188:191], v[192:195], v[24:27]
  v_mfma_f32_16x16x32_bf16 v[28:31], a[192:195], v[192:195], v[28:31]
  buffer_load_dwordx4 v[236:239], v1, s[12:15], s23 offen offset:2048 sc1
  v_mfma_f32_16x16x32_bf16 v[32:35], a[196:199], v[192:195], v[32:35]
  s_add_u32 s23, s23, 4096
  s_waitcnt vmcnt(10)
  v_mfma_f32_16x16x32_bf16 v[36:39], a[180:183], v[196:199], v[36:39]
  v_mfma_f32_16x16x32_bf16 v[40:43], a[184:187], v[196:199], v[40:43]
  v_mfma_f32_16x16x32_bf16 v[44:47], a[188:191], v[196:199], v[44:47]
  buffer_load_dwordx4 v[240:243], v1, s[12:15], s23 offen offset:2048 sc1
  v_mfma_f32_16x16x32_bf16 v[48:51], a[192:195], v[196:199], v[48:51]
  s_add_u32 s23, s23, 4096
  v_mfma_f32_16x16x32_bf16 v[52:55], a[196:199], v[196:199], v[52:55]
  s_cmp_ge_u32 s3, 2
  s_cbranch_scc1 SK43
  v_mfma_f32_16x16x32_bf16 v[16:19], a[200:203], v[120:123], v[16:19]
  v_mfma_f32_16x16x32_bf16 v[20:23], a[204:207], v[120:123], v[20:23]
  v_mfma_f32_16x16x32_bf16 v[24:27], a[208:211], v[120:123], v[24:27]
  v_mfma_f32_16x16x32_bf16 v[28:31], a[212:215], v[120:123], v[28:31]
  v_mfma_f32_16x16x32_bf16 v[32:35], a[216:219], v[120:123], v[32:35]
SK43:
  s_cmp_ge_u32 s3, 2
  s_cbranch_scc1 SK44
  v_mfma_f32_16x16x32_bf16 v[36:39], a[200:203], v[124:127], v[36:39]
  v_mfma_f32_16x16x32_bf16 v[40:43], a[204:207], v[124:127], v[40:43]
  v_mfma_f32_16x16x32_bf16 v[44:47], a[208:211], v[124:127], v[44:47]
  v_mfma_f32_16x16x32_bf16 v[48:51], a[212:215], v[124:127], v[48:51]
  v_mfma_f32_16x16x32_bf16 v[52:55], a[216:219], v[124:127], v[52:55]
SK44:
  s_waitcnt lgkmcnt(0)
  s_mov_b32 s61, 0
  s_cmp_lg_u32 s3, 0
  s_cbranch_scc1 ACQ6_DONE
ACQ6:
  s_xor_b32 s28, s28, s94
  s_xor_b32 s29, s29, s94
  s_xor_b32 s30, s30, s94
  s_xor_b32 s31, s31, s94
  s_xor_b32 s32, s32, s94
  s_xor_b32 s33, s33, s94
  s_xor_b32 s34, s34, s94
  s_xor_b32 s35, s35, s94
  s_or_b64 s[28:29], s[28:29], s[30:31]
  s_or_b64 s[28:29], s[28:29], s[32:33]
  s_or_b64 s[28:29], s[28:29], s[34:35]
  s_cbranch_scc0 ACQ6_DONE
  s_load_dwordx8 s[28:35], s[54:55], 24576 glc
  s_waitcnt lgkmcnt(0)
  s_add_u32 s61, s61, 1
  s_cmp_lt_u32 s61, 262144
  s_cbranch_scc1 ACQ6
ACQ6_DONE:
  s_barrier
  s_waitcnt vmcnt(10)
  v_mfma_f32_16x16x32_bf16 v[56:59], a[220:223], v[200:203], 0
  v_mfma_f32_16x16x32_bf16 v[60:63], a[224:227], v[200:203], 0
  buffer_load_dwordx4 v[244:247], v1, s[12:15], s23 offen offset:2048 sc1
  v_mfma_f32_16x16x32_bf16 v[64:67], a[228:231], v[200:203], 0
  s_add_u32 s23, s23, 8192
  v_mfma_f32_16x16x32_bf16 v[68:71], a[232:235], v[200:203], 0
  v_mfma_f32_16x16x32_bf16 v[72:75], a[236:239], v[200:203], 0
  s_waitcnt vmcnt(10)
  v_mfma_f32_16x16x32_bf16 v[56:59], a[240:243], v[204:207], v[56:59]
  s_cmp_ge_u32 s3, 2
  s_cbranch_scc1 SK45
  buffer_load_dwordx4 v[248:251], v1, s[12:15], s23 offen offset:2048 sc1
SK45:
  v_mfma_f32_16x16x32_bf16 v[60:63], a[244:247], v[204:207], v[60:63]
  ds_write_b128 v12, v[16:19] offset:0
  v_mfma_f32_16x16x32_bf16 v[64:67], a[248:251], v[204:207], v[64:67]
  s_add_u32 s23, s23, -4096
  v_mfma_f32_16x16x32_bf16 v[68:71], a[252:255], v[204:207], v[68:71]
  ds_write_b128 v12, v[20:23] offset:1024
  v_mfma_f32_16x16x32_bf16 v[72:75], v[136:139], v[204:207], v[72:75]
  buffer_load_dwordx4 v[252:255], v1, s[12:15], s23 offen offset:2048 sc1
  s_waitcnt vmcnt(10)
  v_mfma_f32_16x16x32_bf16 v[56:59], v[140:143], v[208:211], v[56:59]
  v_mfma_f32_16x16x32_bf16 v[60:63], v[144:147], v[208:211], v[60:63]
  ds_write_b128 v12, v[24:27] offset:2048
  v_mfma_f32_16x16x32_bf16 v[64:67], v[148:151], v[208:211], v[64:67]
  v_mfma_f32_16x16x32_bf16 v[68:71], v[152:155], v[208:211], v[68:71]
  buffer_load_dwordx4 v[96:99], v1, s[12:15], s63 offen offset:3072 sc1
  v_mfma_f32_16x16x32_bf16 v[72:75], v[156:159], v[208:211], v[72:75]
  s_add_u32 s63, s63, 4096
  s_waitcnt vmcnt(10)
  v_mfma_f32_16x16x32_bf16 v[56:59], a[0:3], v[212:215], v[56:59]
  v_mfma_f32_16x16x32_bf16 v[60:63], a[4:7], v[212:215], v[60:63]
  ds_write_b128 v12, v[28:31] offset:3072
  v_mfma_f32_16x16x32_bf16 v[64:67], a[8:11], v[212:215], v[64:67]
  buffer_load_dwordx4 v[100:103], v1, s[12:15], s63 offen offset:3072 sc1
  v_mfma_f32_16x16x32_bf16 v[68:71], a[12:15], v[212:215], v[68:71]
  ds_write_b128 v12, v[32:35] offset:4096
  v_mfma_f32_16x16x32_bf16 v[72:75], a[16:19], v[212:215], v[72:75]
  s_add_u32 s63, s63, 4096
  s_waitcnt vmcnt(10)
  v_mfma_f32_16x16x32_bf16 v[56:59], a[20:23], v[216:219], v[56:59]
  v_mfma_f32_16x16x32_bf16 v[60:63], a[24:27], v[216:219], v[60:63]
  buffer_load_dwordx4 v[104:107], v1, s[12:15], s63 offen offset:3072 sc1
  v_mfma_f32_16x16x32_bf16 v[64:67], a[28:31], v[216:219], v[64:67]
  s_add_u32 s63, s63, 4096
  v_mfma_f32_16x16x32_bf16 v[68:71], a[32:35], v[216:219], v[68:71]
  ds_write_b128 v12, v[36:39] offset:20480
  v_mfma_f32_16x16x32_bf16 v[72:75], a[36:39], v[216:219], v[72:75]
  s_waitcnt vmcnt(10)
  v_mfma_f32_16x16x32_bf16 v[56:59], a[40:43], v[220:223], v[56:59]
  buffer_load_dwordx4 v[108:111], v1, s[12:15], s63 offen offset:3072 sc1
  v_mfma_f32_16x16x32_bf16 v[60:63], a[44:47], v[220:223], v[60:63]
  ds_write_b128 v12, v[40:43] offset:21504
  v_mfma_f32_16x16x32_bf16 v[64:67], a[48:51], v[220:223], v[64:67]
  s_add_u32 s63, s63, 4096
  v_mfma_f32_16x16x32_bf16 v[68:71], a[52:55], v[220:223], v[68:71]
  ds_write_b128 v12, v[44:47] offset:22528
  v_mfma_f32_16x16x32_bf16 v[72:75], a[56:59], v[220:223], v[72:75]
  buffer_load_dwordx4 v[128:131], v1, s[12:15], s63 offen offset:3072 sc1
  s_waitcnt vmcnt(11)
  v_mfma_f32_16x16x32_bf16 v[56:59], a[60:63], v[224:227], v[56:59]
  s_add_u32 s63, s63, 4096
  v_mfma_f32_16x16x32_bf16 v[60:63], a[64:67], v[224:227], v[60:63]
  ds_write_b128 v12, v[48:51] offset:23552
  v_mfma_f32_16x16x32_bf16 v[64:67], a[68:71], v[224:227], v[64:67]
  v_mfma_f32_16x16x32_bf16 v[68:71], a[72:75], v[224:227], v[68:71]
  buffer_load_dwordx4 v[132:135], v1, s[12:15], s63 offen offset:3072 sc1
  v_mfma_f32_16x16x32_bf16 v[72:75], a[76:79], v[224:227], v[72:75]
  s_add_u32 s63, s63, 4096
  s_waitcnt vmcnt(11)
  v_mfma_f32_16x16x32_bf16 v[56:59], a[80:83], v[228:231], v[56:59]
  v_mfma_f32_16x16x32_bf16 v[60:63], a[84:87], v[228:231], v[60:63]
  ds_write_b128 v12, v[52:55] offset:24576
  v_mfma_f32_16x16x32_bf16 v[64:67], a[88:91], v[228:231], v[64:67]
  buffer_load_dwordx4 v[112:115], v1, s[12:15], s63 offen offset:3072 sc1
  v_mfma_f32_16x16x32_bf16 v[68:71], a[92:95], v[228:231], v[68:71]
  s_add_u32 s63, s63, 4096
  v_mfma_f32_16x16x32_bf16 v[72:75], a[96:99], v[228:231], v[72:75]
  s_waitcnt lgkmcnt(0)
  s_barrier
  s_waitcnt vmcnt(11)
  v_mfma_f32_16x16x32_bf16 v[56:59], a[100:103], v[232:235], v[56:59]
  ds_read_b128 v[16:19], v0 offset:0
  v_lshlrev_b32 v172, 16, v166
  v_mfma_f32_16x16x32_bf16 v[60:63], a[104:107], v[232:235], v[60:63]
  buffer_load_dwordx4 v[116:119], v1, s[12:15], s63 offen offset:3072 sc1
  v_mfma_f32_16x16x32_bf16 v[64:67], a[108:111], v[232:235], v[64:67]
  s_add_u32 s63, s63, 4096
  ds_read_b128 v[20:23], v0 offset:5120
  v_and_b32 v173, 0xffff0000, v166
  v_mfma_f32_16x16x32_bf16 v[68:71], a[112:115], v[232:235], v[68:71]
  ds_read_b128 v[24:27], v0 offset:10240
  v_lshlrev_b32 v174, 16, v180
  v_mfma_f32_16x16x32_bf16 v[72:75], a[116:119], v[232:235], v[72:75]
  ds_read_b128 v[28:31], v0 offset:15360
  v_and_b32 v175, 0xffff0000, v180
  s_waitcnt vmcnt(11)
  v_mfma_f32_16x16x32_bf16 v[56:59], a[120:123], v[236:239], v[56:59]
  buffer_load_dwordx4 v[120:123], v1, s[12:15], s63 offen offset:3072 sc1
  v_mfma_f32_16x16x32_bf16 v[60:63], a[124:127], v[236:239], v[60:63]
  s_add_u32 s63, s63, 4096
  ds_read_b128 v[32:35], v0 offset:1024
  v_mfma_f32_16x16x32_bf16 v[64:67], a[128:131], v[236:239], v[64:67]
  ds_read_b128 v[36:39], v0 offset:6144
  v_lshlrev_b32 v176, 16, v167
  v_mfma_f32_16x16x32_bf16 v[68:71], a[132:135], v[236:239], v[68:71]
  ds_read_b128 v[40:43], v0 offset:11264
  v_and_b32 v177, 0xffff0000, v167
  v_mfma_f32_16x16x32_bf16 v[72:75], a[136:139], v[236:239], v[72:75]
  buffer_load_dwordx4 v[124:127], v1, s[12:15], s63 offen offset:3072 sc1
  s_waitcnt vmcnt(12)
  v_mfma_f32_16x16x32_bf16 v[56:59], a[140:143], v[240:243], v[56:59]
  s_add_u32 s63, s63, 4096
  ds_read_b128 v[44:47], v0 offset:16384
  s_waitcnt lgkmcnt(6)
  v_add_f32 v16, v16, v20
  v_mfma_f32_16x16x32_bf16 v[60:63], a[144:147], v[240:243], v[60:63]
  s_waitcnt lgkmcnt(4)
  v_add_f32 v24, v24, v28
  v_add_f32 v17, v17, v21
  v_mfma_f32_16x16x32_bf16 v[64:67], a[148:151], v[240:243], v[64:67]
  v_add_f32 v25, v25, v29
  v_add_f32 v16, v16, v24
  v_mfma_f32_16x16x32_bf16 v[68:71], a[152:155], v[240:243], v[68:71]
  buffer_load_dwordx4 v[192:195], v1, s[12:15], s63 offen offset:3072 sc1
  v_mfma_f32_16x16x32_bf16 v[72:75], a[156:159], v[240:243], v[72:75]
  s_add_u32 s63, s63, 4096
  v_add_f32 v17, v17, v25
  v_add_f32 v16, v16, v172
  s_waitcnt vmcnt(12)
  v_mfma_f32_16x16x32_bf16 v[56:59], a[160:163], v[244:247], v[56:59]
  v_add_f32 v17, v17, v173
  v_lshlrev_b32 v172, 16, v160
  v_mfma_f32_16x16x32_bf16 v[60:63], a[164:167], v[244:247], v[60:63]
  v_and_b32 v173, 0xffff0000, v160
  v_fma_f32 v174, v16, v172, v174
  v_mfma_f32_16x16x32_bf16 v[64:67], a[168:171], v[244:247], v[64:67]
  buffer_load_dwordx4 v[196:199], v1, s[12:15], s63 offen offset:3072 sc1
  v_mfma_f32_16x16x32_bf16 v[68:71], a[172:175], v[244:247], v[68:71]
  s_add_u32 s63, s63, 8192
  v_fma_f32 v175, v17, v173, v175
  v_cvt_pk_bf16_f32 v48, v174, v175
  v_mfma_f32_16x16x32_bf16 v[72:75], a[176:179], v[244:247], v[72:75]
  s_waitcnt vmcnt(12)
  v_add_f32 v18, v18, v22
  v_add_f32 v26, v26, v30
  v_mfma_f32_16x16x32_bf16 v[56:59], a[180:183], v[252:255], v[56:59]
  v_add_f32 v19, v19, v23
  v_add_f32 v27, v27, v31
  v_mfma_f32_16x16x32_bf16 v[60:63], a[184:187], v[252:255], v[60:63]
  s_cmp_ge_u32 s3, 2
  s_cbranch_scc1 SK46
  buffer_load_dwordx4 v[200:203], v1, s[12:15], s63 offen offset:3072 sc1
SK46:
  v_mfma_f32_16x16x32_bf16 v[64:67], a[188:191], v[252:255], v[64:67]
  s_add_u32 s63, s63, -4096
  v_add_f32 v18, v18, v26
  v_add_f32 v19, v19, v27
  v_mfma_f32_16x16x32_bf16 v[68:71], a[192:195], v[252:255], v[68:71]
  v_add_f32 v18, v18, v176
  v_add_f32 v19, v19, v177
  v_mfma_f32_16x16x32_bf16 v[72:75], a[196:199], v[252:255], v[72:75]
  v_lshlrev_b32 v176, 16, v161
  v_and_b32 v177, 0xffff0000, v161
  s_cmp_ge_u32 s3, 2
  s_cbranch_scc1 SK47
  v_mfma_f32_16x16x32_bf16 v[56:59], a[200:203], v[248:251], v[56:59]
  v_mfma_f32_16x16x32_bf16 v[60:63], a[204:207], v[248:251], v[60:63]
  v_mfma_f32_16x16x32_bf16 v[64:67], a[208:211], v[248:251], v[64:67]
  v_mfma_f32_16x16x32_bf16 v[68:71], a[212:215], v[248:251], v[68:71]
  v_mfma_f32_16x16x32_bf16 v[72:75], a[216:219], v[248:251], v[72:75]
SK47:
  s_waitcnt vmcnt(11)
  v_mfma_f32_16x16x32_bf16 v[76:79], a[220:223], v[96:99], 0
  buffer_load_dwordx4 v[204:207], v1, s[12:15], s63 offen offset:3072 sc1
  v_mfma_f32_16x16x32_bf16 v[80:83], a[224:227], v[96:99], 0
  v_lshlrev_b32 v178, 16, v181
  v_and_b32 v179, 0xffff0000, v181
  v_mfma_f32_16x16x32_bf16 v[84:87], a[228:231], v[96:99], 0
  v_fma_f32 v178, v18, v176, v178
  v_fma_f32 v179, v19, v177, v179
  v_mfma_f32_16x16x32_bf16 v[88:91], a[232:235], v[96:99], 0
  ds_read_b128 v[16:19], v13 offset:4096
  v_cvt_pk_bf16_f32 v49, v178, v179
  v_mfma_f32_16x16x32_bf16 v[92:95], a[236:239], v[96:99], 0
  ds_read_b128 v[20:23], v13 offset:9216
  s_waitcnt lgkmcnt(4)
  v_add_f32 v32, v32, v36
  s_waitcnt vmcnt(11)
  v_mfma_f32_16x16x32_bf16 v[76:79], a[240:243], v[100:103], v[76:79]
  ds_read_b128 v[24:27], v13 offset:14336
  s_waitcnt lgkmcnt(3)
  v_add_f32 v40, v40, v44
  v_mfma_f32_16x16x32_bf16 v[80:83], a[244:247], v[100:103], v[80:83]
  ds_write_b128 v4, v[56:59] offset:0
  v_mfma_f32_16x16x32_bf16 v[84:87], a[248:251], v[100:103], v[84:87]
  ds_read_b128 v[28:31], v13 offset:19456
  v_add_f32 v33, v33, v37
  v_mfma_f32_16x16x32_bf16 v[88:91], a[252:255], v[100:103], v[88:91]
  v_add_f32 v41, v41, v45
  v_lshlrev_b32 v172, 16, v168
  v_mfma_f32_16x16x32_bf16 v[92:95], v[136:139], v[100:103], v[92:95]
  s_waitcnt vmcnt(10)
  v_and_b32 v173, 0xffff0000, v168
  v_add_f32 v32, v32, v40
  v_mfma_f32_16x16x32_bf16 v[76:79], v[140:143], v[104:107], v[76:79]
  v_add_f32 v33, v33, v41
  v_add_f32 v32, v32, v172
  v_mfma_f32_16x16x32_bf16 v[80:83], v[144:147], v[104:107], v[80:83]
  ds_write_b128 v4, v[60:63] offset:1024
  v_mfma_f32_16x16x32_bf16 v[84:87], v[148:151], v[104:107], v[84:87]
  v_add_f32 v33, v33, v173
  v_lshlrev_b32 v172, 16, v162
  v_mfma_f32_16x16x32_bf16 v[88:91], v[152:155], v[104:107], v[88:91]
  ds_write_b128 v4, v[64:67] offset:2048
  v_mfma_f32_16x16x32_bf16 v[92:95], v[156:159], v[104:107], v[92:95]
  s_waitcnt vmcnt(9)
  v_and_b32 v173, 0xffff0000, v162
  v_lshlrev_b32 v174, 16, v182
  v_mfma_f32_16x16x32_bf16 v[76:79], a[0:3], v[108:111], v[76:79]
  v_and_b32 v175, 0xffff0000, v182
  v_fma_f32 v174, v32, v172, v174
  v_mfma_f32_16x16x32_bf16 v[80:83], a[4:7], v[108:111], v[80:83]
  v_fma_f32 v175, v33, v173, v175
  v_cvt_pk_bf16_f32 v50, v174, v175
  v_mfma_f32_16x16x32_bf16 v[84:87], a[8:11], v[108:111], v[84:87]
  v_add_f32 v34, v34, v38
  v_add_f32 v42, v42, v46
  v_mfma_f32_16x16x32_bf16 v[88:91], a[12:15], v[108:111], v[88:91]
  ds_write_b128 v4, v[68:71] offset:3072
  v_mfma_f32_16x16x32_bf16 v[92:95], a[16:19], v[108:111], v[92:95]
  s_waitcnt vmcnt(8)
  v_add_f32 v35, v35, v39
  v_add_f32 v43, v43, v47
  v_mfma_f32_16x16x32_bf16 v[76:79], a[20:23], v[128:131], v[76:79]
  v_lshlrev_b32 v176, 16, v169
  v_and_b32 v177, 0xffff0000, v169
  v_mfma_f32_16x16x32_bf16 v[80:83], a[24:27], v[128:131], v[80:83]
  ds_write_b128 v4, v[72:75] offset:4096
  v_mfma_f32_16x16x32_bf16 v[84:87], a[28:31], v[128:131], v[84:87]
  v_add_f32 v34, v34, v42
  v_add_f32 v35, v35, v43
  v_mfma_f32_16x16x32_bf16 v[88:91], a[32:35], v[128:131], v[88:91]
  v_add_f32 v34, v34, v176
  v_add_f32 v35, v35, v177
  v_mfma_f32_16x16x32_bf16 v[92:95], a[36:39], v[128:131], v[92:95]
  s_waitcnt vmcnt(7)
  v_lshlrev_b32 v176, 16, v163
  v_and_b32 v177, 0xffff0000, v163
  v_mfma_f32_16x16x32_bf16 v[76:79], a[40:43], v[132:135], v[76:79]
  v_lshlrev_b32 v178, 16, v183
  v_and_b32 v179, 0xffff0000, v183
  v_mfma_f32_16x16x32_bf16 v[80:83], a[44:47], v[132:135], v[80:83]
  v_fma_f32 v178, v34, v176, v178
  v_fma_f32 v179, v35, v177, v179
  v_mfma_f32_16x16x32_bf16 v[84:87], a[48:51], v[132:135], v[84:87]
  s_waitcnt lgkmcnt(7)
  v_cvt_pk_bf16_f32 v51, v178, v179
  v_add_f32 v16, v16, v20
  v_mfma_f32_16x16x32_bf16 v[88:91], a[52:55], v[132:135], v[88:91]
  s_waitcnt lgkmcnt(4)
  v_add_f32 v24, v24, v28
  v_add_f32 v17, v17, v21
  v_mfma_f32_16x16x32_bf16 v[92:95], a[56:59], v[132:135], v[92:95]
  s_waitcnt vmcnt(6)
  v_add_f32 v25, v25, v29
  v_lshlrev_b32 v172, 16, v170
  v_mfma_f32_16x16x32_bf16 v[76:79], a[60:63], v[112:115], v[76:79]
  v_and_b32 v173, 0xffff0000, v170
  v_add_f32 v16, v16, v24
  v_mfma_f32_16x16x32_bf16 v[80:83], a[64:67], v[112:115], v[80:83]
  v_add_f32 v17, v17, v25
  v_add_f32 v16, v16, v172
  v_mfma_f32_16x16x32_bf16 v[84:87], a[68:71], v[112:115], v[84:87]
  v_add_f32 v17, v17, v173
  v_lshlrev_b32 v172, 16, v164
  v_mfma_f32_16x16x32_bf16 v[88:91], a[72:75], v[112:115], v[88:91]
  v_and_b32 v173, 0xffff0000, v164
  v_lshlrev_b32 v174, 16, v184
  v_mfma_f32_16x16x32_bf16 v[92:95], a[76:79], v[112:115], v[92:95]
  s_waitcnt vmcnt(5)
  v_and_b32 v175, 0xffff0000, v184
  v_fma_f32 v174, v16, v172, v174
  v_mfma_f32_16x16x32_bf16 v[76:79], a[80:83], v[116:119], v[76:79]
  buffer_store_dwordx4 v[48:51], v6, s[16:19], s97 offen offset:0
  v_mfma_f32_16x16x32_bf16 v[80:83], a[84:87], v[116:119], v[80:83]
  v_fma_f32 v175, v17, v173, v175
  v_cvt_pk_bf16_f32 v52, v174, v175
  v_mfma_f32_16x16x32_bf16 v[84:87], a[88:91], v[116:119], v[84:87]
  v_add_f32 v18, v18, v22
  v_add_f32 v26, v26, v30
  v_mfma_f32_16x16x32_bf16 v[88:91], a[92:95], v[116:119], v[88:91]
  v_add_f32 v19, v19, v23
  v_add_f32 v27, v27, v31
  v_mfma_f32_16x16x32_bf16 v[92:95], a[96:99], v[116:119], v[92:95]
  s_waitcnt vmcnt(5)
  v_lshlrev_b32 v176, 16, v171
  v_and_b32 v177, 0xffff0000, v171
  v_mfma_f32_16x16x32_bf16 v[76:79], a[100:103], v[120:123], v[76:79]
  v_add_f32 v18, v18, v26
  v_add_f32 v19, v19, v27
  v_mfma_f32_16x16x32_bf16 v[80:83], a[104:107], v[120:123], v[80:83]
  v_add_f32 v18, v18, v176
  v_add_f32 v19, v19, v177
  v_mfma_f32_16x16x32_bf16 v[84:87], a[108:111], v[120:123], v[84:87]
  v_lshlrev_b32 v176, 16, v165
  v_and_b32 v177, 0xffff0000, v165
  v_mfma_f32_16x16x32_bf16 v[88:91], a[112:115], v[120:123], v[88:91]
  v_lshlrev_b32 v178, 16, v185
  v_and_b32 v179, 0xffff0000, v185
  v_mfma_f32_16x16x32_bf16 v[92:95], a[116:119], v[120:123], v[92:95]
  s_waitcnt vmcnt(4)
  v_fma_f32 v178, v18, v176, v178
  v_fma_f32 v179, v19, v177, v179
  v_mfma_f32_16x16x32_bf16 v[76:79], a[120:123], v[124:127], v[76:79]
  v_cvt_pk_bf16_f32 v53, v178, v179
  v_lshlrev_b32 v16, 16, v186
  v_mfma_f32_16x16x32_bf16 v[80:83], a[124:127], v[124:127], v[80:83]
  buffer_store_dwordx2 v[52:53], v7, s[16:19], s97 offen offset:128
  v_mfma_f32_16x16x32_bf16 v[84:87], a[128:131], v[124:127], v[84:87]
  v_and_b32 v17, 0xffff0000, v186
  v_lshlrev_b32 v18, 16, v160
  v_mfma_f32_16x16x32_bf16 v[88:91], a[132:135], v[124:127], v[88:91]
  v_and_b32 v19, 0xffff0000, v160
  v_lshlrev_b32 v20, 16, v166
  v_mfma_f32_16x16x32_bf16 v[92:95], a[136:139], v[124:127], v[92:95]
  s_waitcnt vmcnt(4)
  v_and_b32 v21, 0xffff0000, v166
  v_lshlrev_b32 v22, 16, v187
  v_mfma_f32_16x16x32_bf16 v[76:79], a[140:143], v[192:195], v[76:79]
  v_and_b32 v23, 0xffff0000, v187
  v_lshlrev_b32 v24, 16, v161
  v_mfma_f32_16x16x32_bf16 v[80:83], a[144:147], v[192:195], v[80:83]
  v_and_b32 v25, 0xffff0000, v161
  v_lshlrev_b32 v26, 16, v167
  v_mfma_f32_16x16x32_bf16 v[84:87], a[148:151], v[192:195], v[84:87]
  v_and_b32 v27, 0xffff0000, v167
  v_lshlrev_b32 v28, 16, v188
  v_mfma_f32_16x16x32_bf16 v[88:91], a[152:155], v[192:195], v[88:91]
  v_and_b32 v29, 0xffff0000, v188
  v_lshlrev_b32 v30, 16, v162
  v_mfma_f32_16x16x32_bf16 v[92:95], a[156:159], v[192:195], v[92:95]
  s_waitcnt vmcnt(3)
  v_and_b32 v31, 0xffff0000, v162
  v_lshlrev_b32 v32, 16, v168
  v_mfma_f32_16x16x32_bf16 v[76:79], a[160:163], v[196:199], v[76:79]
  v_and_b32 v33, 0xffff0000, v168
  v_lshlrev_b32 v34, 16, v189
  v_mfma_f32_16x16x32_bf16 v[80:83], a[164:167], v[196:199], v[80:83]
  v_and_b32 v35, 0xffff0000, v189
  v_lshlrev_b32 v36, 16, v163
  v_mfma_f32_16x16x32_bf16 v[84:87], a[168:171], v[196:199], v[84:87]
  v_and_b32 v37, 0xffff0000, v163
  v_lshlrev_b32 v38, 16, v169
  v_mfma_f32_16x16x32_bf16 v[88:91], a[172:175], v[196:199], v[88:91]
  v_and_b32 v39, 0xffff0000, v169
  v_lshlrev_b32 v40, 16, v190
  v_mfma_f32_16x16x32_bf16 v[92:95], a[176:179], v[196:199], v[92:95]
  s_waitcnt vmcnt(2)
  v_and_b32 v41, 0xffff0000, v190
  v_lshlrev_b32 v42, 16, v164
  v_mfma_f32_16x16x32_bf16 v[76:79], a[180:183], v[204:207], v[76:79]
  v_and_b32 v43, 0xffff0000, v164
  v_lshlrev_b32 v44, 16, v170
  v_mfma_f32_16x16x32_bf16 v[80:83], a[184:187], v[204:207], v[80:83]
  v_and_b32 v45, 0xffff0000, v170
  v_mfma_f32_16x16x32_bf16 v[84:87], a[188:191], v[204:207], v[84:87]
  v_mfma_f32_16x16x32_bf16 v[88:91], a[192:195], v[204:207], v[88:91]
  v_mfma_f32_16x16x32_bf16 v[92:95], a[196:199], v[204:207], v[92:95]
  s_cmp_ge_u32 s3, 2
  s_cbranch_scc1 SK48
  v_mfma_f32_16x16x32_bf16 v[76:79], a[200:203], v[200:203], v[76:79]
  v_mfma_f32_16x16x32_bf16 v[80:83], a[204:207], v[200:203], v[80:83]
  v_mfma_f32_16x16x32_bf16 v[84:87], a[208:211], v[200:203], v[84:87]
  v_mfma_f32_16x16x32_bf16 v[88:91], a[212:215], v[200:203], v[88:91]
  v_mfma_f32_16x16x32_bf16 v[92:95], a[216:219], v[200:203], v[92:95]
SK48:
  v_lshlrev_b32 v172, 16, v191
  v_and_b32 v173, 0xffff0000, v191
  v_lshlrev_b32 v174, 16, v165
  v_and_b32 v175, 0xffff0000, v165
  v_lshlrev_b32 v176, 16, v171
  v_and_b32 v177, 0xffff0000, v171
  s_nop 1
  ds_write_b128 v4, v[76:79] offset:20480
  ds_write_b128 v4, v[80:83] offset:21504
  ds_write_b128 v4, v[84:87] offset:22528
  ds_write_b128 v4, v[88:91] offset:23552
  ds_write_b128 v4, v[92:95] offset:24576
  s_waitcnt lgkmcnt(0)
  s_barrier
  ds_read_b128 v[192:195], v0 offset:40960
  ds_read_b128 v[196:199], v0 offset:46080
  ds_read_b128 v[200:203], v0 offset:51200
  ds_read_b128 v[204:207], v0 offset:56320
  ds_read_b128 v[208:211], v0 offset:41984
  ds_read_b128 v[212:215], v0 offset:47104
  ds_read_b128 v[216:219], v0 offset:52224
  ds_read_b128 v[220:223], v0 offset:57344
  ds_read_b128 v[224:227], v13 offset:45056
  ds_read_b128 v[228:231], v13 offset:50176
  ds_read_b128 v[232:235], v13 offset:55296
  ds_read_b128 v[236:239], v13 offset:60416
  s_waitcnt lgkmcnt(10)
  v_pk_add_f32 v[192:193], v[192:193], v[196:197]
  s_waitcnt lgkmcnt(8)
  v_pk_add_f32 v[200:201], v[200:201], v[204:205]
  v_pk_add_f32 v[192:193], v[192:193], v[200:201]
  v_pk_add_f32 v[192:193], v[192:193], v[20:21]
  v_pk_fma_f32 v[16:17], v[192:193], v[18:19], v[16:17]
  v_cvt_pk_bf16_f32 v56, v16, v17
  v_pk_add_f32 v[194:195], v[194:195], v[198:199]
  v_pk_add_f32 v[202:203], v[202:203], v[206:207]
  v_pk_add_f32 v[194:195], v[194:195], v[202:203]
  v_pk_add_f32 v[194:195], v[194:195], v[26:27]
  v_pk_fma_f32 v[22:23], v[194:195], v[24:25], v[22:23]
  v_cvt_pk_bf16_f32 v57, v22, v23
  s_waitcnt lgkmcnt(6)
  v_pk_add_f32 v[208:209], v[208:209], v[212:213]
  s_waitcnt lgkmcnt(4)
  v_pk_add_f32 v[216:217], v[216:217], v[220:221]
  v_pk_add_f32 v[208:209], v[208:209], v[216:217]
  v_pk_add_f32 v[208:209], v[208:209], v[32:33]
  v_pk_fma_f32 v[28:29], v[208:209], v[30:31], v[28:29]
  v_cvt_pk_bf16_f32 v58, v28, v29
  v_pk_add_f32 v[210:211], v[210:211], v[214:215]
  v_pk_add_f32 v[218:219], v[218:219], v[222:223]
  v_pk_add_f32 v[210:211], v[210:211], v[218:219]
  v_pk_add_f32 v[210:211], v[210:211], v[38:39]
  v_pk_fma_f32 v[34:35], v[210:211], v[36:37], v[34:35]
  v_cvt_pk_bf16_f32 v59, v34, v35
  buffer_store_dwordx4 v[56:59], v6, s[16:19], s97 offen offset:1280
  s_waitcnt lgkmcnt(2)
  v_pk_add_f32 v[224:225], v[224:225], v[228:229]
  s_waitcnt lgkmcnt(0)
  v_pk_add_f32 v[232:233], v[232:233], v[236:237]
  v_pk_add_f32 v[224:225], v[224:225], v[232:233]
  v_pk_add_f32 v[224:225], v[224:225], v[44:45]
  v_pk_fma_f32 v[40:41], v[224:225], v[42:43], v[40:41]
  v_cvt_pk_bf16_f32 v60, v40, v41
  v_pk_add_f32 v[226:227], v[226:227], v[230:231]
  v_pk_add_f32 v[234:235], v[234:235], v[238:239]
  v_pk_add_f32 v[226:227], v[226:227], v[234:235]
  v_pk_add_f32 v[226:227], v[226:227], v[176:177]
  v_pk_fma_f32 v[172:173], v[226:227], v[174:175], v[172:173]
  v_cvt_pk_bf16_f32 v61, v172, v173
  buffer_store_dwordx2 v[60:61], v7, s[16:19], s97 offen offset:1408
KP_END:
  s_endpgm
.section .rodata,"a"
.p2align 6
.amdhsa_kernel adaLN_cond__sliding_local_dilated__mixer_channel_mlp__prompt_kernel
  .amdhsa_next_free_vgpr 512
  .amdhsa_next_free_sgpr 102
  .amdhsa_accum_offset 256
  .amdhsa_group_segment_fixed_size 0
  .amdhsa_kernarg_size 104
  .amdhsa_user_sgpr_count 2
  .amdhsa_user_sgpr_kernarg_segment_ptr 1
  .amdhsa_system_sgpr_workgroup_id_x 1
.end_amdhsa_kernel
```
